```python
import torch

def _softmax(x, axis=-1):
    return torch.softmax(x, dim=axis)

def _gelu(x):
    return torch.nn.functional.gelu(x, approximate='tanh')

def _silu(x):
    return torch.nn.functional.silu(x)

def _sigmoid(x):
    return torch.sigmoid(x)

def _layernorm(x, axis=-1, eps=1e-05):
    m = x.mean(dim=axis, keepdim=True)
    v = x.var(dim=axis, keepdim=True, unbiased=False)
    return (x - m) / torch.sqrt(v + eps)

def _scatter_add(tgt, idx, src, axis=0):
    return tgt.clone().index_add_(axis, idx, src)

def _segment_sum(src, seg, n):
    out = torch.zeros((n,) + src.shape[1:], dtype=src.dtype)
    return out.index_add_(0, seg, src)

def _pad(x, pw):
    flat = tuple((v for pair in reversed(pw) for v in pair))
    return torch.nn.functional.pad(x, flat)
kernel_name = 'adaLN_cond__compressed_kv_cla__mixer_gmlp__prompt'

def setup_inputs():

    _w = lambda a: (lambda t: t.to(torch.bfloat16) if t.is_floating_point() else t)(torch.as_tensor(a))

    def _A_setup():
        B, H, Sq, Sk, D, M = (1, 32, 2048, 2048, 128, 512)
        Dc = 4 * D
        return {'x': _w((lambda *s: torch.randn(*s, dtype=torch.bfloat16) * 0.05)(B, Sq, M)), 'c_kv': _w((lambda *s: torch.randn(*s, dtype=torch.bfloat16) * 1.6)(B, Sk, Dc)), 'w_q': _w((lambda *s: torch.randn(*s, dtype=torch.bfloat16) * 0.8)(M, H, D) * M ** (-0.5)), 'w_uk': _w((lambda *s: torch.randn(*s, dtype=torch.bfloat16) * 0.8)(Dc, H, D) * Dc ** (-0.5)), 'w_uv': _w((lambda *s: torch.randn(*s, dtype=torch.bfloat16) * 1.6)(Dc, H, D) * Dc ** (-0.5)), 'w_o': _w((lambda *s: torch.randn(*s, dtype=torch.bfloat16) * 1.6)(H, D, M) * (H * D) ** (-0.5))}
    _A_in = _A_setup()

    def _B_setup():
        B, S, D, F = (1, 2048, 512, 1376)
        Fh = F // 2
        return {'x': _w((lambda *s: torch.randn(*s, dtype=torch.bfloat16) * 0.05)(B, S, D)), 'w_in': _w((lambda *s: torch.randn(*s, dtype=torch.bfloat16) * 0.4)(D, 2 * Fh)), 'w_sp': _w(0.01 * (lambda *s: torch.randn(*s, dtype=torch.bfloat16) * 0.4)(S, S)), 'b_sp': _w(1.0 + 0.01 * (lambda *s: torch.randn(*s, dtype=torch.bfloat16) * 0.05)(S)), 'w_out': _w((lambda *s: torch.randn(*s, dtype=torch.bfloat16) * 0.05)(Fh, D))}
    _B_in = _B_setup()
    return {'A_x': _A_in['x'], 'A_c_kv': _A_in['c_kv'], 'A_w_q': _A_in['w_q'], 'A_w_uk': _A_in['w_uk'], 'A_w_uv': _A_in['w_uv'], 'A_w_o': _A_in['w_o'], 'B_x': _B_in['x'], 'B_w_in': _B_in['w_in'], 'B_w_sp': _B_in['w_sp'], 'B_b_sp': _B_in['b_sp'], 'B_w_out': _B_in['w_out'], 'c': _w((lambda *s: torch.randn(*s, dtype=torch.bfloat16) * 0.1)(1, 512) * 8.0), 'w_mod': _w((lambda *s: torch.randn(*s, dtype=torch.bfloat16) * 0.1)(512, 6 * 512) * 512 ** (-0.5) * 8.0)}

def reference(A_x, A_c_kv, A_w_q, A_w_uk, A_w_uv, A_w_o, B_x, B_w_in, B_w_sp, B_b_sp, B_w_out, c, w_mod):

    def _A_ref(x, c_kv, w_q, w_uk, w_uv, w_o):
        B, Sq, M = (x.shape[0], x.shape[1], x.shape[2])
        Sk = c_kv.shape[1]
        H, D = (w_q.shape[1], w_q.shape[2])
        q = torch.einsum('bqm,mhd->bhqd', x, w_q)
        k = torch.einsum('bkc,chd->bhkd', c_kv, w_uk)
        v = torch.einsum('bkc,chd->bhkd', c_kv, w_uv)
        scores = torch.einsum('bhqd,bhkd->bhqk', q, k) * D ** (-0.5)
        off = Sk - Sq
        qi = torch.arange(Sq)[:, None]
        kj = torch.arange(Sk)[None, :]
        cmask = kj <= qi + off
        scores = torch.where(cmask[None, None], scores, -1000000000.0)
        p = _softmax(scores, axis=-1)
        ctx = torch.einsum('bhqk,bhkd->bhqd', p, v)
        return torch.einsum('bhqd,hdm->bqm', ctx, w_o)

    def _B_ref(x, w_in, w_sp, b_sp, w_out):
        B, S, D = x.shape
        F = w_in.shape[-1]
        Fh = F // 2
        z = _gelu(torch.einsum('bsd,df->bsf', x, w_in))
        z1 = z[..., :Fh].clone()
        z2 = _layernorm(z[..., Fh:], axis=-1)
        g = torch.einsum('ts,bsf->btf', w_sp, z2) + b_sp[None, :, None]
        return torch.einsum('bsf,fd->bsd', z1 * g, w_out)
    x = A_x
    mod = (_silu(c) @ w_mod).reshape(c.shape[0], 6, 1, -1)
    sa, ca, ga, sb, cb, gb = (mod[:, 0].clone(), mod[:, 1].clone(), mod[:, 2].clone(), mod[:, 3].clone(), mod[:, 4].clone(), mod[:, 5].clone())
    h = _layernorm(x, axis=-1) * (1 + ca) + sa
    x = x + ga * _A_ref(h, A_c_kv, A_w_q, A_w_uk, A_w_uv, A_w_o)
    h = _layernorm(x, axis=-1) * (1 + cb) + sb
    x = x + gb * _B_ref(h, B_w_in, B_w_sp, B_b_sp, B_w_out)
    return x
```

```asm
; @launch kernel=kva_kernel grid=(256,1,1) block=(512,1,1) lds=163840
.amdgcn_target "amdgcn-amd-amdhsa--gfx950"
.text
.globl kva_kernel
.p2align 8
.type kva_kernel,@function
kva_kernel:
    s_cmp_ge_u32 s2, 256
    s_cbranch_scc1 L_kva_end
    s_load_dwordx16 s[64:79], s[0:1], 0
    s_load_dwordx16 s[80:95], s[0:1], 64
    s_getpc_b64 s[24:25]
L_kva_pc:
    s_sub_u32 s24, s24, L_kva_pc-kva_kernel
    s_subb_u32 s25, s25, 0
    s_mov_b32 s26, L_kva_last-kva_kernel
    s_mov_b32 s27, 0x00020000
    s_lshr_b32 s4, s2, 3
    s_and_b32 s4, s4, 7
    s_lshl_b32 s4, s4, 13
    v_subrev_u32 v1, 448, v0
    v_lshlrev_b32 v1, 7, v1
    v_cmp_gt_u32 vcc, 0x2000, v1
    v_mov_b32 v2, 0x7f000000
    s_nop 0
    v_cndmask_b32 v1, v2, v1, vcc
    buffer_load_dword v255, v1, s[24:27], s4 offen
    v_mov_b32 v9, v0
    v_lshrrev_b32 v1, 6, v0
    v_and_b32 v0, 63, v0
    s_nop 0
    v_readfirstlane_b32 s20, v1
    s_and_b32 s4, s2, 7
    s_lshr_b32 s5, s2, 3
    s_and_b32 s6, s5, 3
    s_lshl_b32 s4, s4, 2
    s_add_u32 s16, s6, s4
    s_lshr_b32 s17, s5, 2
    s_lshr_b32 s46, s20, 2
    s_and_b32 s50, s20, 3
    s_lshr_b32 s18, s20, 1
    s_and_b32 s19, s20, 1
    s_mul_i32 s45, s6, 0
    s_mul_i32 s4, s17, 0
    s_add_u32 s45, s45, s4
    s_and_b32 s45, s45, 7
    s_lshl_b32 s45, s45, 7
    s_sub_u32 s45, s45, 128
    s_mul_i32 s47, s6, 2
    s_mul_i32 s4, s17, 1
    s_add_u32 s47, s47, s4
    s_and_b32 s47, s47, 7
    s_lshl_b32 s47, s47, 7
    s_sub_u32 s47, s47, 128
    s_lshr_b32 s4, s2, 5
    s_lshl_b32 s4, s4, 3
    s_and_b32 s5, s2, 7
    s_add_u32 s4, s4, s5
    s_lshl_b32 s4, s4, 2
    s_add_u32 s43, s4, s6
    s_lshl_b32 s41, s16, 3
    s_add_u32 s41, s41, s17
    s_lshl_b32 s3, s20, 10
    s_sub_u32 s44, 7, s17
    s_lshl_b32 s44, s44, 18
    s_lshl_b32 s4, s20, 13
    s_add_u32 s44, s44, s4
    s_lshl_b32 s48, s20, 15
    s_lshl_b32 s4, s16, 8
    s_add_u32 s48, s48, s4
    v_and_b32 v2, 31, v0
    v_lshrrev_b32 v3, 5, v0
    v_lshrrev_b32 v4, 3, v0
    v_and_b32 v5, 7, v0
    v_lshrrev_b32 v6, 4, v0
    s_lshl_b32 s4, s19, 2
    v_or_b32 v7, s4, v6
    v_xor_b32 v5, v5, v7
    v_lshlrev_b32 v4, 10, v4
    v_lshl_add_u32 v10, v5, 4, v4
    v_bfe_u32 v7, v0, 2, 2
    v_xor_b32 v7, v7, v6
    v_and_b32 v5, 3, v0
    v_lshlrev_b32 v4, 13, v6
    v_lshl_add_u32 v4, v7, 6, v4
    v_lshl_add_u32 v11, v5, 4, v4
    v_lshlrev_b32 v12, 4, v0
    s_waitcnt lgkmcnt(0)
    s_add_u32 s56, s94, 0x0
    s_addc_u32 s57, s95, 0
    s_mov_b32 s58, 0xa0000
    s_mov_b32 s59, 0x00020000
    s_lshl_b32 s40, s41, 7
    s_add_u32 s40, s40, 0x10000
    v_lshlrev_b32 v4, 7, v9
    v_mov_b32 v5, 0
    s_cmp_eq_u32 s2, 0
    s_cselect_b32 s4, 0, 0x7f000000
    s_add_u32 s4, s4, 0x10000
    buffer_store_dword v5, v4, s[56:59], s4 offen sc1
    s_mov_b32 s32, s66
    s_mov_b32 s33, s67
    s_mov_b32 s34, 0x200000
    s_mov_b32 s35, 0x00020000
    s_mov_b32 s36, s70
    s_mov_b32 s37, s71
    s_mov_b32 s38, 0x400000
    s_mov_b32 s39, 0x00020000
    s_mov_b32 s12, s72
    s_mov_b32 s13, s73
    s_mov_b32 s14, 0x400000
    s_mov_b32 s15, 0x00020000
    s_add_u32 m0, s3, 98304
    s_add_u32 s4, s44, 0
    buffer_load_dwordx4 v10, s[32:35], s4 offen lds
    s_add_u32 m0, s3, 106496
    s_add_u32 s4, s44, 65536
    buffer_load_dwordx4 v10, s[32:35], s4 offen lds
    s_add_u32 m0, s3, 114688
    s_add_u32 s4, s44, 131072
    buffer_load_dwordx4 v10, s[32:35], s4 offen lds
    s_add_u32 m0, s3, 122880
    s_add_u32 s4, s44, 196608
    buffer_load_dwordx4 v10, s[32:35], s4 offen lds
    s_add_u32 m0, s3, 32768
    s_add_u32 s4, s48, 0
    buffer_load_dwordx4 v11, s[36:39], s4 offen lds
    s_add_u32 m0, s3, 40960
    s_add_u32 s4, s48, 0
    buffer_load_dwordx4 v11, s[12:15], s4 offen lds
    s_mov_b32 s24, s86
    s_mov_b32 s25, s87
    s_mov_b32 s26, 0x400
    s_mov_b32 s27, 0x00020000
    s_mov_b32 s28, s88
    s_mov_b32 s29, s89
    s_mov_b32 s30, 0x300000
    s_mov_b32 s31, 0x00020000
    s_mov_b32 s60, s64
    s_mov_b32 s61, s65
    s_mov_b32 s62, 0x200000
    s_mov_b32 s63, 0x00020000
    v_lshlrev_b32 v4, 1, v9
    buffer_load_ushort v208, v4, s[24:27], 0 offen
    s_mov_b32 s4, 6144
    v_mul_lo_u32 v4, v9, s4
    s_lshl_b32 s4, s43, 5
    buffer_load_dwordx4 v[210:213], v4, s[28:31], s4 offen
    buffer_load_dwordx4 v[214:217], v4, s[28:31], s4 offen offset:16
    v_and_b32 v5, 7, v0
    v_lshrrev_b32 v6, 3, v0
    v_lshlrev_b32 v4, 10, v5
    v_lshl_add_u32 v4, v6, 4, v4
    s_lshl_b32 s4, s41, 13
    s_lshl_b32 s5, s20, 7
    s_add_u32 s4, s4, s5
    buffer_load_dwordx4 v[234:237], v4, s[60:63], s4 offen
    s_and_b32 s4, s2, 7
    s_lshl_b32 s4, s4, 5
    s_lshr_b32 s5, s2, 3
    s_add_u32 s4, s4, s5
    s_lshl_b32 s4, s4, 11
    s_add_u32 s4, s4, 0x20000
    v_lshlrev_b32 v4, 4, v9
    v_mov_b32 v8, 0x7f000000
    v_cmp_gt_u32 vcc, 128, v9
    v_mov_b32 v6, 0
    v_mov_b32 v7, 0
    v_cndmask_b32 v8, v8, v4, vcc
    s_getreg_b32 s5, hwreg(HW_REG_XCC_ID, 0, 4)
    v_mov_b32 v5, s5
    v_cmp_eq_u32 vcc, 24, v9
    s_nop 1
    v_cndmask_b32 v4, 0, v5, vcc
    v_mov_b32 v5, 0
    buffer_store_dwordx4 v[4:7], v8, s[56:59], s4 offen sc1
    s_add_u32 m0, s3, 49152
    s_add_u32 s4, s48, 262144
    buffer_load_dwordx4 v11, s[36:39], s4 offen lds
    s_add_u32 m0, s3, 57344
    s_add_u32 s4, s48, 262144
    buffer_load_dwordx4 v11, s[12:15], s4 offen lds
    s_add_u32 m0, s3, 0
    s_add_u32 s4, s44, 128
    buffer_load_dwordx4 v10, s[32:35], s4 offen lds
    s_add_u32 m0, s3, 8192
    s_add_u32 s4, s44, 65664
    buffer_load_dwordx4 v10, s[32:35], s4 offen lds
    s_add_u32 m0, s3, 16384
    s_add_u32 s4, s44, 131200
    buffer_load_dwordx4 v10, s[32:35], s4 offen lds
    s_add_u32 m0, s3, 24576
    s_add_u32 s4, s44, 196736
    buffer_load_dwordx4 v10, s[32:35], s4 offen lds
    s_add_u32 m0, s3, 131072
    s_add_u32 s4, s48, 524288
    buffer_load_dwordx4 v11, s[36:39], s4 offen lds
    s_add_u32 m0, s3, 139264
    s_add_u32 s4, s48, 524288
    buffer_load_dwordx4 v11, s[12:15], s4 offen lds
    s_add_u32 m0, s3, 65536
    s_add_u32 s4, s44, 256
    buffer_load_dwordx4 v10, s[32:35], s4 offen lds
    s_add_u32 m0, s3, 73728
    s_add_u32 s4, s44, 65792
    buffer_load_dwordx4 v10, s[32:35], s4 offen lds
    s_add_u32 m0, s3, 81920
    s_add_u32 s4, s44, 131328
    buffer_load_dwordx4 v10, s[32:35], s4 offen lds
    s_add_u32 m0, s3, 90112
    s_add_u32 s4, s44, 196864
    buffer_load_dwordx4 v10, s[32:35], s4 offen lds
    s_add_u32 s8, s94, 0x1400000
    s_addc_u32 s9, s95, 0
    s_mov_b32 s10, 0x6c00000
    s_mov_b32 s11, 0x00020000
    s_add_u32 s52, s94, 0x5800000
    s_addc_u32 s53, s95, 0
    s_mov_b32 s54, 0x200000
    s_mov_b32 s55, 0x00020000
    s_mov_b32 s60, s92
    s_mov_b32 s61, s93
    s_mov_b32 s62, 0x100
    s_mov_b32 s63, 0x00020000
    v_bfe_u32 v6, v0, 1, 3
    v_xor_b32 v6, v6, v3
    s_lshl_b32 s4, s18, 13
    s_add_u32 s4, s4, 98304
    v_lshlrev_b32 v7, 7, v2
    v_add_u32 v7, s4, v7
    v_xor_b32 v8, 0, v6
    v_lshl_add_u32 v16, v8, 4, v7
    v_xor_b32 v8, 2, v6
    v_lshl_add_u32 v17, v8, 4, v7
    v_xor_b32 v8, 4, v6
    v_lshl_add_u32 v18, v8, 4, v7
    v_xor_b32 v8, 6, v6
    v_lshl_add_u32 v19, v8, 4, v7
    v_bfe_u32 v6, v0, 2, 2
    v_lshl_add_u32 v8, v3, 3, v6
    v_lshlrev_b32 v8, 8, v8
    v_bfe_u32 v7, v0, 4, 1
    v_lshl_add_u32 v8, v7, 5, v8
    v_and_b32 v7, 1, v0
    v_lshl_add_u32 v8, v7, 4, v8
    v_bfe_u32 v7, v0, 1, 1
    v_lshl_add_u32 v8, v7, 3, v8
    s_lshl_b32 s4, s19, 1
    s_add_u32 s5, s4, 0
    v_xor_b32 v7, s5, v6
    v_lshl_add_u32 v20, v7, 6, v8
    v_add_u32 v20, 32768, v20
    s_add_u32 s5, s4, 1
    v_xor_b32 v7, s5, v6
    v_lshl_add_u32 v21, v7, 6, v8
    v_add_u32 v21, 32768, v21
    s_lshl_b32 s21, s16, 19
    s_sub_u32 s4, 7, s17
    s_lshl_b32 s4, s4, 16
    s_add_u32 s4, s4, s21
    s_lshl_b32 s5, s18, 14
    s_add_u32 s4, s4, s5
    s_lshl_b32 s5, s19, 12
    s_add_u32 s22, s4, s5
    s_lshl_b32 s5, s19, 11
    s_add_u32 s23, s4, s5
    s_sub_u32 s4, 15, s17
    s_cmp_eq_u32 s46, 0
    s_cselect_b32 s30, s4, s17
    s_lshl_b32 s31, s30, 2
    s_add_u32 s31, s31, s50
    s_lshl_b32 s31, s31, 15
    s_cmp_eq_u32 s20, 0
    s_cselect_b32 s42, 0, 0x7f000000
    s_add_u32 s42, s42, 0x10000
    s_lshl_b32 s21, s50, 12
    s_lshl_b32 s4, s46, 14
    s_add_u32 s21, s21, s4
    s_waitcnt vmcnt(17)
    s_barrier
    ds_read_b128 v[160:163], v16 offset:0
    ds_read_b128 v[164:167], v16 offset:4096
    ds_read_b64_tr_b16 v[168:169], v20 offset:0
    ds_read_b64_tr_b16 v[170:171], v20 offset:1024
    ds_read_b64_tr_b16 v[172:173], v21 offset:0
    ds_read_b64_tr_b16 v[174:175], v21 offset:1024
    ds_read_b64_tr_b16 v[184:185], v20 offset:8192
    ds_read_b64_tr_b16 v[186:187], v20 offset:9216
    ds_read_b64_tr_b16 v[188:189], v21 offset:8192
    ds_read_b64_tr_b16 v[190:191], v21 offset:9216
    s_waitcnt lgkmcnt(4)
    v_mfma_f32_32x32x16_bf16 v[32:47], v[168:171], v[160:163], 0
    v_mov_b32 v4, 1
    v_mov_b32 v5, 0x7f000000
    v_cmp_eq_u32 vcc, 0x0, v9
    s_cmp_eq_u32 s2, 0
    s_cselect_b32 s4, 0, 0x7f000000
    v_cndmask_b32 v5, v5, 0, vcc
    buffer_store_dword v4, v5, s[60:63], s4 offen sc1
    v_mfma_f32_32x32x16_bf16 v[48:63], v[172:175], v[160:163], 0
    v_mfma_f32_32x32x16_bf16 v[64:79], v[168:171], v[164:167], 0
    v_mfma_f32_32x32x16_bf16 v[80:95], v[172:175], v[164:167], 0
    ds_read_b128 v[176:179], v17 offset:0
    ds_read_b128 v[180:183], v17 offset:4096
    ds_read_b64_tr_b16 v[168:169], v20 offset:4096
    ds_read_b64_tr_b16 v[170:171], v20 offset:5120
    ds_read_b64_tr_b16 v[172:173], v21 offset:4096
    ds_read_b64_tr_b16 v[174:175], v21 offset:5120
    s_waitcnt lgkmcnt(6)
    v_mfma_f32_32x32x16_bf16 v[96:111], v[160:163], v[184:187], 0
    v_mfma_f32_32x32x16_bf16 v[112:127], v[160:163], v[188:191], 0
    v_mfma_f32_32x32x16_bf16 v[128:143], v[164:167], v[184:187], 0
    v_mfma_f32_32x32x16_bf16 v[144:159], v[164:167], v[188:191], 0
    ds_read_b64_tr_b16 v[184:185], v20 offset:12288
    ds_read_b64_tr_b16 v[186:187], v20 offset:13312
    ds_read_b64_tr_b16 v[188:189], v21 offset:12288
    ds_read_b64_tr_b16 v[190:191], v21 offset:13312
    s_waitcnt lgkmcnt(4)
    v_mfma_f32_32x32x16_bf16 v[32:47], v[168:171], v[176:179], v[32:47]
    v_mfma_f32_32x32x16_bf16 v[48:63], v[172:175], v[176:179], v[48:63]
    v_mfma_f32_32x32x16_bf16 v[64:79], v[168:171], v[180:183], v[64:79]
    v_mfma_f32_32x32x16_bf16 v[80:95], v[172:175], v[180:183], v[80:95]
    s_waitcnt lgkmcnt(0)
    v_mfma_f32_32x32x16_bf16 v[96:111], v[176:179], v[184:187], v[96:111]
    s_waitcnt vmcnt(11)
    s_barrier
    v_add_u32 v20, 0x4000, v20
    v_add_u32 v21, 0x4000, v21
    ds_read_b128 v[160:163], v18 offset:0
    ds_read_b128 v[164:167], v18 offset:4096
    ds_read_b64_tr_b16 v[168:169], v20 offset:0
    ds_read_b64_tr_b16 v[170:171], v20 offset:1024
    ds_read_b64_tr_b16 v[172:173], v21 offset:0
    ds_read_b64_tr_b16 v[174:175], v21 offset:1024
    v_mfma_f32_32x32x16_bf16 v[112:127], v[176:179], v[188:191], v[112:127]
    s_add_u32 m0, s3, 32768
    s_add_u32 s4, s48, 786432
    buffer_load_dwordx4 v11, s[36:39], s4 offen lds
    v_mfma_f32_32x32x16_bf16 v[128:143], v[180:183], v[184:187], v[128:143]
    s_add_u32 m0, s3, 40960
    s_add_u32 s4, s48, 786432
    buffer_load_dwordx4 v11, s[12:15], s4 offen lds
    v_mfma_f32_32x32x16_bf16 v[144:159], v[180:183], v[188:191], v[144:159]
    ds_read_b64_tr_b16 v[184:185], v20 offset:8192
    ds_read_b64_tr_b16 v[186:187], v20 offset:9216
    ds_read_b64_tr_b16 v[188:189], v21 offset:8192
    ds_read_b64_tr_b16 v[190:191], v21 offset:9216
    s_waitcnt lgkmcnt(4)
    v_mfma_f32_32x32x16_bf16 v[32:47], v[168:171], v[160:163], v[32:47]
    s_waitcnt vmcnt(16)
    v_lshlrev_b32 v208, 16, v208
    v_mul_f32 v209, 0xbfb8aa3b, v208
    v_exp_f32 v209, v209
    v_lshlrev_b32 v218, 16, v210
    v_and_b32 v219, 0xffff0000, v210
    v_mfma_f32_32x32x16_bf16 v[48:63], v[172:175], v[160:163], v[48:63]
    v_add_f32 v209, 1.0, v209
    v_rcp_f32 v209, v209
    v_lshlrev_b32 v220, 16, v211
    v_and_b32 v221, 0xffff0000, v211
    v_mul_f32 v208, v208, v209
    v_cvt_pk_bf16_f32 v208, v208, v208
    v_mfma_f32_32x32x16_bf16 v[64:79], v[168:171], v[164:167], v[64:79]
    v_lshlrev_b32 v208, 16, v208
    v_lshlrev_b32 v222, 16, v212
    v_and_b32 v223, 0xffff0000, v212
    v_lshlrev_b32 v224, 16, v213
    v_and_b32 v225, 0xffff0000, v213
    v_lshlrev_b32 v226, 16, v214
    v_mfma_f32_32x32x16_bf16 v[80:95], v[172:175], v[164:167], v[80:95]
    v_and_b32 v227, 0xffff0000, v214
    v_lshlrev_b32 v228, 16, v215
    v_and_b32 v229, 0xffff0000, v215
    v_lshlrev_b32 v230, 16, v216
    v_and_b32 v231, 0xffff0000, v216
    v_lshlrev_b32 v232, 16, v217
    ds_read_b128 v[176:179], v19 offset:0
    ds_read_b128 v[180:183], v19 offset:4096
    ds_read_b64_tr_b16 v[168:169], v20 offset:4096
    ds_read_b64_tr_b16 v[170:171], v20 offset:5120
    ds_read_b64_tr_b16 v[172:173], v21 offset:4096
    ds_read_b64_tr_b16 v[174:175], v21 offset:5120
    s_waitcnt lgkmcnt(6)
    v_mfma_f32_32x32x16_bf16 v[96:111], v[160:163], v[184:187], v[96:111]
    v_and_b32 v233, 0xffff0000, v217
    v_mul_f32 v218, v218, v208
    v_mul_f32 v219, v219, v208
    v_mul_f32 v220, v220, v208
    v_mul_f32 v221, v221, v208
    v_mul_f32 v222, v222, v208
    v_mfma_f32_32x32x16_bf16 v[112:127], v[160:163], v[188:191], v[112:127]
    v_mul_f32 v223, v223, v208
    v_mul_f32 v224, v224, v208
    v_mul_f32 v225, v225, v208
    v_mul_f32 v226, v226, v208
    v_mul_f32 v227, v227, v208
    v_mul_f32 v228, v228, v208
    v_mfma_f32_32x32x16_bf16 v[128:143], v[164:167], v[184:187], v[128:143]
    v_mul_f32 v229, v229, v208
    v_mul_f32 v230, v230, v208
    v_mul_f32 v231, v231, v208
    v_mul_f32 v232, v232, v208
    v_mul_f32 v233, v233, v208
    v_add_f32_dpp v218, v218, v218 row_shr:1 bound_ctrl:0
    v_mfma_f32_32x32x16_bf16 v[144:159], v[164:167], v[188:191], v[144:159]
    v_add_f32_dpp v219, v219, v219 row_shr:1 bound_ctrl:0
    v_add_f32_dpp v220, v220, v220 row_shr:1 bound_ctrl:0
    v_add_f32_dpp v221, v221, v221 row_shr:1 bound_ctrl:0
    v_add_f32_dpp v222, v222, v222 row_shr:1 bound_ctrl:0
    v_add_f32_dpp v223, v223, v223 row_shr:1 bound_ctrl:0
    v_add_f32_dpp v224, v224, v224 row_shr:1 bound_ctrl:0
    ds_read_b64_tr_b16 v[184:185], v20 offset:12288
    ds_read_b64_tr_b16 v[186:187], v20 offset:13312
    ds_read_b64_tr_b16 v[188:189], v21 offset:12288
    ds_read_b64_tr_b16 v[190:191], v21 offset:13312
    s_waitcnt lgkmcnt(4)
    v_mfma_f32_32x32x16_bf16 v[32:47], v[168:171], v[176:179], v[32:47]
    v_add_f32_dpp v225, v225, v225 row_shr:1 bound_ctrl:0
    v_add_f32_dpp v226, v226, v226 row_shr:1 bound_ctrl:0
    v_add_f32_dpp v227, v227, v227 row_shr:1 bound_ctrl:0
    v_add_f32_dpp v228, v228, v228 row_shr:1 bound_ctrl:0
    v_add_f32_dpp v229, v229, v229 row_shr:1 bound_ctrl:0
    v_add_f32_dpp v230, v230, v230 row_shr:1 bound_ctrl:0
    v_mfma_f32_32x32x16_bf16 v[48:63], v[172:175], v[176:179], v[48:63]
    v_add_f32_dpp v231, v231, v231 row_shr:1 bound_ctrl:0
    v_add_f32_dpp v232, v232, v232 row_shr:1 bound_ctrl:0
    v_add_f32_dpp v233, v233, v233 row_shr:1 bound_ctrl:0
    v_add_f32_dpp v218, v218, v218 row_shr:2 bound_ctrl:0
    v_add_f32_dpp v219, v219, v219 row_shr:2 bound_ctrl:0
    v_add_f32_dpp v220, v220, v220 row_shr:2 bound_ctrl:0
    v_mfma_f32_32x32x16_bf16 v[64:79], v[168:171], v[180:183], v[64:79]
    v_add_f32_dpp v221, v221, v221 row_shr:2 bound_ctrl:0
    v_add_f32_dpp v222, v222, v222 row_shr:2 bound_ctrl:0
    v_add_f32_dpp v223, v223, v223 row_shr:2 bound_ctrl:0
    v_add_f32_dpp v224, v224, v224 row_shr:2 bound_ctrl:0
    v_add_f32_dpp v225, v225, v225 row_shr:2 bound_ctrl:0
    v_add_f32_dpp v226, v226, v226 row_shr:2 bound_ctrl:0
    v_mfma_f32_32x32x16_bf16 v[80:95], v[172:175], v[180:183], v[80:95]
    v_add_f32_dpp v227, v227, v227 row_shr:2 bound_ctrl:0
    v_add_f32_dpp v228, v228, v228 row_shr:2 bound_ctrl:0
    v_add_f32_dpp v229, v229, v229 row_shr:2 bound_ctrl:0
    v_add_f32_dpp v230, v230, v230 row_shr:2 bound_ctrl:0
    v_add_f32_dpp v231, v231, v231 row_shr:2 bound_ctrl:0
    v_add_f32_dpp v232, v232, v232 row_shr:2 bound_ctrl:0
    s_waitcnt lgkmcnt(0)
    v_mfma_f32_32x32x16_bf16 v[96:111], v[176:179], v[184:187], v[96:111]
    s_waitcnt vmcnt(7)
    s_barrier
    v_add_u32 v16, 0xfffe8000, v16
    v_add_u32 v17, 0xfffe8000, v17
    v_add_u32 v18, 0xfffe8000, v18
    v_add_u32 v19, 0xfffe8000, v19
    v_add_u32 v20, 0x14000, v20
    v_add_u32 v21, 0x14000, v21
    ds_read_b128 v[160:163], v16 offset:0
    ds_read_b128 v[164:167], v16 offset:4096
    ds_read_b64_tr_b16 v[168:169], v20 offset:0
    ds_read_b64_tr_b16 v[170:171], v20 offset:1024
    ds_read_b64_tr_b16 v[172:173], v21 offset:0
    ds_read_b64_tr_b16 v[174:175], v21 offset:1024
    v_mfma_f32_32x32x16_bf16 v[112:127], v[176:179], v[188:191], v[112:127]
    s_add_u32 m0, s3, 49152
    s_add_u32 s4, s48, 1048576
    buffer_load_dwordx4 v11, s[36:39], s4 offen lds
    v_add_f32_dpp v233, v233, v233 row_shr:2 bound_ctrl:0
    v_add_f32_dpp v218, v218, v218 row_shr:4 bound_ctrl:0
    v_add_f32_dpp v219, v219, v219 row_shr:4 bound_ctrl:0
    v_add_f32_dpp v220, v220, v220 row_shr:4 bound_ctrl:0
    v_add_f32_dpp v221, v221, v221 row_shr:4 bound_ctrl:0
    v_add_f32_dpp v222, v222, v222 row_shr:4 bound_ctrl:0
    v_add_f32_dpp v223, v223, v223 row_shr:4 bound_ctrl:0
    v_add_f32_dpp v224, v224, v224 row_shr:4 bound_ctrl:0
    v_mfma_f32_32x32x16_bf16 v[128:143], v[180:183], v[184:187], v[128:143]
    s_add_u32 m0, s3, 57344
    s_add_u32 s4, s48, 1048576
    buffer_load_dwordx4 v11, s[12:15], s4 offen lds
    v_add_f32_dpp v225, v225, v225 row_shr:4 bound_ctrl:0
    v_add_f32_dpp v226, v226, v226 row_shr:4 bound_ctrl:0
    v_add_f32_dpp v227, v227, v227 row_shr:4 bound_ctrl:0
    v_add_f32_dpp v228, v228, v228 row_shr:4 bound_ctrl:0
    v_add_f32_dpp v229, v229, v229 row_shr:4 bound_ctrl:0
    v_add_f32_dpp v230, v230, v230 row_shr:4 bound_ctrl:0
    v_add_f32_dpp v231, v231, v231 row_shr:4 bound_ctrl:0
    v_add_f32_dpp v232, v232, v232 row_shr:4 bound_ctrl:0
    v_mfma_f32_32x32x16_bf16 v[144:159], v[180:183], v[188:191], v[144:159]
    s_add_u32 m0, s3, 98304
    s_add_u32 s4, s44, 384
    buffer_load_dwordx4 v10, s[32:35], s4 offen lds
    v_add_f32_dpp v233, v233, v233 row_shr:4 bound_ctrl:0
    v_add_f32_dpp v218, v218, v218 row_shr:8 bound_ctrl:0
    v_add_f32_dpp v219, v219, v219 row_shr:8 bound_ctrl:0
    v_add_f32_dpp v220, v220, v220 row_shr:8 bound_ctrl:0
    v_add_f32_dpp v221, v221, v221 row_shr:8 bound_ctrl:0
    v_add_f32_dpp v222, v222, v222 row_shr:8 bound_ctrl:0
    v_add_f32_dpp v223, v223, v223 row_shr:8 bound_ctrl:0
    v_add_f32_dpp v224, v224, v224 row_shr:8 bound_ctrl:0
    ds_read_b64_tr_b16 v[184:185], v20 offset:8192
    ds_read_b64_tr_b16 v[186:187], v20 offset:9216
    ds_read_b64_tr_b16 v[188:189], v21 offset:8192
    ds_read_b64_tr_b16 v[190:191], v21 offset:9216
    s_waitcnt lgkmcnt(4)
    v_mfma_f32_32x32x16_bf16 v[32:47], v[168:171], v[160:163], v[32:47]
    s_add_u32 m0, s3, 106496
    s_add_u32 s4, s44, 65920
    buffer_load_dwordx4 v10, s[32:35], s4 offen lds
    v_add_f32_dpp v225, v225, v225 row_shr:8 bound_ctrl:0
    v_add_f32_dpp v226, v226, v226 row_shr:8 bound_ctrl:0
    v_add_f32_dpp v227, v227, v227 row_shr:8 bound_ctrl:0
    v_add_f32_dpp v228, v228, v228 row_shr:8 bound_ctrl:0
    v_add_f32_dpp v229, v229, v229 row_shr:8 bound_ctrl:0
    v_add_f32_dpp v230, v230, v230 row_shr:8 bound_ctrl:0
    v_mfma_f32_32x32x16_bf16 v[48:63], v[172:175], v[160:163], v[48:63]
    v_add_f32_dpp v231, v231, v231 row_shr:8 bound_ctrl:0
    v_add_f32_dpp v232, v232, v232 row_shr:8 bound_ctrl:0
    v_add_f32_dpp v233, v233, v233 row_shr:8 bound_ctrl:0
    v_add_f32_dpp v218, v218, v218 row_bcast:15 row_mask:0xa
    v_add_f32_dpp v219, v219, v219 row_bcast:15 row_mask:0xa
    v_add_f32_dpp v220, v220, v220 row_bcast:15 row_mask:0xa
    v_mfma_f32_32x32x16_bf16 v[64:79], v[168:171], v[164:167], v[64:79]
    v_add_f32_dpp v221, v221, v221 row_bcast:15 row_mask:0xa
    v_add_f32_dpp v222, v222, v222 row_bcast:15 row_mask:0xa
    v_add_f32_dpp v223, v223, v223 row_bcast:15 row_mask:0xa
    v_add_f32_dpp v224, v224, v224 row_bcast:15 row_mask:0xa
    v_add_f32_dpp v225, v225, v225 row_bcast:15 row_mask:0xa
    v_add_f32_dpp v226, v226, v226 row_bcast:15 row_mask:0xa
    v_mfma_f32_32x32x16_bf16 v[80:95], v[172:175], v[164:167], v[80:95]
    v_add_f32_dpp v227, v227, v227 row_bcast:15 row_mask:0xa
    v_add_f32_dpp v228, v228, v228 row_bcast:15 row_mask:0xa
    v_add_f32_dpp v229, v229, v229 row_bcast:15 row_mask:0xa
    v_add_f32_dpp v230, v230, v230 row_bcast:15 row_mask:0xa
    v_add_f32_dpp v231, v231, v231 row_bcast:15 row_mask:0xa
    v_add_f32_dpp v232, v232, v232 row_bcast:15 row_mask:0xa
    ds_read_b128 v[176:179], v17 offset:0
    ds_read_b128 v[180:183], v17 offset:4096
    ds_read_b64_tr_b16 v[168:169], v20 offset:4096
    ds_read_b64_tr_b16 v[170:171], v20 offset:5120
    ds_read_b64_tr_b16 v[172:173], v21 offset:4096
    ds_read_b64_tr_b16 v[174:175], v21 offset:5120
    s_waitcnt lgkmcnt(6)
    v_mfma_f32_32x32x16_bf16 v[96:111], v[160:163], v[184:187], v[96:111]
    v_add_f32_dpp v233, v233, v233 row_bcast:15 row_mask:0xa
    v_add_f32_dpp v218, v218, v218 row_bcast:31 row_mask:0xc
    v_add_f32_dpp v219, v219, v219 row_bcast:31 row_mask:0xc
    v_add_f32_dpp v220, v220, v220 row_bcast:31 row_mask:0xc
    v_add_f32_dpp v221, v221, v221 row_bcast:31 row_mask:0xc
    v_add_f32_dpp v222, v222, v222 row_bcast:31 row_mask:0xc
    v_add_f32_dpp v223, v223, v223 row_bcast:31 row_mask:0xc
    v_mfma_f32_32x32x16_bf16 v[112:127], v[160:163], v[188:191], v[112:127]
    v_add_f32_dpp v224, v224, v224 row_bcast:31 row_mask:0xc
    v_add_f32_dpp v225, v225, v225 row_bcast:31 row_mask:0xc
    v_add_f32_dpp v226, v226, v226 row_bcast:31 row_mask:0xc
    v_add_f32_dpp v227, v227, v227 row_bcast:31 row_mask:0xc
    v_add_f32_dpp v228, v228, v228 row_bcast:31 row_mask:0xc
    v_add_f32_dpp v229, v229, v229 row_bcast:31 row_mask:0xc
    v_mfma_f32_32x32x16_bf16 v[128:143], v[164:167], v[184:187], v[128:143]
    v_add_f32_dpp v230, v230, v230 row_bcast:31 row_mask:0xc
    v_add_f32_dpp v231, v231, v231 row_bcast:31 row_mask:0xc
    v_add_f32_dpp v232, v232, v232 row_bcast:31 row_mask:0xc
    v_add_f32_dpp v233, v233, v233 row_bcast:31 row_mask:0xc
    s_lshl_b32 s4, s20, 6
    s_add_u32 s4, s4, 147456
    v_mov_b32 v4, 149504
    v_mov_b32 v5, s4
    v_cmp_eq_u32 vcc, 63, v0
    s_nop 1
    v_cndmask_b32 v4, v4, v5, vcc
    ds_write_b128 v4, v[218:221] offset:0
    ds_write_b128 v4, v[222:225] offset:16
    ds_write_b128 v4, v[226:229] offset:32
    ds_write_b128 v4, v[230:233] offset:48
    v_lshlrev_b32 v238, 16, v234
    v_mfma_f32_32x32x16_bf16 v[144:159], v[164:167], v[188:191], v[144:159]
    v_and_b32 v239, 0xffff0000, v234
    v_lshlrev_b32 v240, 16, v235
    v_and_b32 v241, 0xffff0000, v235
    v_lshlrev_b32 v242, 16, v236
    v_and_b32 v243, 0xffff0000, v236
    s_mov_b32 s24, s68
    s_mov_b32 s25, s69
    s_mov_b32 s26, 0x400000
    s_lshl_b32 s4, s17, 19
    s_add_u32 s4, s4, s48
    s_add_u32 s4, s4, 0x0
    buffer_load_dwordx4 v[28:31], v11, s[24:27], s4 offen
    ds_read_b64_tr_b16 v[184:185], v20 offset:12288
    ds_read_b64_tr_b16 v[186:187], v20 offset:13312
    ds_read_b64_tr_b16 v[188:189], v21 offset:12288
    ds_read_b64_tr_b16 v[190:191], v21 offset:13312
    s_waitcnt lgkmcnt(4)
    v_mfma_f32_32x32x16_bf16 v[32:47], v[168:171], v[176:179], v[32:47]
    v_lshlrev_b32 v244, 16, v237
    v_and_b32 v245, 0xffff0000, v237
    v_add_f32 v246, v238, v239
    v_mul_f32 v247, v238, v238
    v_fmac_f32 v247, v239, v239
    v_mfma_f32_32x32x16_bf16 v[48:63], v[172:175], v[176:179], v[48:63]
    v_add_f32 v246, v246, v240
    v_fmac_f32 v247, v240, v240
    v_add_f32 v246, v246, v241
    v_fmac_f32 v247, v241, v241
    v_add_f32 v246, v246, v242
    v_mfma_f32_32x32x16_bf16 v[64:79], v[168:171], v[180:183], v[64:79]
    v_fmac_f32 v247, v242, v242
    v_add_f32 v246, v246, v243
    v_fmac_f32 v247, v243, v243
    v_add_f32 v246, v246, v244
    v_fmac_f32 v247, v244, v244
    v_mfma_f32_32x32x16_bf16 v[80:95], v[172:175], v[180:183], v[80:95]
    v_add_f32 v246, v246, v245
    v_fmac_f32 v247, v245, v245
    s_nop 1
    v_add_f32_dpp v246, v246, v246 row_ror:8
    v_add_f32_dpp v247, v247, v247 row_ror:8
    s_nop 0
    v_mov_b32 v248, v246
    v_mov_b32 v249, v247
    s_nop 1
    v_permlane16_swap_b32 v246, v248
    v_permlane16_swap_b32 v247, v249
    s_nop 1
    v_add_f32 v246, v246, v248
    v_add_f32 v247, v247, v249
    v_mov_b32 v248, v246
    v_mov_b32 v249, v247
    s_nop 1
    v_permlane32_swap_b32 v246, v248
    v_permlane32_swap_b32 v247, v249
    s_nop 1
    v_add_f32 v246, v246, v248
    v_add_f32 v247, v247, v249
    v_and_b32 v4, 7, v0
    v_lshlrev_b32 v4, 6, v4
    v_add_u32 v250, 148480, v4
    s_lshl_b32 s4, s20, 3
    v_add_u32 v4, s4, v250
    ds_write_b64 v4, v[246:247]
    v_mov_b32 v4, 0
    v_cmp_eq_u32 vcc, 0x0, v9
    s_nop 0
    v_lshlrev_b32 v4, 7, v4
    v_mov_b32 v25, 0x7f000000
    v_cndmask_b32 v25, v25, v4, vcc
    v_cndmask_b32 v26, 0, 1, vcc
    buffer_load_dword v24, v25, s[60:63], 0 offen sc1
    s_waitcnt lgkmcnt(0)
    v_mfma_f32_32x32x16_bf16 v[96:111], v[176:179], v[184:187], v[96:111]
    s_waitcnt vmcnt(6)
    s_barrier
    v_add_u32 v20, 0xfffe8000, v20
    v_add_u32 v21, 0xfffe8000, v21
    ds_read_b128 v[160:163], v18 offset:0
    ds_read_b128 v[164:167], v18 offset:4096
    ds_read_b64_tr_b16 v[168:169], v20 offset:0
    ds_read_b64_tr_b16 v[170:171], v20 offset:1024
    ds_read_b64_tr_b16 v[172:173], v21 offset:0
    ds_read_b64_tr_b16 v[174:175], v21 offset:1024
    v_mfma_f32_32x32x16_bf16 v[112:127], v[176:179], v[188:191], v[112:127]
    s_add_u32 m0, s3, 131072
    s_add_u32 s4, s48, 1310720
    buffer_load_dwordx4 v11, s[36:39], s4 offen lds
    v_mfma_f32_32x32x16_bf16 v[128:143], v[180:183], v[184:187], v[128:143]
    s_add_u32 m0, s3, 139264
    s_add_u32 s4, s48, 1310720
    buffer_load_dwordx4 v11, s[12:15], s4 offen lds
    v_mfma_f32_32x32x16_bf16 v[144:159], v[180:183], v[188:191], v[144:159]
    s_add_u32 m0, s3, 114688
    s_add_u32 s4, s44, 131456
    buffer_load_dwordx4 v10, s[32:35], s4 offen lds
    ds_read_b64_tr_b16 v[184:185], v20 offset:8192
    ds_read_b64_tr_b16 v[186:187], v20 offset:9216
    ds_read_b64_tr_b16 v[188:189], v21 offset:8192
    ds_read_b64_tr_b16 v[190:191], v21 offset:9216
    s_waitcnt lgkmcnt(4)
    v_mfma_f32_32x32x16_bf16 v[32:47], v[168:171], v[160:163], v[32:47]
    s_add_u32 m0, s3, 122880
    s_add_u32 s4, s44, 196992
    buffer_load_dwordx4 v10, s[32:35], s4 offen lds
    v_and_b32 v4, 15, v0
    v_lshlrev_b32 v4, 2, v4
    v_add_u32 v5, 147456, v4
    ds_read_b32 v210, v5 offset:0
    ds_read_b32 v211, v5 offset:64
    ds_read_b32 v212, v5 offset:128
    ds_read_b32 v213, v5 offset:192
    ds_read_b32 v214, v5 offset:256
    ds_read_b32 v215, v5 offset:320
    ds_read_b32 v216, v5 offset:384
    ds_read_b32 v217, v5 offset:448
    ds_read_b128 v[218:221], v250 offset:0
    ds_read_b128 v[222:225], v250 offset:16
    ds_read_b128 v[226:229], v250 offset:32
    ds_read_b128 v[230:233], v250 offset:48
    v_mfma_f32_32x32x16_bf16 v[48:63], v[172:175], v[160:163], v[48:63]
    v_mfma_f32_32x32x16_bf16 v[64:79], v[168:171], v[164:167], v[64:79]
    v_mfma_f32_32x32x16_bf16 v[80:95], v[172:175], v[164:167], v[80:95]
    ds_read_b128 v[176:179], v19 offset:0
    ds_read_b128 v[180:183], v19 offset:4096
    ds_read_b64_tr_b16 v[168:169], v20 offset:4096
    ds_read_b64_tr_b16 v[170:171], v20 offset:5120
    ds_read_b64_tr_b16 v[172:173], v21 offset:4096
    ds_read_b64_tr_b16 v[174:175], v21 offset:5120
    s_waitcnt lgkmcnt(6)
    v_mfma_f32_32x32x16_bf16 v[96:111], v[160:163], v[184:187], v[96:111]
    v_add_f32 v210, v210, v211
    v_add_f32 v210, v210, v212
    v_add_f32 v210, v210, v213
    v_add_f32 v210, v210, v214
    v_add_f32 v210, v210, v215
    v_add_f32 v210, v210, v216
    v_mfma_f32_32x32x16_bf16 v[112:127], v[160:163], v[188:191], v[112:127]
    v_add_f32 v210, v210, v217
    v_cvt_pk_bf16_f32 v210, v210, v210
    v_lshlrev_b32 v210, 16, v210
    v_mov_b32 v5, 0x7f000000
    v_subrev_u32 v4, 0x0, v9
    v_cmp_gt_u32 vcc, 16, v4
    v_lshlrev_b32 v4, 2, v4
    s_lshl_b32 s4, s43, 6
    v_cndmask_b32 v5, v5, v4, vcc
    buffer_store_dword v210, v5, s[56:59], s4 offen sc1
    v_add_f32 v218, v218, v220
    v_add_f32 v219, v219, v221
    v_mfma_f32_32x32x16_bf16 v[128:143], v[164:167], v[184:187], v[128:143]
    v_add_f32 v218, v218, v222
    v_add_f32 v219, v219, v223
    v_add_f32 v218, v218, v224
    v_add_f32 v219, v219, v225
    v_add_f32 v218, v218, v226
    v_add_f32 v219, v219, v227
    v_mfma_f32_32x32x16_bf16 v[144:159], v[164:167], v[188:191], v[144:159]
    v_add_f32 v218, v218, v228
    v_add_f32 v219, v219, v229
    v_add_f32 v218, v218, v230
    v_add_f32 v219, v219, v231
    s_mov_b32 s24, s68
    s_mov_b32 s25, s69
    s_mov_b32 s26, 0x400000
    s_lshl_b32 s4, s17, 19
    s_add_u32 s4, s4, s48
    s_add_u32 s4, s4, 0x40000
    buffer_load_dwordx4 v[28:31], v11, s[24:27], s4 offen
    ds_read_b64_tr_b16 v[184:185], v20 offset:12288
    ds_read_b64_tr_b16 v[186:187], v20 offset:13312
    ds_read_b64_tr_b16 v[188:189], v21 offset:12288
    ds_read_b64_tr_b16 v[190:191], v21 offset:13312
    s_waitcnt lgkmcnt(4)
    v_mfma_f32_32x32x16_bf16 v[32:47], v[168:171], v[176:179], v[32:47]
    v_add_f32 v218, v218, v232
    v_add_f32 v219, v219, v233
    v_mul_f32 v218, 0x3b000000, v218
    v_mfma_f32_32x32x16_bf16 v[48:63], v[172:175], v[176:179], v[48:63]
    v_mul_f32 v219, 0x3b000000, v219
    v_fma_f32 v219, -v218, v218, v219
    v_max_f32 v219, 0, v219
    v_mfma_f32_32x32x16_bf16 v[64:79], v[168:171], v[180:183], v[64:79]
    v_add_f32 v219, 0x3727c5ac, v219
    v_rsq_f32 v219, v219
    v_sub_f32 v238, v238, v218
    v_mfma_f32_32x32x16_bf16 v[80:95], v[172:175], v[180:183], v[80:95]
    v_sub_f32 v239, v239, v218
    v_sub_f32 v240, v240, v218
    v_sub_f32 v241, v241, v218
    s_waitcnt lgkmcnt(0)
    v_mfma_f32_32x32x16_bf16 v[96:111], v[176:179], v[184:187], v[96:111]
    s_cmp_lg_u32 s20, 0
    s_cbranch_scc1 L_kva_pl1_b
    s_waitcnt vmcnt(6)
    s_mov_b32 s7, 0x40000
L_kva_pl1_a:
    v_cmp_gt_u32 vcc, v26, v24
    s_sub_u32 s7, s7, 1
    s_nop 2
    s_cbranch_vccz L_kva_pl1_b
    s_cmp_eq_u32 s7, 0
    s_cbranch_scc1 L_kva_pl1_b
    s_sleep 2
    buffer_load_dword v24, v25, s[60:63], 0 offen sc1
    s_waitcnt vmcnt(0)
    s_branch L_kva_pl1_a
L_kva_pl1_b:
    s_waitcnt vmcnt(10)
    s_barrier
    v_add_u32 v16, 0x10000, v16
    v_add_u32 v17, 0x10000, v17
    v_add_u32 v18, 0x10000, v18
    v_add_u32 v19, 0x10000, v19
    v_add_u32 v20, 0x4000, v20
    v_add_u32 v21, 0x4000, v21
    ds_read_b128 v[160:163], v16 offset:0
    ds_read_b128 v[164:167], v16 offset:4096
    ds_read_b64_tr_b16 v[168:169], v20 offset:0
    ds_read_b64_tr_b16 v[170:171], v20 offset:1024
    ds_read_b64_tr_b16 v[172:173], v21 offset:0
    ds_read_b64_tr_b16 v[174:175], v21 offset:1024
    v_mfma_f32_32x32x16_bf16 v[112:127], v[176:179], v[188:191], v[112:127]
    s_add_u32 m0, s3, 32768
    s_add_u32 s4, s48, 1572864
    buffer_load_dwordx4 v11, s[36:39], s4 offen lds
    v_sub_f32 v242, v242, v218
    v_sub_f32 v243, v243, v218
    v_sub_f32 v244, v244, v218
    v_sub_f32 v245, v245, v218
    v_mfma_f32_32x32x16_bf16 v[128:143], v[180:183], v[184:187], v[128:143]
    s_add_u32 m0, s3, 40960
    s_add_u32 s4, s48, 1572864
    buffer_load_dwordx4 v11, s[12:15], s4 offen lds
    v_mul_f32 v238, v238, v219
    v_mul_f32 v239, v239, v219
    v_mul_f32 v240, v240, v219
    v_mul_f32 v241, v241, v219
    v_mfma_f32_32x32x16_bf16 v[144:159], v[180:183], v[188:191], v[144:159]
    s_add_u32 m0, s3, 0
    s_add_u32 s4, s44, 512
    buffer_load_dwordx4 v10, s[32:35], s4 offen lds
    v_mul_f32 v242, v242, v219
    v_mul_f32 v243, v243, v219
    v_mul_f32 v244, v244, v219
    v_mul_f32 v245, v245, v219
    ds_read_b64_tr_b16 v[184:185], v20 offset:8192
    ds_read_b64_tr_b16 v[186:187], v20 offset:9216
    ds_read_b64_tr_b16 v[188:189], v21 offset:8192
    ds_read_b64_tr_b16 v[190:191], v21 offset:9216
    s_waitcnt lgkmcnt(4)
    v_mfma_f32_32x32x16_bf16 v[32:47], v[168:171], v[160:163], v[32:47]
    s_add_u32 m0, s3, 8192
    s_add_u32 s4, s44, 66048
    buffer_load_dwordx4 v10, s[32:35], s4 offen lds
    v_mfma_f32_32x32x16_bf16 v[48:63], v[172:175], v[160:163], v[48:63]
    v_mfma_f32_32x32x16_bf16 v[64:79], v[168:171], v[164:167], v[64:79]
    v_mfma_f32_32x32x16_bf16 v[80:95], v[172:175], v[164:167], v[80:95]
    ds_read_b128 v[176:179], v17 offset:0
    ds_read_b128 v[180:183], v17 offset:4096
    ds_read_b64_tr_b16 v[168:169], v20 offset:4096
    ds_read_b64_tr_b16 v[170:171], v20 offset:5120
    ds_read_b64_tr_b16 v[172:173], v21 offset:4096
    ds_read_b64_tr_b16 v[174:175], v21 offset:5120
    s_waitcnt lgkmcnt(6)
    v_mfma_f32_32x32x16_bf16 v[96:111], v[160:163], v[184:187], v[96:111]
    s_waitcnt vmcnt(5)
    v_mfma_f32_32x32x16_bf16 v[112:127], v[160:163], v[188:191], v[112:127]
    v_mov_b32 v4, 1
    v_mov_b32 v5, 0x7f000000
    v_cmp_eq_u32 vcc, 0x0, v9
    s_nop 1
    v_cndmask_b32 v5, v5, 0, vcc
    buffer_store_dword v4, v5, s[56:59], s40 offen sc1
    v_mfma_f32_32x32x16_bf16 v[128:143], v[164:167], v[184:187], v[128:143]
    v_mfma_f32_32x32x16_bf16 v[144:159], v[164:167], v[188:191], v[144:159]
    ds_read_b64_tr_b16 v[184:185], v20 offset:12288
    ds_read_b64_tr_b16 v[186:187], v20 offset:13312
    ds_read_b64_tr_b16 v[188:189], v21 offset:12288
    ds_read_b64_tr_b16 v[190:191], v21 offset:13312
    s_waitcnt lgkmcnt(4)
    v_mfma_f32_32x32x16_bf16 v[32:47], v[168:171], v[176:179], v[32:47]
    v_mfma_f32_32x32x16_bf16 v[48:63], v[172:175], v[176:179], v[48:63]
    v_mfma_f32_32x32x16_bf16 v[64:79], v[168:171], v[180:183], v[64:79]
    v_mfma_f32_32x32x16_bf16 v[80:95], v[172:175], v[180:183], v[80:95]
    s_waitcnt lgkmcnt(0)
    v_mfma_f32_32x32x16_bf16 v[96:111], v[176:179], v[184:187], v[96:111]
    s_waitcnt vmcnt(9)
    s_barrier
    v_add_u32 v20, 0x14000, v20
    v_add_u32 v21, 0x14000, v21
    ds_read_b128 v[160:163], v18 offset:0
    ds_read_b128 v[164:167], v18 offset:4096
    ds_read_b64_tr_b16 v[168:169], v20 offset:0
    ds_read_b64_tr_b16 v[170:171], v20 offset:1024
    ds_read_b64_tr_b16 v[172:173], v21 offset:0
    ds_read_b64_tr_b16 v[174:175], v21 offset:1024
    v_mfma_f32_32x32x16_bf16 v[112:127], v[176:179], v[188:191], v[112:127]
    s_add_u32 m0, s3, 49152
    s_add_u32 s4, s48, 1835008
    buffer_load_dwordx4 v11, s[36:39], s4 offen lds
    v_mfma_f32_32x32x16_bf16 v[128:143], v[180:183], v[184:187], v[128:143]
    s_add_u32 m0, s3, 57344
    s_add_u32 s4, s48, 1835008
    buffer_load_dwordx4 v11, s[12:15], s4 offen lds
    v_mfma_f32_32x32x16_bf16 v[144:159], v[180:183], v[188:191], v[144:159]
    s_add_u32 m0, s3, 16384
    s_add_u32 s4, s44, 131584
    buffer_load_dwordx4 v10, s[32:35], s4 offen lds
    ds_read_b64_tr_b16 v[184:185], v20 offset:8192
    ds_read_b64_tr_b16 v[186:187], v20 offset:9216
    ds_read_b64_tr_b16 v[188:189], v21 offset:8192
    ds_read_b64_tr_b16 v[190:191], v21 offset:9216
    s_waitcnt lgkmcnt(4)
    v_mfma_f32_32x32x16_bf16 v[32:47], v[168:171], v[160:163], v[32:47]
    s_add_u32 m0, s3, 24576
    s_add_u32 s4, s44, 197120
    buffer_load_dwordx4 v10, s[32:35], s4 offen lds
    v_mfma_f32_32x32x16_bf16 v[48:63], v[172:175], v[160:163], v[48:63]
    v_mfma_f32_32x32x16_bf16 v[64:79], v[168:171], v[164:167], v[64:79]
    v_mfma_f32_32x32x16_bf16 v[80:95], v[172:175], v[164:167], v[80:95]
    ds_read_b128 v[176:179], v19 offset:0
    ds_read_b128 v[180:183], v19 offset:4096
    ds_read_b64_tr_b16 v[168:169], v20 offset:4096
    ds_read_b64_tr_b16 v[170:171], v20 offset:5120
    ds_read_b64_tr_b16 v[172:173], v21 offset:4096
    ds_read_b64_tr_b16 v[174:175], v21 offset:5120
    s_waitcnt lgkmcnt(6)
    v_mfma_f32_32x32x16_bf16 v[96:111], v[160:163], v[184:187], v[96:111]
    v_mfma_f32_32x32x16_bf16 v[112:127], v[160:163], v[188:191], v[112:127]
    v_mfma_f32_32x32x16_bf16 v[128:143], v[164:167], v[184:187], v[128:143]
    v_mfma_f32_32x32x16_bf16 v[144:159], v[164:167], v[188:191], v[144:159]
    ds_read_b64_tr_b16 v[184:185], v20 offset:12288
    ds_read_b64_tr_b16 v[186:187], v20 offset:13312
    ds_read_b64_tr_b16 v[188:189], v21 offset:12288
    ds_read_b64_tr_b16 v[190:191], v21 offset:13312
    s_waitcnt lgkmcnt(4)
    v_mfma_f32_32x32x16_bf16 v[32:47], v[168:171], v[176:179], v[32:47]
    v_mfma_f32_32x32x16_bf16 v[48:63], v[172:175], v[176:179], v[48:63]
    v_mfma_f32_32x32x16_bf16 v[64:79], v[168:171], v[180:183], v[64:79]
    v_mfma_f32_32x32x16_bf16 v[80:95], v[172:175], v[180:183], v[80:95]
    s_waitcnt lgkmcnt(0)
    v_mfma_f32_32x32x16_bf16 v[96:111], v[176:179], v[184:187], v[96:111]
    s_waitcnt vmcnt(7)
    s_barrier
    v_add_u32 v16, 0x8000, v16
    v_add_u32 v17, 0x8000, v17
    v_add_u32 v18, 0x8000, v18
    v_add_u32 v19, 0x8000, v19
    v_add_u32 v20, 0xfffe8000, v20
    v_add_u32 v21, 0xfffe8000, v21
    ds_read_b128 v[160:163], v16 offset:0
    ds_read_b128 v[164:167], v16 offset:4096
    ds_read_b64_tr_b16 v[168:169], v20 offset:0
    ds_read_b64_tr_b16 v[170:171], v20 offset:1024
    ds_read_b64_tr_b16 v[172:173], v21 offset:0
    ds_read_b64_tr_b16 v[174:175], v21 offset:1024
    v_mfma_f32_32x32x16_bf16 v[112:127], v[176:179], v[188:191], v[112:127]
    s_add_u32 m0, s3, 131072
    s_add_u32 s4, s48, 2097152
    buffer_load_dwordx4 v11, s[36:39], s4 offen lds
    v_mfma_f32_32x32x16_bf16 v[128:143], v[180:183], v[184:187], v[128:143]
    s_add_u32 m0, s3, 139264
    s_add_u32 s4, s48, 2097152
    buffer_load_dwordx4 v11, s[12:15], s4 offen lds
    v_mfma_f32_32x32x16_bf16 v[144:159], v[180:183], v[188:191], v[144:159]
    s_add_u32 m0, s3, 65536
    s_add_u32 s4, s44, 640
    buffer_load_dwordx4 v10, s[32:35], s4 offen lds
    ds_read_b64_tr_b16 v[184:185], v20 offset:8192
    ds_read_b64_tr_b16 v[186:187], v20 offset:9216
    ds_read_b64_tr_b16 v[188:189], v21 offset:8192
    ds_read_b64_tr_b16 v[190:191], v21 offset:9216
    s_waitcnt lgkmcnt(4)
    v_mfma_f32_32x32x16_bf16 v[32:47], v[168:171], v[160:163], v[32:47]
    s_add_u32 m0, s3, 73728
    s_add_u32 s4, s44, 66176
    buffer_load_dwordx4 v10, s[32:35], s4 offen lds
    v_mfma_f32_32x32x16_bf16 v[48:63], v[172:175], v[160:163], v[48:63]
    v_mfma_f32_32x32x16_bf16 v[64:79], v[168:171], v[164:167], v[64:79]
    v_mfma_f32_32x32x16_bf16 v[80:95], v[172:175], v[164:167], v[80:95]
    ds_read_b128 v[176:179], v17 offset:0
    ds_read_b128 v[180:183], v17 offset:4096
    ds_read_b64_tr_b16 v[168:169], v20 offset:4096
    ds_read_b64_tr_b16 v[170:171], v20 offset:5120
    ds_read_b64_tr_b16 v[172:173], v21 offset:4096
    ds_read_b64_tr_b16 v[174:175], v21 offset:5120
    s_waitcnt lgkmcnt(6)
    v_mfma_f32_32x32x16_bf16 v[96:111], v[160:163], v[184:187], v[96:111]
    v_mfma_f32_32x32x16_bf16 v[112:127], v[160:163], v[188:191], v[112:127]
    v_mfma_f32_32x32x16_bf16 v[128:143], v[164:167], v[184:187], v[128:143]
    v_mfma_f32_32x32x16_bf16 v[144:159], v[164:167], v[188:191], v[144:159]
    ds_read_b64_tr_b16 v[184:185], v20 offset:12288
    ds_read_b64_tr_b16 v[186:187], v20 offset:13312
    ds_read_b64_tr_b16 v[188:189], v21 offset:12288
    ds_read_b64_tr_b16 v[190:191], v21 offset:13312
    s_waitcnt lgkmcnt(4)
    v_mfma_f32_32x32x16_bf16 v[32:47], v[168:171], v[176:179], v[32:47]
    v_mfma_f32_32x32x16_bf16 v[48:63], v[172:175], v[176:179], v[48:63]
    v_mfma_f32_32x32x16_bf16 v[64:79], v[168:171], v[180:183], v[64:79]
    v_mfma_f32_32x32x16_bf16 v[80:95], v[172:175], v[180:183], v[80:95]
    s_waitcnt lgkmcnt(0)
    v_mfma_f32_32x32x16_bf16 v[96:111], v[176:179], v[184:187], v[96:111]
    s_waitcnt vmcnt(6)
    s_barrier
    v_add_u32 v20, 0x4000, v20
    v_add_u32 v21, 0x4000, v21
    ds_read_b128 v[160:163], v18 offset:0
    ds_read_b128 v[164:167], v18 offset:4096
    ds_read_b64_tr_b16 v[168:169], v20 offset:0
    ds_read_b64_tr_b16 v[170:171], v20 offset:1024
    ds_read_b64_tr_b16 v[172:173], v21 offset:0
    ds_read_b64_tr_b16 v[174:175], v21 offset:1024
    v_mfma_f32_32x32x16_bf16 v[112:127], v[176:179], v[188:191], v[112:127]
    s_add_u32 m0, s3, 32768
    s_add_u32 s4, s48, 2359296
    buffer_load_dwordx4 v11, s[36:39], s4 offen lds
    v_mfma_f32_32x32x16_bf16 v[128:143], v[180:183], v[184:187], v[128:143]
    s_add_u32 m0, s3, 40960
    s_add_u32 s4, s48, 2359296
    buffer_load_dwordx4 v11, s[12:15], s4 offen lds
    v_mfma_f32_32x32x16_bf16 v[144:159], v[180:183], v[188:191], v[144:159]
    s_add_u32 m0, s3, 81920
    s_add_u32 s4, s44, 131712
    buffer_load_dwordx4 v10, s[32:35], s4 offen lds
    ds_read_b64_tr_b16 v[184:185], v20 offset:8192
    ds_read_b64_tr_b16 v[186:187], v20 offset:9216
    ds_read_b64_tr_b16 v[188:189], v21 offset:8192
    ds_read_b64_tr_b16 v[190:191], v21 offset:9216
    s_waitcnt lgkmcnt(4)
    v_mfma_f32_32x32x16_bf16 v[32:47], v[168:171], v[160:163], v[32:47]
    s_add_u32 m0, s3, 90112
    s_add_u32 s4, s44, 197248
    buffer_load_dwordx4 v10, s[32:35], s4 offen lds
    v_mfma_f32_32x32x16_bf16 v[48:63], v[172:175], v[160:163], v[48:63]
    v_mfma_f32_32x32x16_bf16 v[64:79], v[168:171], v[164:167], v[64:79]
    v_mfma_f32_32x32x16_bf16 v[80:95], v[172:175], v[164:167], v[80:95]
    ds_read_b128 v[176:179], v19 offset:0
    ds_read_b128 v[180:183], v19 offset:4096
    ds_read_b64_tr_b16 v[168:169], v20 offset:4096
    ds_read_b64_tr_b16 v[170:171], v20 offset:5120
    ds_read_b64_tr_b16 v[172:173], v21 offset:4096
    ds_read_b64_tr_b16 v[174:175], v21 offset:5120
    s_waitcnt lgkmcnt(6)
    v_mfma_f32_32x32x16_bf16 v[96:111], v[160:163], v[184:187], v[96:111]
    v_mfma_f32_32x32x16_bf16 v[112:127], v[160:163], v[188:191], v[112:127]
    v_mfma_f32_32x32x16_bf16 v[128:143], v[164:167], v[184:187], v[128:143]
    v_mfma_f32_32x32x16_bf16 v[144:159], v[164:167], v[188:191], v[144:159]
    ds_read_b64_tr_b16 v[184:185], v20 offset:12288
    ds_read_b64_tr_b16 v[186:187], v20 offset:13312
    ds_read_b64_tr_b16 v[188:189], v21 offset:12288
    ds_read_b64_tr_b16 v[190:191], v21 offset:13312
    s_waitcnt lgkmcnt(4)
    v_mfma_f32_32x32x16_bf16 v[32:47], v[168:171], v[176:179], v[32:47]
    v_lshrrev_b32 v4, 1, v0
    v_and_b32 v5, 1, v0
    v_lshl_add_u32 v4, v4, 3, v5
    s_mov_b64 vcc, -1
    v_lshlrev_b32 v4, 7, v4
    v_mov_b32 v25, 0x7f000000
    v_cndmask_b32 v25, v25, v4, vcc
    v_cndmask_b32 v26, 0, 1, vcc
    buffer_load_dword v24, v25, s[56:59], s42 offen sc1
    v_mfma_f32_32x32x16_bf16 v[48:63], v[172:175], v[176:179], v[48:63]
    v_mfma_f32_32x32x16_bf16 v[64:79], v[168:171], v[180:183], v[64:79]
    v_mfma_f32_32x32x16_bf16 v[80:95], v[172:175], v[180:183], v[80:95]
    s_waitcnt lgkmcnt(0)
    v_mfma_f32_32x32x16_bf16 v[96:111], v[176:179], v[184:187], v[96:111]
    s_waitcnt vmcnt(7)
    s_barrier
    v_add_u32 v16, 0xfffe8000, v16
    v_add_u32 v17, 0xfffe8000, v17
    v_add_u32 v18, 0xfffe8000, v18
    v_add_u32 v19, 0xfffe8000, v19
    v_add_u32 v20, 0x14000, v20
    v_add_u32 v21, 0x14000, v21
    ds_read_b128 v[160:163], v16 offset:0
    ds_read_b128 v[164:167], v16 offset:4096
    ds_read_b64_tr_b16 v[168:169], v20 offset:0
    ds_read_b64_tr_b16 v[170:171], v20 offset:1024
    ds_read_b64_tr_b16 v[172:173], v21 offset:0
    ds_read_b64_tr_b16 v[174:175], v21 offset:1024
    v_mfma_f32_32x32x16_bf16 v[112:127], v[176:179], v[188:191], v[112:127]
    s_add_u32 m0, s3, 49152
    s_add_u32 s4, s48, 2621440
    buffer_load_dwordx4 v11, s[36:39], s4 offen lds
    v_mfma_f32_32x32x16_bf16 v[128:143], v[180:183], v[184:187], v[128:143]
    s_add_u32 m0, s3, 57344
    s_add_u32 s4, s48, 2621440
    buffer_load_dwordx4 v11, s[12:15], s4 offen lds
    v_mfma_f32_32x32x16_bf16 v[144:159], v[180:183], v[188:191], v[144:159]
    s_add_u32 m0, s3, 98304
    s_add_u32 s4, s44, 768
    buffer_load_dwordx4 v10, s[32:35], s4 offen lds
    ds_read_b64_tr_b16 v[184:185], v20 offset:8192
    ds_read_b64_tr_b16 v[186:187], v20 offset:9216
    ds_read_b64_tr_b16 v[188:189], v21 offset:8192
    ds_read_b64_tr_b16 v[190:191], v21 offset:9216
    s_waitcnt lgkmcnt(4)
    v_mfma_f32_32x32x16_bf16 v[32:47], v[168:171], v[160:163], v[32:47]
    s_add_u32 m0, s3, 106496
    s_add_u32 s4, s44, 66304
    buffer_load_dwordx4 v10, s[32:35], s4 offen lds
    v_mfma_f32_32x32x16_bf16 v[48:63], v[172:175], v[160:163], v[48:63]
    v_mfma_f32_32x32x16_bf16 v[64:79], v[168:171], v[164:167], v[64:79]
    v_mfma_f32_32x32x16_bf16 v[80:95], v[172:175], v[164:167], v[80:95]
    ds_read_b128 v[176:179], v17 offset:0
    ds_read_b128 v[180:183], v17 offset:4096
    ds_read_b64_tr_b16 v[168:169], v20 offset:4096
    ds_read_b64_tr_b16 v[170:171], v20 offset:5120
    ds_read_b64_tr_b16 v[172:173], v21 offset:4096
    ds_read_b64_tr_b16 v[174:175], v21 offset:5120
    s_waitcnt lgkmcnt(6)
    v_mfma_f32_32x32x16_bf16 v[96:111], v[160:163], v[184:187], v[96:111]
    v_mfma_f32_32x32x16_bf16 v[112:127], v[160:163], v[188:191], v[112:127]
    v_mfma_f32_32x32x16_bf16 v[128:143], v[164:167], v[184:187], v[128:143]
    v_mfma_f32_32x32x16_bf16 v[144:159], v[164:167], v[188:191], v[144:159]
    ds_read_b64_tr_b16 v[184:185], v20 offset:12288
    ds_read_b64_tr_b16 v[186:187], v20 offset:13312
    ds_read_b64_tr_b16 v[188:189], v21 offset:12288
    ds_read_b64_tr_b16 v[190:191], v21 offset:13312
    s_waitcnt lgkmcnt(4)
    v_mfma_f32_32x32x16_bf16 v[32:47], v[168:171], v[176:179], v[32:47]
    v_mfma_f32_32x32x16_bf16 v[48:63], v[172:175], v[176:179], v[48:63]
    v_mfma_f32_32x32x16_bf16 v[64:79], v[168:171], v[180:183], v[64:79]
    v_mfma_f32_32x32x16_bf16 v[80:95], v[172:175], v[180:183], v[80:95]
    s_waitcnt lgkmcnt(0)
    v_mfma_f32_32x32x16_bf16 v[96:111], v[176:179], v[184:187], v[96:111]
    s_cmp_lg_u32 s20, 0
    s_cbranch_scc1 L_kva_pl2_b
    s_waitcnt vmcnt(4)
    s_mov_b32 s7, 0x40000
L_kva_pl2_a:
    v_cmp_gt_u32 vcc, v26, v24
    s_sub_u32 s7, s7, 1
    s_nop 2
    s_cbranch_vccz L_kva_pl2_b
    s_cmp_eq_u32 s7, 0
    s_cbranch_scc1 L_kva_pl2_b
    s_sleep 2
    buffer_load_dword v24, v25, s[56:59], s42 offen sc1
    s_waitcnt vmcnt(0)
    s_branch L_kva_pl2_a
L_kva_pl2_b:
    s_waitcnt vmcnt(7)
    s_barrier
    v_lshrrev_b32 v4, 3, v0
    v_lshlrev_b32 v4, 5, v4
    s_lshl_b32 s4, s20, 8
    s_add_u32 s5, s4, 2048
    buffer_load_dwordx4 v[218:221], v4, s[56:59], s5 offen sc1
    buffer_load_dwordx4 v[222:225], v4, s[56:59], s5 offen offset:16 sc1
    buffer_load_dwordx4 v[226:229], v4, s[56:59], s4 offen sc1
    buffer_load_dwordx4 v[230:233], v4, s[56:59], s4 offen offset:16 sc1
    v_add_u32 v20, 0xfffe8000, v20
    v_add_u32 v21, 0xfffe8000, v21
    ds_read_b128 v[160:163], v18 offset:0
    ds_read_b128 v[164:167], v18 offset:4096
    ds_read_b64_tr_b16 v[168:169], v20 offset:0
    ds_read_b64_tr_b16 v[170:171], v20 offset:1024
    ds_read_b64_tr_b16 v[172:173], v21 offset:0
    ds_read_b64_tr_b16 v[174:175], v21 offset:1024
    v_mfma_f32_32x32x16_bf16 v[112:127], v[176:179], v[188:191], v[112:127]
    s_add_u32 m0, s3, 131072
    s_add_u32 s4, s48, 2883584
    buffer_load_dwordx4 v11, s[36:39], s4 offen lds
    v_mfma_f32_32x32x16_bf16 v[128:143], v[180:183], v[184:187], v[128:143]
    s_add_u32 m0, s3, 139264
    s_add_u32 s4, s48, 2883584
    buffer_load_dwordx4 v11, s[12:15], s4 offen lds
    v_mfma_f32_32x32x16_bf16 v[144:159], v[180:183], v[188:191], v[144:159]
    s_add_u32 m0, s3, 114688
    s_add_u32 s4, s44, 131840
    buffer_load_dwordx4 v10, s[32:35], s4 offen lds
    ds_read_b64_tr_b16 v[184:185], v20 offset:8192
    ds_read_b64_tr_b16 v[186:187], v20 offset:9216
    ds_read_b64_tr_b16 v[188:189], v21 offset:8192
    ds_read_b64_tr_b16 v[190:191], v21 offset:9216
    s_waitcnt lgkmcnt(4)
    v_mfma_f32_32x32x16_bf16 v[32:47], v[168:171], v[160:163], v[32:47]
    s_add_u32 m0, s3, 122880
    s_add_u32 s4, s44, 197376
    buffer_load_dwordx4 v10, s[32:35], s4 offen lds
    v_mfma_f32_32x32x16_bf16 v[48:63], v[172:175], v[160:163], v[48:63]
    v_mfma_f32_32x32x16_bf16 v[64:79], v[168:171], v[164:167], v[64:79]
    v_mfma_f32_32x32x16_bf16 v[80:95], v[172:175], v[164:167], v[80:95]
    ds_read_b128 v[176:179], v19 offset:0
    ds_read_b128 v[180:183], v19 offset:4096
    ds_read_b64_tr_b16 v[168:169], v20 offset:4096
    ds_read_b64_tr_b16 v[170:171], v20 offset:5120
    ds_read_b64_tr_b16 v[172:173], v21 offset:4096
    ds_read_b64_tr_b16 v[174:175], v21 offset:5120
    s_waitcnt lgkmcnt(6)
    v_mfma_f32_32x32x16_bf16 v[96:111], v[160:163], v[184:187], v[96:111]
    v_mfma_f32_32x32x16_bf16 v[112:127], v[160:163], v[188:191], v[112:127]
    v_mfma_f32_32x32x16_bf16 v[128:143], v[164:167], v[184:187], v[128:143]
    v_mfma_f32_32x32x16_bf16 v[144:159], v[164:167], v[188:191], v[144:159]
    ds_read_b64_tr_b16 v[184:185], v20 offset:12288
    ds_read_b64_tr_b16 v[186:187], v20 offset:13312
    ds_read_b64_tr_b16 v[188:189], v21 offset:12288
    ds_read_b64_tr_b16 v[190:191], v21 offset:13312
    s_waitcnt lgkmcnt(4)
    v_mfma_f32_32x32x16_bf16 v[32:47], v[168:171], v[176:179], v[32:47]
    s_waitcnt vmcnt(4)
    v_add_f32 v218, 1.0, v218
    v_add_f32 v219, 1.0, v219
    v_add_f32 v220, 1.0, v220
    v_add_f32 v221, 1.0, v221
    v_mfma_f32_32x32x16_bf16 v[48:63], v[172:175], v[176:179], v[48:63]
    v_add_f32 v222, 1.0, v222
    v_add_f32 v223, 1.0, v223
    v_add_f32 v224, 1.0, v224
    v_add_f32 v225, 1.0, v225
    v_mfma_f32_32x32x16_bf16 v[64:79], v[168:171], v[180:183], v[64:79]
    v_cvt_pk_bf16_f32 v218, v218, v219
    v_and_b32 v219, 0xffff0000, v218
    v_lshlrev_b32 v218, 16, v218
    v_cvt_pk_bf16_f32 v220, v220, v221
    v_mfma_f32_32x32x16_bf16 v[80:95], v[172:175], v[180:183], v[80:95]
    v_and_b32 v221, 0xffff0000, v220
    v_lshlrev_b32 v220, 16, v220
    v_cvt_pk_bf16_f32 v222, v222, v223
    v_and_b32 v223, 0xffff0000, v222
    s_waitcnt lgkmcnt(0)
    v_mfma_f32_32x32x16_bf16 v[96:111], v[176:179], v[184:187], v[96:111]
    s_waitcnt vmcnt(10)
    s_barrier
    v_add_u32 v16, 0x10000, v16
    v_add_u32 v17, 0x10000, v17
    v_add_u32 v18, 0x10000, v18
    v_add_u32 v19, 0x10000, v19
    v_add_u32 v20, 0x4000, v20
    v_add_u32 v21, 0x4000, v21
    ds_read_b128 v[160:163], v16 offset:0
    ds_read_b128 v[164:167], v16 offset:4096
    ds_read_b64_tr_b16 v[168:169], v20 offset:0
    ds_read_b64_tr_b16 v[170:171], v20 offset:1024
    ds_read_b64_tr_b16 v[172:173], v21 offset:0
    ds_read_b64_tr_b16 v[174:175], v21 offset:1024
    v_mfma_f32_32x32x16_bf16 v[112:127], v[176:179], v[188:191], v[112:127]
    s_add_u32 m0, s3, 32768
    s_add_u32 s4, s48, 3145728
    buffer_load_dwordx4 v11, s[36:39], s4 offen lds
    v_lshlrev_b32 v222, 16, v222
    v_cvt_pk_bf16_f32 v224, v224, v225
    v_and_b32 v225, 0xffff0000, v224
    v_lshlrev_b32 v224, 16, v224
    v_fma_f32 v238, v238, v218, v226
    v_fma_f32 v239, v239, v219, v227
    v_mfma_f32_32x32x16_bf16 v[128:143], v[180:183], v[184:187], v[128:143]
    s_add_u32 m0, s3, 40960
    s_add_u32 s4, s48, 3145728
    buffer_load_dwordx4 v11, s[12:15], s4 offen lds
    v_fma_f32 v240, v240, v220, v228
    v_fma_f32 v241, v241, v221, v229
    v_fma_f32 v242, v242, v222, v230
    v_fma_f32 v243, v243, v223, v231
    v_fma_f32 v244, v244, v224, v232
    v_fma_f32 v245, v245, v225, v233
    v_mfma_f32_32x32x16_bf16 v[144:159], v[180:183], v[188:191], v[144:159]
    s_add_u32 m0, s3, 0
    s_add_u32 s4, s44, 896
    buffer_load_dwordx4 v10, s[32:35], s4 offen lds
    v_cvt_pk_bf16_f32 v234, v238, v239
    v_cvt_pk_bf16_f32 v235, v240, v241
    v_cvt_pk_bf16_f32 v236, v242, v243
    v_cvt_pk_bf16_f32 v237, v244, v245
    v_lshrrev_b32 v4, 4, v0
    v_lshlrev_b32 v4, 10, v4
    v_bfe_u32 v5, v0, 3, 1
    v_lshl_add_u32 v4, v5, 9, v4
    v_and_b32 v5, 7, v0
    v_lshl_add_u32 v4, v5, 4, v4
    s_lshr_b32 s4, s41, 2
    s_lshl_b32 s4, s4, 15
    s_and_b32 s5, s41, 3
    s_lshl_b32 s5, s5, 7
    s_add_u32 s4, s4, s5
    s_lshl_b32 s5, s20, 12
    s_add_u32 s4, s4, s5
    buffer_store_dwordx4 v[234:237], v4, s[52:55], s4 offen sc1
    ds_read_b64_tr_b16 v[184:185], v20 offset:8192
    ds_read_b64_tr_b16 v[186:187], v20 offset:9216
    ds_read_b64_tr_b16 v[188:189], v21 offset:8192
    ds_read_b64_tr_b16 v[190:191], v21 offset:9216
    s_waitcnt lgkmcnt(4)
    v_mfma_f32_32x32x16_bf16 v[32:47], v[168:171], v[160:163], v[32:47]
    s_add_u32 m0, s3, 8192
    s_add_u32 s4, s44, 66432
    buffer_load_dwordx4 v10, s[32:35], s4 offen lds
    v_mfma_f32_32x32x16_bf16 v[48:63], v[172:175], v[160:163], v[48:63]
    v_mfma_f32_32x32x16_bf16 v[64:79], v[168:171], v[164:167], v[64:79]
    v_mfma_f32_32x32x16_bf16 v[80:95], v[172:175], v[164:167], v[80:95]
    ds_read_b128 v[176:179], v17 offset:0
    ds_read_b128 v[180:183], v17 offset:4096
    ds_read_b64_tr_b16 v[168:169], v20 offset:4096
    ds_read_b64_tr_b16 v[170:171], v20 offset:5120
    ds_read_b64_tr_b16 v[172:173], v21 offset:4096
    ds_read_b64_tr_b16 v[174:175], v21 offset:5120
    s_waitcnt lgkmcnt(6)
    v_mfma_f32_32x32x16_bf16 v[96:111], v[160:163], v[184:187], v[96:111]
    v_mfma_f32_32x32x16_bf16 v[112:127], v[160:163], v[188:191], v[112:127]
    v_mfma_f32_32x32x16_bf16 v[128:143], v[164:167], v[184:187], v[128:143]
    v_mfma_f32_32x32x16_bf16 v[144:159], v[164:167], v[188:191], v[144:159]
    ds_read_b64_tr_b16 v[184:185], v20 offset:12288
    ds_read_b64_tr_b16 v[186:187], v20 offset:13312
    ds_read_b64_tr_b16 v[188:189], v21 offset:12288
    ds_read_b64_tr_b16 v[190:191], v21 offset:13312
    s_waitcnt lgkmcnt(4)
    v_mfma_f32_32x32x16_bf16 v[32:47], v[168:171], v[176:179], v[32:47]
    v_mfma_f32_32x32x16_bf16 v[48:63], v[172:175], v[176:179], v[48:63]
    v_mfma_f32_32x32x16_bf16 v[64:79], v[168:171], v[180:183], v[64:79]
    v_mfma_f32_32x32x16_bf16 v[80:95], v[172:175], v[180:183], v[80:95]
    s_waitcnt lgkmcnt(0)
    v_mfma_f32_32x32x16_bf16 v[96:111], v[176:179], v[184:187], v[96:111]
    s_waitcnt vmcnt(1)
    s_barrier
    v_add_u32 v20, 0x14000, v20
    v_add_u32 v21, 0x14000, v21
    ds_read_b128 v[160:163], v18 offset:0
    ds_read_b128 v[164:167], v18 offset:4096
    ds_read_b64_tr_b16 v[168:169], v20 offset:0
    ds_read_b64_tr_b16 v[170:171], v20 offset:1024
    ds_read_b64_tr_b16 v[172:173], v21 offset:0
    ds_read_b64_tr_b16 v[174:175], v21 offset:1024
    v_mfma_f32_32x32x16_bf16 v[112:127], v[176:179], v[188:191], v[112:127]
    s_add_u32 m0, s3, 49152
    s_add_u32 s4, s48, 3407872
    buffer_load_dwordx4 v11, s[36:39], s4 offen lds
    v_mov_b32 v4, 2
    v_mov_b32 v5, 0x7f000000
    v_cmp_eq_u32 vcc, 0x0, v9
    s_nop 1
    v_cndmask_b32 v5, v5, 0, vcc
    buffer_store_dword v4, v5, s[56:59], s40 offen sc1
    v_mfma_f32_32x32x16_bf16 v[128:143], v[180:183], v[184:187], v[128:143]
    s_add_u32 m0, s3, 57344
    s_add_u32 s4, s48, 3407872
    buffer_load_dwordx4 v11, s[12:15], s4 offen lds
    v_mfma_f32_32x32x16_bf16 v[144:159], v[180:183], v[188:191], v[144:159]
    s_add_u32 m0, s3, 16384
    s_add_u32 s4, s44, 131968
    buffer_load_dwordx4 v10, s[32:35], s4 offen lds
    ds_read_b64_tr_b16 v[184:185], v20 offset:8192
    ds_read_b64_tr_b16 v[186:187], v20 offset:9216
    ds_read_b64_tr_b16 v[188:189], v21 offset:8192
    ds_read_b64_tr_b16 v[190:191], v21 offset:9216
    s_waitcnt lgkmcnt(4)
    v_mfma_f32_32x32x16_bf16 v[32:47], v[168:171], v[160:163], v[32:47]
    s_add_u32 m0, s3, 24576
    s_add_u32 s4, s44, 197504
    buffer_load_dwordx4 v10, s[32:35], s4 offen lds
    v_mfma_f32_32x32x16_bf16 v[48:63], v[172:175], v[160:163], v[48:63]
    v_mfma_f32_32x32x16_bf16 v[64:79], v[168:171], v[164:167], v[64:79]
    v_mfma_f32_32x32x16_bf16 v[80:95], v[172:175], v[164:167], v[80:95]
    ds_read_b128 v[176:179], v19 offset:0
    ds_read_b128 v[180:183], v19 offset:4096
    ds_read_b64_tr_b16 v[168:169], v20 offset:4096
    ds_read_b64_tr_b16 v[170:171], v20 offset:5120
    ds_read_b64_tr_b16 v[172:173], v21 offset:4096
    ds_read_b64_tr_b16 v[174:175], v21 offset:5120
    s_waitcnt lgkmcnt(6)
    v_mfma_f32_32x32x16_bf16 v[96:111], v[160:163], v[184:187], v[96:111]
    v_mfma_f32_32x32x16_bf16 v[112:127], v[160:163], v[188:191], v[112:127]
    v_mfma_f32_32x32x16_bf16 v[128:143], v[164:167], v[184:187], v[128:143]
    v_mfma_f32_32x32x16_bf16 v[144:159], v[164:167], v[188:191], v[144:159]
    ds_read_b64_tr_b16 v[184:185], v20 offset:12288
    ds_read_b64_tr_b16 v[186:187], v20 offset:13312
    ds_read_b64_tr_b16 v[188:189], v21 offset:12288
    ds_read_b64_tr_b16 v[190:191], v21 offset:13312
    s_waitcnt lgkmcnt(4)
    v_mfma_f32_32x32x16_bf16 v[32:47], v[168:171], v[176:179], v[32:47]
    v_mfma_f32_32x32x16_bf16 v[48:63], v[172:175], v[176:179], v[48:63]
    v_mfma_f32_32x32x16_bf16 v[64:79], v[168:171], v[180:183], v[64:79]
    v_mfma_f32_32x32x16_bf16 v[80:95], v[172:175], v[180:183], v[80:95]
    s_waitcnt lgkmcnt(0)
    v_mfma_f32_32x32x16_bf16 v[96:111], v[176:179], v[184:187], v[96:111]
    s_waitcnt vmcnt(8)
    s_barrier
    v_add_u32 v16, 0x8000, v16
    v_add_u32 v17, 0x8000, v17
    v_add_u32 v18, 0x8000, v18
    v_add_u32 v19, 0x8000, v19
    v_add_u32 v20, 0xfffe8000, v20
    v_add_u32 v21, 0xfffe8000, v21
    ds_read_b128 v[160:163], v16 offset:0
    ds_read_b128 v[164:167], v16 offset:4096
    ds_read_b64_tr_b16 v[168:169], v20 offset:0
    ds_read_b64_tr_b16 v[170:171], v20 offset:1024
    ds_read_b64_tr_b16 v[172:173], v21 offset:0
    ds_read_b64_tr_b16 v[174:175], v21 offset:1024
    v_mfma_f32_32x32x16_bf16 v[112:127], v[176:179], v[188:191], v[112:127]
    s_add_u32 m0, s3, 131072
    s_add_u32 s4, s48, 3670016
    buffer_load_dwordx4 v11, s[36:39], s4 offen lds
    v_mfma_f32_32x32x16_bf16 v[128:143], v[180:183], v[184:187], v[128:143]
    s_add_u32 m0, s3, 139264
    s_add_u32 s4, s48, 3670016
    buffer_load_dwordx4 v11, s[12:15], s4 offen lds
    v_mfma_f32_32x32x16_bf16 v[144:159], v[180:183], v[188:191], v[144:159]
    s_mov_b32 s32, s68
    s_mov_b32 s33, s69
    s_mov_b32 s34, 0x400000
    s_add_u32 m0, s3, 65536
    s_add_u32 s4, s48, 0
    buffer_load_dwordx4 v11, s[32:35], s4 offen lds
    ds_read_b64_tr_b16 v[184:185], v20 offset:8192
    ds_read_b64_tr_b16 v[186:187], v20 offset:9216
    ds_read_b64_tr_b16 v[188:189], v21 offset:8192
    ds_read_b64_tr_b16 v[190:191], v21 offset:9216
    s_waitcnt lgkmcnt(4)
    v_mfma_f32_32x32x16_bf16 v[32:47], v[168:171], v[160:163], v[32:47]
    s_add_u32 m0, s3, 73728
    s_add_u32 s4, s48, 262144
    buffer_load_dwordx4 v11, s[32:35], s4 offen lds
    v_mfma_f32_32x32x16_bf16 v[48:63], v[172:175], v[160:163], v[48:63]
    v_mfma_f32_32x32x16_bf16 v[64:79], v[168:171], v[164:167], v[64:79]
    v_mfma_f32_32x32x16_bf16 v[80:95], v[172:175], v[164:167], v[80:95]
    ds_read_b128 v[176:179], v17 offset:0
    ds_read_b128 v[180:183], v17 offset:4096
    ds_read_b64_tr_b16 v[168:169], v20 offset:4096
    ds_read_b64_tr_b16 v[170:171], v20 offset:5120
    ds_read_b64_tr_b16 v[172:173], v21 offset:4096
    ds_read_b64_tr_b16 v[174:175], v21 offset:5120
    s_waitcnt lgkmcnt(6)
    v_mfma_f32_32x32x16_bf16 v[96:111], v[160:163], v[184:187], v[96:111]
    v_mfma_f32_32x32x16_bf16 v[112:127], v[160:163], v[188:191], v[112:127]
    v_mfma_f32_32x32x16_bf16 v[128:143], v[164:167], v[184:187], v[128:143]
    v_mfma_f32_32x32x16_bf16 v[144:159], v[164:167], v[188:191], v[144:159]
    ds_read_b64_tr_b16 v[184:185], v20 offset:12288
    ds_read_b64_tr_b16 v[186:187], v20 offset:13312
    ds_read_b64_tr_b16 v[188:189], v21 offset:12288
    ds_read_b64_tr_b16 v[190:191], v21 offset:13312
    s_waitcnt lgkmcnt(4)
    v_mfma_f32_32x32x16_bf16 v[32:47], v[168:171], v[176:179], v[32:47]
    s_lshl_b32 s4, s17, 4
    s_sub_u32 s5, 224, s4
    v_mov_b32 v4, s4
    v_mov_b32 v5, s5
    v_cmp_gt_u32 vcc, 16, v0
    s_nop 1
    v_cndmask_b32 v4, v5, v4, vcc
    v_add_u32 v4, v4, v0
    v_cmp_gt_u32 vcc, 32, v0
    s_nop 0
    v_lshlrev_b32 v4, 7, v4
    v_mov_b32 v25, 0x7f000000
    v_cndmask_b32 v25, v25, v4, vcc
    v_cndmask_b32 v26, 0, 2, vcc
    buffer_load_dword v24, v25, s[56:59], s42 offen sc1
    v_mfma_f32_32x32x16_bf16 v[48:63], v[172:175], v[176:179], v[48:63]
    v_mfma_f32_32x32x16_bf16 v[64:79], v[168:171], v[180:183], v[64:79]
    v_mfma_f32_32x32x16_bf16 v[80:95], v[172:175], v[180:183], v[80:95]
    s_waitcnt lgkmcnt(0)
    v_mfma_f32_32x32x16_bf16 v[96:111], v[176:179], v[184:187], v[96:111]
    s_waitcnt vmcnt(7)
    s_barrier
    v_add_u32 v20, 0x4000, v20
    v_add_u32 v21, 0x4000, v21
    ds_read_b128 v[160:163], v18 offset:0
    ds_read_b128 v[164:167], v18 offset:4096
    ds_read_b64_tr_b16 v[168:169], v20 offset:0
    ds_read_b64_tr_b16 v[170:171], v20 offset:1024
    ds_read_b64_tr_b16 v[172:173], v21 offset:0
    ds_read_b64_tr_b16 v[174:175], v21 offset:1024
    v_mfma_f32_32x32x16_bf16 v[112:127], v[176:179], v[188:191], v[112:127]
    s_add_u32 m0, s3, 32768
    s_add_u32 s4, s48, 3932160
    buffer_load_dwordx4 v11, s[36:39], s4 offen lds
    v_mfma_f32_32x32x16_bf16 v[128:143], v[180:183], v[184:187], v[128:143]
    s_add_u32 m0, s3, 40960
    s_add_u32 s4, s48, 3932160
    buffer_load_dwordx4 v11, s[12:15], s4 offen lds
    v_mfma_f32_32x32x16_bf16 v[144:159], v[180:183], v[188:191], v[144:159]
    s_add_u32 m0, s3, 81920
    s_add_u32 s4, s48, 524288
    buffer_load_dwordx4 v11, s[32:35], s4 offen lds
    ds_read_b64_tr_b16 v[184:185], v20 offset:8192
    ds_read_b64_tr_b16 v[186:187], v20 offset:9216
    ds_read_b64_tr_b16 v[188:189], v21 offset:8192
    ds_read_b64_tr_b16 v[190:191], v21 offset:9216
    s_waitcnt lgkmcnt(4)
    v_mfma_f32_32x32x16_bf16 v[32:47], v[168:171], v[160:163], v[32:47]
    s_add_u32 m0, s3, 90112
    s_add_u32 s4, s48, 786432
    buffer_load_dwordx4 v11, s[32:35], s4 offen lds
    v_mfma_f32_32x32x16_bf16 v[48:63], v[172:175], v[160:163], v[48:63]
    v_mfma_f32_32x32x16_bf16 v[64:79], v[168:171], v[164:167], v[64:79]
    v_mfma_f32_32x32x16_bf16 v[80:95], v[172:175], v[164:167], v[80:95]
    ds_read_b128 v[176:179], v19 offset:0
    ds_read_b128 v[180:183], v19 offset:4096
    ds_read_b64_tr_b16 v[168:169], v20 offset:4096
    ds_read_b64_tr_b16 v[170:171], v20 offset:5120
    ds_read_b64_tr_b16 v[172:173], v21 offset:4096
    ds_read_b64_tr_b16 v[174:175], v21 offset:5120
    s_waitcnt lgkmcnt(6)
    v_mfma_f32_32x32x16_bf16 v[96:111], v[160:163], v[184:187], v[96:111]
    v_mfma_f32_32x32x16_bf16 v[112:127], v[160:163], v[188:191], v[112:127]
    v_mfma_f32_32x32x16_bf16 v[128:143], v[164:167], v[184:187], v[128:143]
    v_mfma_f32_32x32x16_bf16 v[144:159], v[164:167], v[188:191], v[144:159]
    ds_read_b64_tr_b16 v[184:185], v20 offset:12288
    ds_read_b64_tr_b16 v[186:187], v20 offset:13312
    ds_read_b64_tr_b16 v[188:189], v21 offset:12288
    ds_read_b64_tr_b16 v[190:191], v21 offset:13312
    s_waitcnt lgkmcnt(4)
    v_mfma_f32_32x32x16_bf16 v[32:47], v[168:171], v[176:179], v[32:47]
    v_mfma_f32_32x32x16_bf16 v[48:63], v[172:175], v[176:179], v[48:63]
    v_mfma_f32_32x32x16_bf16 v[64:79], v[168:171], v[180:183], v[64:79]
    v_mfma_f32_32x32x16_bf16 v[80:95], v[172:175], v[180:183], v[80:95]
    s_waitcnt lgkmcnt(0)
    v_mfma_f32_32x32x16_bf16 v[96:111], v[176:179], v[184:187], v[96:111]
    s_cmp_lg_u32 s20, 0
    s_cbranch_scc1 L_kva_pl3_b
    s_waitcnt vmcnt(4)
    s_mov_b32 s7, 0x40000
L_kva_pl3_a:
    v_cmp_gt_u32 vcc, v26, v24
    s_sub_u32 s7, s7, 1
    s_nop 2
    s_cbranch_vccz L_kva_pl3_b
    s_cmp_eq_u32 s7, 0
    s_cbranch_scc1 L_kva_pl3_b
    s_sleep 2
    buffer_load_dword v24, v25, s[56:59], s42 offen sc1
    s_waitcnt vmcnt(0)
    s_branch L_kva_pl3_a
L_kva_pl3_b:
    s_waitcnt vmcnt(7)
    s_barrier
    v_add_u32 v16, 0xfffe8000, v16
    v_add_u32 v17, 0xfffe8000, v17
    v_add_u32 v18, 0xfffe8000, v18
    v_add_u32 v19, 0xfffe8000, v19
    v_add_u32 v20, 0x14000, v20
    v_add_u32 v21, 0x14000, v21
    ds_read_b128 v[160:163], v16 offset:0
    ds_read_b128 v[164:167], v16 offset:4096
    ds_read_b64_tr_b16 v[168:169], v20 offset:0
    ds_read_b64_tr_b16 v[170:171], v20 offset:1024
    ds_read_b64_tr_b16 v[172:173], v21 offset:0
    ds_read_b64_tr_b16 v[174:175], v21 offset:1024
    v_mfma_f32_32x32x16_bf16 v[112:127], v[176:179], v[188:191], v[112:127]
    s_add_u32 m0, s3, 98304
    s_add_u32 s4, s48, 1048576
    buffer_load_dwordx4 v11, s[32:35], s4 offen lds
    s_add_u32 s4, s31, 0
    buffer_load_dwordx4 v[208:211], v12, s[52:55], s4 offen sc1
    v_mfma_f32_32x32x16_bf16 v[128:143], v[180:183], v[184:187], v[128:143]
    s_add_u32 m0, s3, 106496
    s_add_u32 s4, s48, 1310720
    buffer_load_dwordx4 v11, s[32:35], s4 offen lds
    s_add_u32 s4, s31, 1024
    buffer_load_dwordx4 v[212:215], v12, s[52:55], s4 offen sc1
    v_mfma_f32_32x32x16_bf16 v[144:159], v[180:183], v[188:191], v[144:159]
    s_add_u32 m0, s3, 114688
    s_add_u32 s4, s48, 1572864
    buffer_load_dwordx4 v11, s[32:35], s4 offen lds
    ds_read_b64_tr_b16 v[184:185], v20 offset:8192
    ds_read_b64_tr_b16 v[186:187], v20 offset:9216
    ds_read_b64_tr_b16 v[188:189], v21 offset:8192
    ds_read_b64_tr_b16 v[190:191], v21 offset:9216
    s_waitcnt lgkmcnt(4)
    v_mfma_f32_32x32x16_bf16 v[32:47], v[168:171], v[160:163], v[32:47]
    s_add_u32 m0, s3, 122880
    s_add_u32 s4, s48, 1835008
    buffer_load_dwordx4 v11, s[32:35], s4 offen lds
    s_add_u32 s4, s31, 2048
    buffer_load_dwordx4 v[216:219], v12, s[52:55], s4 offen sc1
    v_mfma_f32_32x32x16_bf16 v[48:63], v[172:175], v[160:163], v[48:63]
    s_add_u32 s4, s31, 3072
    buffer_load_dwordx4 v[220:223], v12, s[52:55], s4 offen sc1
    v_mfma_f32_32x32x16_bf16 v[64:79], v[168:171], v[164:167], v[64:79]
    v_mfma_f32_32x32x16_bf16 v[80:95], v[172:175], v[164:167], v[80:95]
    ds_read_b128 v[176:179], v17 offset:0
    ds_read_b128 v[180:183], v17 offset:4096
    ds_read_b64_tr_b16 v[168:169], v20 offset:4096
    ds_read_b64_tr_b16 v[170:171], v20 offset:5120
    ds_read_b64_tr_b16 v[172:173], v21 offset:4096
    ds_read_b64_tr_b16 v[174:175], v21 offset:5120
    s_waitcnt lgkmcnt(6)
    v_mfma_f32_32x32x16_bf16 v[96:111], v[160:163], v[184:187], v[96:111]
    s_add_u32 s4, s31, 4096
    buffer_load_dwordx4 v[224:227], v12, s[52:55], s4 offen sc1
    v_mfma_f32_32x32x16_bf16 v[112:127], v[160:163], v[188:191], v[112:127]
    s_add_u32 s4, s31, 5120
    buffer_load_dwordx4 v[228:231], v12, s[52:55], s4 offen sc1
    v_mfma_f32_32x32x16_bf16 v[128:143], v[164:167], v[184:187], v[128:143]
    v_mfma_f32_32x32x16_bf16 v[144:159], v[164:167], v[188:191], v[144:159]
    ds_read_b64_tr_b16 v[184:185], v20 offset:12288
    ds_read_b64_tr_b16 v[186:187], v20 offset:13312
    ds_read_b64_tr_b16 v[188:189], v21 offset:12288
    ds_read_b64_tr_b16 v[190:191], v21 offset:13312
    s_waitcnt lgkmcnt(4)
    v_mfma_f32_32x32x16_bf16 v[32:47], v[168:171], v[176:179], v[32:47]
    s_add_u32 s4, s31, 6144
    buffer_load_dwordx4 v[232:235], v12, s[52:55], s4 offen sc1
    v_mfma_f32_32x32x16_bf16 v[48:63], v[172:175], v[176:179], v[48:63]
    s_add_u32 s4, s31, 7168
    buffer_load_dwordx4 v[236:239], v12, s[52:55], s4 offen sc1
    v_mfma_f32_32x32x16_bf16 v[64:79], v[168:171], v[180:183], v[64:79]
    v_mfma_f32_32x32x16_bf16 v[80:95], v[172:175], v[180:183], v[80:95]
    s_waitcnt lgkmcnt(0)
    v_mfma_f32_32x32x16_bf16 v[96:111], v[176:179], v[184:187], v[96:111]
    s_waitcnt vmcnt(14)
    s_barrier
    v_add_u32 v20, 0xfffe8000, v20
    v_add_u32 v21, 0xfffe8000, v21
    ds_read_b128 v[160:163], v18 offset:0
    ds_read_b128 v[164:167], v18 offset:4096
    ds_read_b64_tr_b16 v[168:169], v20 offset:0
    ds_read_b64_tr_b16 v[170:171], v20 offset:1024
    ds_read_b64_tr_b16 v[172:173], v21 offset:0
    ds_read_b64_tr_b16 v[174:175], v21 offset:1024
    v_mfma_f32_32x32x16_bf16 v[112:127], v[176:179], v[188:191], v[112:127]
    s_add_u32 m0, s3, 49152
    s_add_u32 s4, s48, 2097152
    buffer_load_dwordx4 v11, s[32:35], s4 offen lds
    s_add_u32 s4, s31, 8192
    buffer_load_dwordx4 v[240:243], v12, s[52:55], s4 offen sc1
    v_mfma_f32_32x32x16_bf16 v[128:143], v[180:183], v[184:187], v[128:143]
    s_add_u32 m0, s3, 57344
    s_add_u32 s4, s48, 2359296
    buffer_load_dwordx4 v11, s[32:35], s4 offen lds
    s_add_u32 s4, s31, 9216
    buffer_load_dwordx4 v[244:247], v12, s[52:55], s4 offen sc1
    v_mfma_f32_32x32x16_bf16 v[144:159], v[180:183], v[188:191], v[144:159]
    s_add_u32 m0, s3, 131072
    s_add_u32 s4, s48, 2621440
    buffer_load_dwordx4 v11, s[32:35], s4 offen lds
    ds_read_b64_tr_b16 v[184:185], v20 offset:8192
    ds_read_b64_tr_b16 v[186:187], v20 offset:9216
    ds_read_b64_tr_b16 v[188:189], v21 offset:8192
    ds_read_b64_tr_b16 v[190:191], v21 offset:9216
    s_waitcnt lgkmcnt(4)
    v_mfma_f32_32x32x16_bf16 v[32:47], v[168:171], v[160:163], v[32:47]
    s_add_u32 m0, s3, 139264
    s_add_u32 s4, s48, 2883584
    buffer_load_dwordx4 v11, s[32:35], s4 offen lds
    s_add_u32 s4, s31, 10240
    buffer_load_dwordx4 v[248:251], v12, s[52:55], s4 offen sc1
    v_mfma_f32_32x32x16_bf16 v[48:63], v[172:175], v[160:163], v[48:63]
    s_add_u32 s4, s31, 11264
    buffer_load_dwordx4 v[252:255], v12, s[52:55], s4 offen sc1
    v_mfma_f32_32x32x16_bf16 v[64:79], v[168:171], v[164:167], v[64:79]
    v_mfma_f32_32x32x16_bf16 v[80:95], v[172:175], v[164:167], v[80:95]
    ds_read_b128 v[176:179], v19 offset:0
    ds_read_b128 v[180:183], v19 offset:4096
    ds_read_b64_tr_b16 v[168:169], v20 offset:4096
    ds_read_b64_tr_b16 v[170:171], v20 offset:5120
    ds_read_b64_tr_b16 v[172:173], v21 offset:4096
    ds_read_b64_tr_b16 v[174:175], v21 offset:5120
    s_waitcnt lgkmcnt(6)
    v_mfma_f32_32x32x16_bf16 v[96:111], v[160:163], v[184:187], v[96:111]
    v_mfma_f32_32x32x16_bf16 v[112:127], v[160:163], v[188:191], v[112:127]
    v_mfma_f32_32x32x16_bf16 v[128:143], v[164:167], v[184:187], v[128:143]
    v_mfma_f32_32x32x16_bf16 v[144:159], v[164:167], v[188:191], v[144:159]
    ds_read_b64_tr_b16 v[184:185], v20 offset:12288
    ds_read_b64_tr_b16 v[186:187], v20 offset:13312
    ds_read_b64_tr_b16 v[188:189], v21 offset:12288
    ds_read_b64_tr_b16 v[190:191], v21 offset:13312
    s_waitcnt lgkmcnt(4)
    v_mfma_f32_32x32x16_bf16 v[32:47], v[168:171], v[176:179], v[32:47]
    v_mfma_f32_32x32x16_bf16 v[48:63], v[172:175], v[176:179], v[48:63]
    v_mfma_f32_32x32x16_bf16 v[64:79], v[168:171], v[180:183], v[64:79]
    v_mfma_f32_32x32x16_bf16 v[80:95], v[172:175], v[180:183], v[80:95]
    s_waitcnt lgkmcnt(0)
    v_mfma_f32_32x32x16_bf16 v[96:111], v[176:179], v[184:187], v[96:111]
    s_waitcnt vmcnt(17)
    s_barrier
    v_xor_b32 v7, 0, v6
    v_lshl_add_u32 v20, v7, 6, v8
    v_add_u32 v20, 65536, v20
    v_xor_b32 v7, 1, v6
    v_lshl_add_u32 v21, v7, 6, v8
    v_add_u32 v21, 65536, v21
    v_xor_b32 v7, 2, v6
    v_lshl_add_u32 v22, v7, 6, v8
    v_add_u32 v22, 65536, v22
    v_xor_b32 v7, 3, v6
    v_lshl_add_u32 v23, v7, 6, v8
    v_add_u32 v23, 65536, v23
    ds_read_b64_tr_b16 v[160:161], v20 offset:0
    ds_read_b64_tr_b16 v[162:163], v20 offset:1024
    ds_read_b64_tr_b16 v[164:165], v21 offset:0
    ds_read_b64_tr_b16 v[166:167], v21 offset:1024
    ds_read_b64_tr_b16 v[168:169], v22 offset:0
    ds_read_b64_tr_b16 v[170:171], v22 offset:1024
    ds_read_b64_tr_b16 v[172:173], v23 offset:0
    ds_read_b64_tr_b16 v[174:175], v23 offset:1024
    v_mfma_f32_32x32x16_bf16 v[112:127], v[176:179], v[188:191], v[112:127]
    s_add_u32 m0, s3, 0
    s_add_u32 s4, s48, 3145728
    buffer_load_dwordx4 v11, s[32:35], s4 offen lds
    v_cvt_pk_bf16_f32 v32, v32, v33
    v_cvt_pk_bf16_f32 v33, v34, v35
    v_cvt_pk_bf16_f32 v34, v36, v37
    v_cvt_pk_bf16_f32 v35, v38, v39
    v_cvt_pk_bf16_f32 v36, v40, v41
    v_cvt_pk_bf16_f32 v37, v42, v43
    v_cvt_pk_bf16_f32 v38, v44, v45
    v_cvt_pk_bf16_f32 v39, v46, v47
    v_cvt_pk_bf16_f32 v40, v48, v49
    v_cvt_pk_bf16_f32 v41, v50, v51
    v_cvt_pk_bf16_f32 v42, v52, v53
    v_mfma_f32_32x32x16_bf16 v[128:143], v[180:183], v[184:187], v[128:143]
    s_add_u32 m0, s3, 8192
    s_add_u32 s4, s48, 3407872
    buffer_load_dwordx4 v11, s[32:35], s4 offen lds
    v_cvt_pk_bf16_f32 v43, v54, v55
    v_cvt_pk_bf16_f32 v44, v56, v57
    v_cvt_pk_bf16_f32 v45, v58, v59
    v_cvt_pk_bf16_f32 v46, v60, v61
    v_cvt_pk_bf16_f32 v47, v62, v63
    v_cvt_pk_bf16_f32 v48, v64, v65
    v_cvt_pk_bf16_f32 v49, v66, v67
    v_cvt_pk_bf16_f32 v50, v68, v69
    v_cvt_pk_bf16_f32 v51, v70, v71
    v_cvt_pk_bf16_f32 v52, v72, v73
    v_cvt_pk_bf16_f32 v53, v74, v75
    v_mfma_f32_32x32x16_bf16 v[144:159], v[180:183], v[188:191], v[144:159]
    s_add_u32 m0, s3, 16384
    s_add_u32 s4, s48, 3670016
    buffer_load_dwordx4 v11, s[32:35], s4 offen lds
    v_cvt_pk_bf16_f32 v54, v76, v77
    v_cvt_pk_bf16_f32 v55, v78, v79
    v_cvt_pk_bf16_f32 v56, v80, v81
    v_cvt_pk_bf16_f32 v57, v82, v83
    v_cvt_pk_bf16_f32 v58, v84, v85
    v_cvt_pk_bf16_f32 v59, v86, v87
    v_cvt_pk_bf16_f32 v60, v88, v89
    v_cvt_pk_bf16_f32 v61, v90, v91
    v_cvt_pk_bf16_f32 v62, v92, v93
    v_cvt_pk_bf16_f32 v63, v94, v95
    s_lshl_b32 s49, s50, 12
    s_lshl_b32 s4, s46, 14
    s_add_u32 s49, s49, s4
    s_lshl_b32 s4, s18, 14
    s_lshl_b32 s5, s19, 12
    s_add_u32 s5, s5, s4
    s_add_u32 s5, s5, 65536
    v_add_u32 v192, s5, v12
    s_lshl_b32 s5, s19, 11
    s_add_u32 s5, s5, s4
    s_add_u32 s5, s5, 32768
    v_add_u32 v193, s5, v12
    s_mov_b32 s24, 0x76543210
    s_mov_b32 s25, 0xfedcba98
    s_lshl_b32 s4, s17, 3
    s_sub_u32 s18, 56, s4
    s_bfm_b64 s[92:93], s18, 0
    s_and_b64 s[92:93], s[92:93], s[24:25]
    s_lshr_b64 s[6:7], s[24:25], 8
    s_lshl_b32 s26, s17, 2
    s_bfm_b64 s[4:5], s26, s18
    s_and_b64 s[6:7], s[6:7], s[4:5]
    s_or_b64 s[92:93], s[92:93], s[6:7]
    s_sub_u32 s26, 56, s26
    s_lshl_b64 s[6:7], s[24:25], s26
    s_or_b64 s[92:93], s[92:93], s[6:7]
    s_lshl_b32 s4, s17, 1
    s_sub_u32 s4, 15, s4
    s_lshl_b32 s26, s4, 15
    s_add_u32 s26, s26, s21
    s_and_b32 s24, s92, 15
    s_lshr_b64 s[92:93], s[92:93], 4
    s_lshl_b32 s24, s24, 15
    s_add_u32 s24, s24, s21
    s_add_u32 s12, s94, 0x3400000
    s_addc_u32 s13, s95, 0
    s_mov_b32 s14, 0x1000000
    s_mov_b32 s15, 0x00020000
    ds_read_b64_tr_b16 v[176:177], v20 offset:4096
    ds_read_b64_tr_b16 v[178:179], v20 offset:5120
    ds_read_b64_tr_b16 v[180:181], v21 offset:4096
    ds_read_b64_tr_b16 v[182:183], v21 offset:5120
    ds_read_b64_tr_b16 v[184:185], v22 offset:4096
    ds_read_b64_tr_b16 v[186:187], v22 offset:5120
    ds_read_b64_tr_b16 v[188:189], v23 offset:4096
    ds_read_b64_tr_b16 v[190:191], v23 offset:5120
    s_waitcnt vmcnt(21) lgkmcnt(8)
    v_mfma_f32_32x32x16_bf16 v[64:79], v[160:163], v[208:211], 0
    v_cvt_pk_bf16_f32 v96, v96, v97
    v_cvt_pk_bf16_f32 v97, v98, v99
    v_cvt_pk_bf16_f32 v98, v100, v101
    v_cvt_pk_bf16_f32 v99, v102, v103
    v_cvt_pk_bf16_f32 v100, v104, v105
    v_cvt_pk_bf16_f32 v101, v106, v107
    v_cvt_pk_bf16_f32 v102, v108, v109
    v_cvt_pk_bf16_f32 v103, v110, v111
    v_cvt_pk_bf16_f32 v104, v112, v113
    v_cvt_pk_bf16_f32 v105, v114, v115
    v_cvt_pk_bf16_f32 v106, v116, v117
    v_cvt_pk_bf16_f32 v107, v118, v119
    v_cvt_pk_bf16_f32 v108, v120, v121
    v_cvt_pk_bf16_f32 v109, v122, v123
    v_cvt_pk_bf16_f32 v110, v124, v125
    v_cvt_pk_bf16_f32 v111, v126, v127
    s_add_u32 m0, s3, 24576
    s_add_u32 s4, s48, 3932160
    buffer_load_dwordx4 v11, s[32:35], s4 offen lds
    s_add_u32 s4, s22, 0x0
    buffer_store_dwordx4 v[32:35], v12, s[8:11], s4 offen sc1
    v_mfma_f32_32x32x16_bf16 v[80:95], v[164:167], v[208:211], 0
    v_cvt_pk_bf16_f32 v112, v128, v129
    v_cvt_pk_bf16_f32 v113, v130, v131
    v_cvt_pk_bf16_f32 v114, v132, v133
    v_cvt_pk_bf16_f32 v115, v134, v135
    v_cvt_pk_bf16_f32 v116, v136, v137
    v_cvt_pk_bf16_f32 v117, v138, v139
    v_cvt_pk_bf16_f32 v118, v140, v141
    v_cvt_pk_bf16_f32 v119, v142, v143
    v_cvt_pk_bf16_f32 v120, v144, v145
    v_cvt_pk_bf16_f32 v121, v146, v147
    v_cvt_pk_bf16_f32 v122, v148, v149
    v_cvt_pk_bf16_f32 v123, v150, v151
    v_cvt_pk_bf16_f32 v124, v152, v153
    v_cvt_pk_bf16_f32 v125, v154, v155
    v_cvt_pk_bf16_f32 v126, v156, v157
    v_cvt_pk_bf16_f32 v127, v158, v159
    v_mfma_f32_32x32x16_bf16 v[128:143], v[168:171], v[208:211], 0
    v_mfma_f32_32x32x16_bf16 v[144:159], v[172:175], v[208:211], 0
    s_add_u32 s4, s31, 12288
    buffer_load_dwordx4 v[208:211], v12, s[52:55], s4 offen sc1
    ds_read_b64_tr_b16 v[160:161], v20 offset:8192
    ds_read_b64_tr_b16 v[162:163], v20 offset:9216
    ds_read_b64_tr_b16 v[164:165], v21 offset:8192
    ds_read_b64_tr_b16 v[166:167], v21 offset:9216
    ds_read_b64_tr_b16 v[168:169], v22 offset:8192
    ds_read_b64_tr_b16 v[170:171], v22 offset:9216
    ds_read_b64_tr_b16 v[172:173], v23 offset:8192
    ds_read_b64_tr_b16 v[174:175], v23 offset:9216
    s_waitcnt vmcnt(22) lgkmcnt(8)
    v_mfma_f32_32x32x16_bf16 v[64:79], v[176:179], v[212:215], v[64:79]
    v_mfma_f32_32x32x16_bf16 v[80:95], v[180:183], v[212:215], v[80:95]
    v_mfma_f32_32x32x16_bf16 v[128:143], v[184:187], v[212:215], v[128:143]
    v_mfma_f32_32x32x16_bf16 v[144:159], v[188:191], v[212:215], v[144:159]
    s_add_u32 s4, s31, 13312
    buffer_load_dwordx4 v[212:215], v12, s[52:55], s4 offen sc1
    s_lshl_b32 s4, s16, 19
    s_add_u32 s32, s8, s4
    s_addc_u32 s33, s9, 0
    s_mov_b32 s34, 0x4000000
    s_add_u32 s60, s32, 0x1000000
    s_addc_u32 s61, s33, 0
    s_mov_b32 s62, 0x4000000
    ds_read_b64_tr_b16 v[176:177], v20 offset:12288
    ds_read_b64_tr_b16 v[178:179], v20 offset:13312
    ds_read_b64_tr_b16 v[180:181], v21 offset:12288
    ds_read_b64_tr_b16 v[182:183], v21 offset:13312
    ds_read_b64_tr_b16 v[184:185], v22 offset:12288
    ds_read_b64_tr_b16 v[186:187], v22 offset:13312
    ds_read_b64_tr_b16 v[188:189], v23 offset:12288
    ds_read_b64_tr_b16 v[190:191], v23 offset:13312
    s_waitcnt vmcnt(20) lgkmcnt(8)
    v_mfma_f32_32x32x16_bf16 v[64:79], v[160:163], v[216:219], v[64:79]
    s_add_u32 s4, s22, 0x400
    buffer_store_dwordx4 v[36:39], v12, s[8:11], s4 offen sc1
    v_mfma_f32_32x32x16_bf16 v[80:95], v[164:167], v[216:219], v[80:95]
    v_mfma_f32_32x32x16_bf16 v[128:143], v[168:171], v[216:219], v[128:143]
    v_mfma_f32_32x32x16_bf16 v[144:159], v[172:175], v[216:219], v[144:159]
    s_add_u32 s4, s31, 14336
    buffer_load_dwordx4 v[216:219], v12, s[52:55], s4 offen sc1
    ds_read_b64_tr_b16 v[160:161], v20 offset:16384
    ds_read_b64_tr_b16 v[162:163], v20 offset:17408
    ds_read_b64_tr_b16 v[164:165], v21 offset:16384
    ds_read_b64_tr_b16 v[166:167], v21 offset:17408
    ds_read_b64_tr_b16 v[168:169], v22 offset:16384
    ds_read_b64_tr_b16 v[170:171], v22 offset:17408
    ds_read_b64_tr_b16 v[172:173], v23 offset:16384
    ds_read_b64_tr_b16 v[174:175], v23 offset:17408
    s_waitcnt vmcnt(21) lgkmcnt(8)
    v_mfma_f32_32x32x16_bf16 v[64:79], v[176:179], v[220:223], v[64:79]
    s_add_u32 s4, s22, 0x800
    buffer_store_dwordx4 v[40:43], v12, s[8:11], s4 offen sc1
    v_mfma_f32_32x32x16_bf16 v[80:95], v[180:183], v[220:223], v[80:95]
    v_mfma_f32_32x32x16_bf16 v[128:143], v[184:187], v[220:223], v[128:143]
    v_mfma_f32_32x32x16_bf16 v[144:159], v[188:191], v[220:223], v[144:159]
    s_add_u32 s4, s31, 15360
    buffer_load_dwordx4 v[220:223], v12, s[52:55], s4 offen sc1
    ds_read_b64_tr_b16 v[176:177], v20 offset:20480
    ds_read_b64_tr_b16 v[178:179], v20 offset:21504
    ds_read_b64_tr_b16 v[180:181], v21 offset:20480
    ds_read_b64_tr_b16 v[182:183], v21 offset:21504
    ds_read_b64_tr_b16 v[184:185], v22 offset:20480
    ds_read_b64_tr_b16 v[186:187], v22 offset:21504
    ds_read_b64_tr_b16 v[188:189], v23 offset:20480
    ds_read_b64_tr_b16 v[190:191], v23 offset:21504
    s_waitcnt vmcnt(22) lgkmcnt(8)
    v_mfma_f32_32x32x16_bf16 v[64:79], v[160:163], v[224:227], v[64:79]
    v_mfma_f32_32x32x16_bf16 v[80:95], v[164:167], v[224:227], v[80:95]
    v_mfma_f32_32x32x16_bf16 v[128:143], v[168:171], v[224:227], v[128:143]
    v_mfma_f32_32x32x16_bf16 v[144:159], v[172:175], v[224:227], v[144:159]
    s_add_u32 s4, s31, 16384
    buffer_load_dwordx4 v[224:227], v12, s[52:55], s4 offen sc1
    ds_read_b64_tr_b16 v[160:161], v20 offset:24576
    ds_read_b64_tr_b16 v[162:163], v20 offset:25600
    ds_read_b64_tr_b16 v[164:165], v21 offset:24576
    ds_read_b64_tr_b16 v[166:167], v21 offset:25600
    ds_read_b64_tr_b16 v[168:169], v22 offset:24576
    ds_read_b64_tr_b16 v[170:171], v22 offset:25600
    ds_read_b64_tr_b16 v[172:173], v23 offset:24576
    ds_read_b64_tr_b16 v[174:175], v23 offset:25600
    s_waitcnt vmcnt(22) lgkmcnt(8)
    v_mfma_f32_32x32x16_bf16 v[64:79], v[176:179], v[228:231], v[64:79]
    s_add_u32 s4, s22, 0xc00
    buffer_store_dwordx4 v[44:47], v12, s[8:11], s4 offen sc1
    v_mfma_f32_32x32x16_bf16 v[80:95], v[180:183], v[228:231], v[80:95]
    v_mfma_f32_32x32x16_bf16 v[128:143], v[184:187], v[228:231], v[128:143]
    v_mfma_f32_32x32x16_bf16 v[144:159], v[188:191], v[228:231], v[144:159]
    s_add_u32 s4, s31, 17408
    buffer_load_dwordx4 v[228:231], v12, s[52:55], s4 offen sc1
    ds_read_b64_tr_b16 v[176:177], v20 offset:28672
    ds_read_b64_tr_b16 v[178:179], v20 offset:29696
    ds_read_b64_tr_b16 v[180:181], v21 offset:28672
    ds_read_b64_tr_b16 v[182:183], v21 offset:29696
    ds_read_b64_tr_b16 v[184:185], v22 offset:28672
    ds_read_b64_tr_b16 v[186:187], v22 offset:29696
    ds_read_b64_tr_b16 v[188:189], v23 offset:28672
    ds_read_b64_tr_b16 v[190:191], v23 offset:29696
    s_waitcnt vmcnt(23) lgkmcnt(8)
    v_mfma_f32_32x32x16_bf16 v[64:79], v[160:163], v[232:235], v[64:79]
    s_add_u32 s4, s22, 0x2000
    buffer_store_dwordx4 v[48:51], v12, s[8:11], s4 offen sc1
    v_mfma_f32_32x32x16_bf16 v[80:95], v[164:167], v[232:235], v[80:95]
    v_mfma_f32_32x32x16_bf16 v[128:143], v[168:171], v[232:235], v[128:143]
    v_mfma_f32_32x32x16_bf16 v[144:159], v[172:175], v[232:235], v[144:159]
    s_add_u32 s4, s31, 18432
    buffer_load_dwordx4 v[232:235], v12, s[52:55], s4 offen sc1
    ds_read_b64_tr_b16 v[160:161], v20 offset:32768
    ds_read_b64_tr_b16 v[162:163], v20 offset:33792
    ds_read_b64_tr_b16 v[164:165], v21 offset:32768
    ds_read_b64_tr_b16 v[166:167], v21 offset:33792
    ds_read_b64_tr_b16 v[168:169], v22 offset:32768
    ds_read_b64_tr_b16 v[170:171], v22 offset:33792
    ds_read_b64_tr_b16 v[172:173], v23 offset:32768
    ds_read_b64_tr_b16 v[174:175], v23 offset:33792
    s_waitcnt vmcnt(24) lgkmcnt(8)
    v_mfma_f32_32x32x16_bf16 v[64:79], v[176:179], v[236:239], v[64:79]
    v_mfma_f32_32x32x16_bf16 v[80:95], v[180:183], v[236:239], v[80:95]
    v_mfma_f32_32x32x16_bf16 v[128:143], v[184:187], v[236:239], v[128:143]
    v_mfma_f32_32x32x16_bf16 v[144:159], v[188:191], v[236:239], v[144:159]
    s_add_u32 s4, s31, 19456
    buffer_load_dwordx4 v[236:239], v12, s[52:55], s4 offen sc1
    ds_read_b64_tr_b16 v[176:177], v20 offset:36864
    ds_read_b64_tr_b16 v[178:179], v20 offset:37888
    ds_read_b64_tr_b16 v[180:181], v21 offset:36864
    ds_read_b64_tr_b16 v[182:183], v21 offset:37888
    ds_read_b64_tr_b16 v[184:185], v22 offset:36864
    ds_read_b64_tr_b16 v[186:187], v22 offset:37888
    ds_read_b64_tr_b16 v[188:189], v23 offset:36864
    ds_read_b64_tr_b16 v[190:191], v23 offset:37888
    s_waitcnt vmcnt(23) lgkmcnt(8)
    v_mfma_f32_32x32x16_bf16 v[64:79], v[160:163], v[240:243], v[64:79]
    s_add_u32 s4, s22, 0x2400
    buffer_store_dwordx4 v[52:55], v12, s[8:11], s4 offen sc1
    v_mfma_f32_32x32x16_bf16 v[80:95], v[164:167], v[240:243], v[80:95]
    v_mfma_f32_32x32x16_bf16 v[128:143], v[168:171], v[240:243], v[128:143]
    v_mfma_f32_32x32x16_bf16 v[144:159], v[172:175], v[240:243], v[144:159]
    s_add_u32 s4, s31, 20480
    buffer_load_dwordx4 v[240:243], v12, s[52:55], s4 offen sc1
    ds_read_b64_tr_b16 v[160:161], v20 offset:40960
    ds_read_b64_tr_b16 v[162:163], v20 offset:41984
    ds_read_b64_tr_b16 v[164:165], v21 offset:40960
    ds_read_b64_tr_b16 v[166:167], v21 offset:41984
    ds_read_b64_tr_b16 v[168:169], v22 offset:40960
    ds_read_b64_tr_b16 v[170:171], v22 offset:41984
    ds_read_b64_tr_b16 v[172:173], v23 offset:40960
    ds_read_b64_tr_b16 v[174:175], v23 offset:41984
    s_waitcnt vmcnt(23) lgkmcnt(8)
    v_mfma_f32_32x32x16_bf16 v[64:79], v[176:179], v[244:247], v[64:79]
    s_add_u32 s4, s22, 0x2800
    buffer_store_dwordx4 v[56:59], v12, s[8:11], s4 offen sc1
    v_mfma_f32_32x32x16_bf16 v[80:95], v[180:183], v[244:247], v[80:95]
    v_mfma_f32_32x32x16_bf16 v[128:143], v[184:187], v[244:247], v[128:143]
    v_mfma_f32_32x32x16_bf16 v[144:159], v[188:191], v[244:247], v[144:159]
    s_add_u32 s4, s31, 21504
    buffer_load_dwordx4 v[244:247], v12, s[52:55], s4 offen sc1
    ds_read_b64_tr_b16 v[176:177], v20 offset:45056
    ds_read_b64_tr_b16 v[178:179], v20 offset:46080
    ds_read_b64_tr_b16 v[180:181], v21 offset:45056
    ds_read_b64_tr_b16 v[182:183], v21 offset:46080
    ds_read_b64_tr_b16 v[184:185], v22 offset:45056
    ds_read_b64_tr_b16 v[186:187], v22 offset:46080
    ds_read_b64_tr_b16 v[188:189], v23 offset:45056
    ds_read_b64_tr_b16 v[190:191], v23 offset:46080
    s_waitcnt vmcnt(22) lgkmcnt(8)
    v_mfma_f32_32x32x16_bf16 v[64:79], v[160:163], v[248:251], v[64:79]
    v_mfma_f32_32x32x16_bf16 v[80:95], v[164:167], v[248:251], v[80:95]
    v_mfma_f32_32x32x16_bf16 v[128:143], v[168:171], v[248:251], v[128:143]
    v_mfma_f32_32x32x16_bf16 v[144:159], v[172:175], v[248:251], v[144:159]
    s_add_u32 s4, s31, 22528
    buffer_load_dwordx4 v[248:251], v12, s[52:55], s4 offen sc1
    s_waitcnt vmcnt(22) lgkmcnt(0)
    v_mfma_f32_32x32x16_bf16 v[64:79], v[176:179], v[252:255], v[64:79]
    s_waitcnt vmcnt(24)
    s_barrier
    ds_read_b64_tr_b16 v[160:161], v20 offset:49152
    ds_read_b64_tr_b16 v[162:163], v20 offset:50176
    ds_read_b64_tr_b16 v[164:165], v21 offset:49152
    ds_read_b64_tr_b16 v[166:167], v21 offset:50176
    ds_read_b64_tr_b16 v[168:169], v22 offset:49152
    ds_read_b64_tr_b16 v[170:171], v22 offset:50176
    ds_read_b64_tr_b16 v[172:173], v23 offset:49152
    ds_read_b64_tr_b16 v[174:175], v23 offset:50176
    v_mfma_f32_32x32x16_bf16 v[80:95], v[180:183], v[252:255], v[80:95]
    s_add_u32 s4, s22, 0x2c00
    buffer_store_dwordx4 v[60:63], v12, s[8:11], s4 offen sc1
    v_mfma_f32_32x32x16_bf16 v[128:143], v[184:187], v[252:255], v[128:143]
    v_mfma_f32_32x32x16_bf16 v[144:159], v[188:191], v[252:255], v[144:159]
    s_add_u32 s4, s31, 23552
    buffer_load_dwordx4 v[252:255], v12, s[52:55], s4 offen sc1
    ds_read_b64_tr_b16 v[176:177], v20 offset:53248
    ds_read_b64_tr_b16 v[178:179], v20 offset:54272
    ds_read_b64_tr_b16 v[180:181], v21 offset:53248
    ds_read_b64_tr_b16 v[182:183], v21 offset:54272
    ds_read_b64_tr_b16 v[184:185], v22 offset:53248
    ds_read_b64_tr_b16 v[186:187], v22 offset:54272
    ds_read_b64_tr_b16 v[188:189], v23 offset:53248
    ds_read_b64_tr_b16 v[190:191], v23 offset:54272
    s_waitcnt vmcnt(18) lgkmcnt(8)
    v_mfma_f32_32x32x16_bf16 v[64:79], v[160:163], v[208:211], v[64:79]
    s_add_u32 s4, s23, 0x1000000
    buffer_store_dwordx4 v[96:99], v12, s[8:11], s4 offen sc1
    v_mfma_f32_32x32x16_bf16 v[80:95], v[164:167], v[208:211], v[80:95]
    v_mfma_f32_32x32x16_bf16 v[128:143], v[168:171], v[208:211], v[128:143]
    v_mfma_f32_32x32x16_bf16 v[144:159], v[172:175], v[208:211], v[144:159]
    s_add_u32 s4, s31, 24576
    buffer_load_dwordx4 v[208:211], v12, s[52:55], s4 offen sc1
    ds_read_b64_tr_b16 v[160:161], v20 offset:57344
    ds_read_b64_tr_b16 v[162:163], v20 offset:58368
    ds_read_b64_tr_b16 v[164:165], v21 offset:57344
    ds_read_b64_tr_b16 v[166:167], v21 offset:58368
    ds_read_b64_tr_b16 v[168:169], v22 offset:57344
    ds_read_b64_tr_b16 v[170:171], v22 offset:58368
    ds_read_b64_tr_b16 v[172:173], v23 offset:57344
    ds_read_b64_tr_b16 v[174:175], v23 offset:58368
    s_waitcnt vmcnt(19) lgkmcnt(8)
    v_mfma_f32_32x32x16_bf16 v[64:79], v[176:179], v[212:215], v[64:79]
    v_mfma_f32_32x32x16_bf16 v[80:95], v[180:183], v[212:215], v[80:95]
    v_mfma_f32_32x32x16_bf16 v[128:143], v[184:187], v[212:215], v[128:143]
    v_mfma_f32_32x32x16_bf16 v[144:159], v[188:191], v[212:215], v[144:159]
    s_add_u32 s4, s31, 25600
    buffer_load_dwordx4 v[212:215], v12, s[52:55], s4 offen sc1
    ds_read_b64_tr_b16 v[176:177], v20 offset:61440
    ds_read_b64_tr_b16 v[178:179], v20 offset:62464
    ds_read_b64_tr_b16 v[180:181], v21 offset:61440
    ds_read_b64_tr_b16 v[182:183], v21 offset:62464
    ds_read_b64_tr_b16 v[184:185], v22 offset:61440
    ds_read_b64_tr_b16 v[186:187], v22 offset:62464
    ds_read_b64_tr_b16 v[188:189], v23 offset:61440
    ds_read_b64_tr_b16 v[190:191], v23 offset:62464
    s_waitcnt vmcnt(18) lgkmcnt(8)
    v_mfma_f32_32x32x16_bf16 v[64:79], v[160:163], v[216:219], v[64:79]
    s_add_u32 s4, s23, 0x1001000
    buffer_store_dwordx4 v[100:103], v12, s[8:11], s4 offen sc1
    v_mfma_f32_32x32x16_bf16 v[80:95], v[164:167], v[216:219], v[80:95]
    v_mfma_f32_32x32x16_bf16 v[128:143], v[168:171], v[216:219], v[128:143]
    v_mfma_f32_32x32x16_bf16 v[144:159], v[172:175], v[216:219], v[144:159]
    s_add_u32 s4, s31, 26624
    buffer_load_dwordx4 v[216:219], v12, s[52:55], s4 offen sc1
    v_add_u32 v20, 0xffff0000, v20
    v_add_u32 v21, 0xffff0000, v21
    v_add_u32 v22, 0xffff0000, v22
    v_add_u32 v23, 0xffff0000, v23
    ds_read_b64_tr_b16 v[160:161], v20 offset:49152
    ds_read_b64_tr_b16 v[162:163], v20 offset:50176
    ds_read_b64_tr_b16 v[164:165], v21 offset:49152
    ds_read_b64_tr_b16 v[166:167], v21 offset:50176
    ds_read_b64_tr_b16 v[168:169], v22 offset:49152
    ds_read_b64_tr_b16 v[170:171], v22 offset:50176
    ds_read_b64_tr_b16 v[172:173], v23 offset:49152
    ds_read_b64_tr_b16 v[174:175], v23 offset:50176
    s_waitcnt vmcnt(18) lgkmcnt(8)
    v_mfma_f32_32x32x16_bf16 v[64:79], v[176:179], v[220:223], v[64:79]
    s_add_u32 s4, s23, 0x1000400
    buffer_store_dwordx4 v[104:107], v12, s[8:11], s4 offen sc1
    v_mfma_f32_32x32x16_bf16 v[80:95], v[180:183], v[220:223], v[80:95]
    v_mfma_f32_32x32x16_bf16 v[128:143], v[184:187], v[220:223], v[128:143]
    v_mfma_f32_32x32x16_bf16 v[144:159], v[188:191], v[220:223], v[144:159]
    s_add_u32 s4, s31, 27648
    buffer_load_dwordx4 v[220:223], v12, s[52:55], s4 offen sc1
    ds_read_b64_tr_b16 v[176:177], v20 offset:53248
    ds_read_b64_tr_b16 v[178:179], v20 offset:54272
    ds_read_b64_tr_b16 v[180:181], v21 offset:53248
    ds_read_b64_tr_b16 v[182:183], v21 offset:54272
    ds_read_b64_tr_b16 v[184:185], v22 offset:53248
    ds_read_b64_tr_b16 v[186:187], v22 offset:54272
    ds_read_b64_tr_b16 v[188:189], v23 offset:53248
    ds_read_b64_tr_b16 v[190:191], v23 offset:54272
    s_waitcnt vmcnt(19) lgkmcnt(8)
    v_mfma_f32_32x32x16_bf16 v[64:79], v[160:163], v[224:227], v[64:79]
    v_mfma_f32_32x32x16_bf16 v[80:95], v[164:167], v[224:227], v[80:95]
    v_mfma_f32_32x32x16_bf16 v[128:143], v[168:171], v[224:227], v[128:143]
    v_mfma_f32_32x32x16_bf16 v[144:159], v[172:175], v[224:227], v[144:159]
    s_add_u32 s4, s31, 28672
    buffer_load_dwordx4 v[224:227], v12, s[52:55], s4 offen sc1
    ds_read_b64_tr_b16 v[160:161], v20 offset:57344
    ds_read_b64_tr_b16 v[162:163], v20 offset:58368
    ds_read_b64_tr_b16 v[164:165], v21 offset:57344
    ds_read_b64_tr_b16 v[166:167], v21 offset:58368
    ds_read_b64_tr_b16 v[168:169], v22 offset:57344
    ds_read_b64_tr_b16 v[170:171], v22 offset:58368
    ds_read_b64_tr_b16 v[172:173], v23 offset:57344
    ds_read_b64_tr_b16 v[174:175], v23 offset:58368
    s_waitcnt vmcnt(18) lgkmcnt(8)
    v_mfma_f32_32x32x16_bf16 v[64:79], v[176:179], v[228:231], v[64:79]
    s_add_u32 s4, s23, 0x1001400
    buffer_store_dwordx4 v[108:111], v12, s[8:11], s4 offen sc1
    v_mfma_f32_32x32x16_bf16 v[80:95], v[180:183], v[228:231], v[80:95]
    v_mfma_f32_32x32x16_bf16 v[128:143], v[184:187], v[228:231], v[128:143]
    v_mfma_f32_32x32x16_bf16 v[144:159], v[188:191], v[228:231], v[144:159]
    s_add_u32 s4, s31, 29696
    buffer_load_dwordx4 v[228:231], v12, s[52:55], s4 offen sc1
    ds_read_b64_tr_b16 v[176:177], v20 offset:61440
    ds_read_b64_tr_b16 v[178:179], v20 offset:62464
    ds_read_b64_tr_b16 v[180:181], v21 offset:61440
    ds_read_b64_tr_b16 v[182:183], v21 offset:62464
    ds_read_b64_tr_b16 v[184:185], v22 offset:61440
    ds_read_b64_tr_b16 v[186:187], v22 offset:62464
    ds_read_b64_tr_b16 v[188:189], v23 offset:61440
    ds_read_b64_tr_b16 v[190:191], v23 offset:62464
    s_waitcnt vmcnt(18) lgkmcnt(8)
    v_mfma_f32_32x32x16_bf16 v[64:79], v[160:163], v[232:235], v[64:79]
    s_add_u32 s4, s23, 0x1002000
    buffer_store_dwordx4 v[112:115], v12, s[8:11], s4 offen sc1
    v_mfma_f32_32x32x16_bf16 v[80:95], v[164:167], v[232:235], v[80:95]
    v_mfma_f32_32x32x16_bf16 v[128:143], v[168:171], v[232:235], v[128:143]
    v_mfma_f32_32x32x16_bf16 v[144:159], v[172:175], v[232:235], v[144:159]
    s_add_u32 s4, s31, 30720
    buffer_load_dwordx4 v[232:235], v12, s[52:55], s4 offen sc1
    v_add_u32 v20, 0x20000, v20
    v_add_u32 v21, 0x20000, v21
    v_add_u32 v22, 0x20000, v22
    v_add_u32 v23, 0x20000, v23
    ds_read_b64_tr_b16 v[160:161], v20 offset:0
    ds_read_b64_tr_b16 v[162:163], v20 offset:1024
    ds_read_b64_tr_b16 v[164:165], v21 offset:0
    ds_read_b64_tr_b16 v[166:167], v21 offset:1024
    ds_read_b64_tr_b16 v[168:169], v22 offset:0
    ds_read_b64_tr_b16 v[170:171], v22 offset:1024
    ds_read_b64_tr_b16 v[172:173], v23 offset:0
    ds_read_b64_tr_b16 v[174:175], v23 offset:1024
    s_waitcnt vmcnt(19) lgkmcnt(8)
    v_mfma_f32_32x32x16_bf16 v[64:79], v[176:179], v[236:239], v[64:79]
    v_mfma_f32_32x32x16_bf16 v[80:95], v[180:183], v[236:239], v[80:95]
    v_mfma_f32_32x32x16_bf16 v[128:143], v[184:187], v[236:239], v[128:143]
    v_mfma_f32_32x32x16_bf16 v[144:159], v[188:191], v[236:239], v[144:159]
    s_add_u32 s4, s31, 31744
    buffer_load_dwordx4 v[236:239], v12, s[52:55], s4 offen sc1
    ds_read_b64_tr_b16 v[176:177], v20 offset:4096
    ds_read_b64_tr_b16 v[178:179], v20 offset:5120
    ds_read_b64_tr_b16 v[180:181], v21 offset:4096
    ds_read_b64_tr_b16 v[182:183], v21 offset:5120
    ds_read_b64_tr_b16 v[184:185], v22 offset:4096
    ds_read_b64_tr_b16 v[186:187], v22 offset:5120
    ds_read_b64_tr_b16 v[188:189], v23 offset:4096
    ds_read_b64_tr_b16 v[190:191], v23 offset:5120
    s_waitcnt vmcnt(18) lgkmcnt(8)
    v_mfma_f32_32x32x16_bf16 v[64:79], v[160:163], v[240:243], v[64:79]
    s_add_u32 s4, s23, 0x1003000
    buffer_store_dwordx4 v[116:119], v12, s[8:11], s4 offen sc1
    v_mfma_f32_32x32x16_bf16 v[80:95], v[164:167], v[240:243], v[80:95]
    v_mfma_f32_32x32x16_bf16 v[128:143], v[168:171], v[240:243], v[128:143]
    v_mfma_f32_32x32x16_bf16 v[144:159], v[172:175], v[240:243], v[144:159]
    ds_read_b64_tr_b16 v[160:161], v20 offset:8192
    ds_read_b64_tr_b16 v[162:163], v20 offset:9216
    ds_read_b64_tr_b16 v[164:165], v21 offset:8192
    ds_read_b64_tr_b16 v[166:167], v21 offset:9216
    ds_read_b64_tr_b16 v[168:169], v22 offset:8192
    ds_read_b64_tr_b16 v[170:171], v22 offset:9216
    ds_read_b64_tr_b16 v[172:173], v23 offset:8192
    ds_read_b64_tr_b16 v[174:175], v23 offset:9216
    s_waitcnt vmcnt(17) lgkmcnt(8)
    v_mfma_f32_32x32x16_bf16 v[64:79], v[176:179], v[244:247], v[64:79]
    s_add_u32 s4, s23, 0x1002400
    buffer_store_dwordx4 v[120:123], v12, s[8:11], s4 offen sc1
    v_mfma_f32_32x32x16_bf16 v[80:95], v[180:183], v[244:247], v[80:95]
    v_mfma_f32_32x32x16_bf16 v[128:143], v[184:187], v[244:247], v[128:143]
    v_mfma_f32_32x32x16_bf16 v[144:159], v[188:191], v[244:247], v[144:159]
    ds_read_b64_tr_b16 v[176:177], v20 offset:12288
    ds_read_b64_tr_b16 v[178:179], v20 offset:13312
    ds_read_b64_tr_b16 v[180:181], v21 offset:12288
    ds_read_b64_tr_b16 v[182:183], v21 offset:13312
    ds_read_b64_tr_b16 v[184:185], v22 offset:12288
    ds_read_b64_tr_b16 v[186:187], v22 offset:13312
    ds_read_b64_tr_b16 v[188:189], v23 offset:12288
    ds_read_b64_tr_b16 v[190:191], v23 offset:13312
    s_waitcnt vmcnt(17) lgkmcnt(8)
    v_mfma_f32_32x32x16_bf16 v[64:79], v[160:163], v[248:251], v[64:79]
    v_mfma_f32_32x32x16_bf16 v[80:95], v[164:167], v[248:251], v[80:95]
    v_mfma_f32_32x32x16_bf16 v[128:143], v[168:171], v[248:251], v[128:143]
    v_mfma_f32_32x32x16_bf16 v[144:159], v[172:175], v[248:251], v[144:159]
    s_waitcnt vmcnt(15) lgkmcnt(0)
    v_mfma_f32_32x32x16_bf16 v[64:79], v[176:179], v[252:255], v[64:79]
    s_waitcnt vmcnt(16)
    s_barrier
    v_add_u32 v20, 0xfffe0000, v20
    v_add_u32 v21, 0xfffe0000, v21
    v_add_u32 v22, 0xfffe0000, v22
    v_add_u32 v23, 0xfffe0000, v23
    ds_read_b64_tr_b16 v[160:161], v20 offset:0
    ds_read_b64_tr_b16 v[162:163], v20 offset:1024
    ds_read_b64_tr_b16 v[164:165], v21 offset:0
    ds_read_b64_tr_b16 v[166:167], v21 offset:1024
    ds_read_b64_tr_b16 v[168:169], v22 offset:0
    ds_read_b64_tr_b16 v[170:171], v22 offset:1024
    ds_read_b64_tr_b16 v[172:173], v23 offset:0
    ds_read_b64_tr_b16 v[174:175], v23 offset:1024
    v_mfma_f32_32x32x16_bf16 v[80:95], v[180:183], v[252:255], v[80:95]
    ds_write_b128 v192, v[32:35] offset:0
    s_add_u32 s4, s23, 0x1003400
    buffer_store_dwordx4 v[124:127], v12, s[8:11], s4 offen sc1
    v_mfma_f32_32x32x16_bf16 v[128:143], v[184:187], v[252:255], v[128:143]
    ds_write_b128 v192, v[36:39] offset:1024
    v_mov_b32 v4, 3
    v_mov_b32 v5, 0x7f000000
    v_cmp_eq_u32 vcc, 0x0, v9
    s_nop 1
    v_cndmask_b32 v5, v5, 0, vcc
    buffer_store_dword v4, v5, s[56:59], s40 offen sc1
    v_mfma_f32_32x32x16_bf16 v[144:159], v[188:191], v[252:255], v[144:159]
    ds_write_b128 v192, v[40:43] offset:2048
    ds_read_b64_tr_b16 v[176:177], v20 offset:4096
    ds_read_b64_tr_b16 v[178:179], v20 offset:5120
    ds_read_b64_tr_b16 v[180:181], v21 offset:4096
    ds_read_b64_tr_b16 v[182:183], v21 offset:5120
    ds_read_b64_tr_b16 v[184:185], v22 offset:4096
    ds_read_b64_tr_b16 v[186:187], v22 offset:5120
    ds_read_b64_tr_b16 v[188:189], v23 offset:4096
    ds_read_b64_tr_b16 v[190:191], v23 offset:5120
    s_waitcnt vmcnt(15) lgkmcnt(8)
    v_mfma_f32_32x32x16_bf16 v[64:79], v[160:163], v[208:211], v[64:79]
    ds_write_b128 v192, v[44:47] offset:3072
    v_mfma_f32_32x32x16_bf16 v[80:95], v[164:167], v[208:211], v[80:95]
    ds_write_b128 v192, v[48:51] offset:8192
    v_mfma_f32_32x32x16_bf16 v[128:143], v[168:171], v[208:211], v[128:143]
    ds_write_b128 v192, v[52:55] offset:9216
    v_mfma_f32_32x32x16_bf16 v[144:159], v[172:175], v[208:211], v[144:159]
    ds_write_b128 v192, v[56:59] offset:10240
    ds_read_b64_tr_b16 v[160:161], v20 offset:8192
    ds_read_b64_tr_b16 v[162:163], v20 offset:9216
    ds_read_b64_tr_b16 v[164:165], v21 offset:8192
    ds_read_b64_tr_b16 v[166:167], v21 offset:9216
    ds_read_b64_tr_b16 v[168:169], v22 offset:8192
    ds_read_b64_tr_b16 v[170:171], v22 offset:9216
    ds_read_b64_tr_b16 v[172:173], v23 offset:8192
    ds_read_b64_tr_b16 v[174:175], v23 offset:9216
    s_waitcnt vmcnt(14) lgkmcnt(8)
    v_mfma_f32_32x32x16_bf16 v[64:79], v[176:179], v[212:215], v[64:79]
    ds_write_b128 v192, v[60:63] offset:11264
    v_mfma_f32_32x32x16_bf16 v[80:95], v[180:183], v[212:215], v[80:95]
    s_cmp_ge_u32 s20, 4
    s_cbranch_scc1 L_kva_ow00
    ds_write_b128 v193, v[96:99] offset:0
    ds_write_b128 v193, v[100:103] offset:4096
L_kva_ow00:
    v_mfma_f32_32x32x16_bf16 v[128:143], v[184:187], v[212:215], v[128:143]
    s_cmp_ge_u32 s20, 4
    s_cbranch_scc1 L_kva_ow01
    ds_write_b128 v193, v[104:107] offset:1024
    ds_write_b128 v193, v[108:111] offset:5120
L_kva_ow01:
    v_mfma_f32_32x32x16_bf16 v[144:159], v[188:191], v[212:215], v[144:159]
    s_cmp_ge_u32 s20, 4
    s_cbranch_scc1 L_kva_ow10
    ds_write_b128 v193, v[112:115] offset:8192
    ds_write_b128 v193, v[116:119] offset:12288
L_kva_ow10:
    ds_read_b64_tr_b16 v[176:177], v20 offset:12288
    ds_read_b64_tr_b16 v[178:179], v20 offset:13312
    ds_read_b64_tr_b16 v[180:181], v21 offset:12288
    ds_read_b64_tr_b16 v[182:183], v21 offset:13312
    ds_read_b64_tr_b16 v[184:185], v22 offset:12288
    ds_read_b64_tr_b16 v[186:187], v22 offset:13312
    ds_read_b64_tr_b16 v[188:189], v23 offset:12288
    ds_read_b64_tr_b16 v[190:191], v23 offset:13312
    s_waitcnt vmcnt(12) lgkmcnt(8)
    v_mfma_f32_32x32x16_bf16 v[64:79], v[160:163], v[216:219], v[64:79]
    s_cmp_ge_u32 s20, 4
    s_cbranch_scc1 L_kva_ow11
    ds_write_b128 v193, v[120:123] offset:9216
    ds_write_b128 v193, v[124:127] offset:13312
L_kva_ow11:
    v_mfma_f32_32x32x16_bf16 v[80:95], v[164:167], v[216:219], v[80:95]
    v_mfma_f32_32x32x16_bf16 v[128:143], v[168:171], v[216:219], v[128:143]
    v_mfma_f32_32x32x16_bf16 v[144:159], v[172:175], v[216:219], v[144:159]
    ds_read_b64_tr_b16 v[160:161], v20 offset:16384
    ds_read_b64_tr_b16 v[162:163], v20 offset:17408
    ds_read_b64_tr_b16 v[164:165], v21 offset:16384
    ds_read_b64_tr_b16 v[166:167], v21 offset:17408
    ds_read_b64_tr_b16 v[168:169], v22 offset:16384
    ds_read_b64_tr_b16 v[170:171], v22 offset:17408
    ds_read_b64_tr_b16 v[172:173], v23 offset:16384
    ds_read_b64_tr_b16 v[174:175], v23 offset:17408
    s_waitcnt vmcnt(10) lgkmcnt(8)
    v_mfma_f32_32x32x16_bf16 v[64:79], v[176:179], v[220:223], v[64:79]
    v_mfma_f32_32x32x16_bf16 v[80:95], v[180:183], v[220:223], v[80:95]
    v_mfma_f32_32x32x16_bf16 v[128:143], v[184:187], v[220:223], v[128:143]
    v_mfma_f32_32x32x16_bf16 v[144:159], v[188:191], v[220:223], v[144:159]
    ds_read_b64_tr_b16 v[176:177], v20 offset:20480
    ds_read_b64_tr_b16 v[178:179], v20 offset:21504
    ds_read_b64_tr_b16 v[180:181], v21 offset:20480
    ds_read_b64_tr_b16 v[182:183], v21 offset:21504
    ds_read_b64_tr_b16 v[184:185], v22 offset:20480
    ds_read_b64_tr_b16 v[186:187], v22 offset:21504
    ds_read_b64_tr_b16 v[188:189], v23 offset:20480
    ds_read_b64_tr_b16 v[190:191], v23 offset:21504
    s_waitcnt vmcnt(9) lgkmcnt(8)
    v_mfma_f32_32x32x16_bf16 v[64:79], v[160:163], v[224:227], v[64:79]
    v_mfma_f32_32x32x16_bf16 v[80:95], v[164:167], v[224:227], v[80:95]
    v_mfma_f32_32x32x16_bf16 v[128:143], v[168:171], v[224:227], v[128:143]
    v_mfma_f32_32x32x16_bf16 v[144:159], v[172:175], v[224:227], v[144:159]
    ds_read_b64_tr_b16 v[160:161], v20 offset:24576
    ds_read_b64_tr_b16 v[162:163], v20 offset:25600
    ds_read_b64_tr_b16 v[164:165], v21 offset:24576
    ds_read_b64_tr_b16 v[166:167], v21 offset:25600
    ds_read_b64_tr_b16 v[168:169], v22 offset:24576
    ds_read_b64_tr_b16 v[170:171], v22 offset:25600
    ds_read_b64_tr_b16 v[172:173], v23 offset:24576
    ds_read_b64_tr_b16 v[174:175], v23 offset:25600
    s_waitcnt vmcnt(7) lgkmcnt(8)
    v_mfma_f32_32x32x16_bf16 v[64:79], v[176:179], v[228:231], v[64:79]
    v_mfma_f32_32x32x16_bf16 v[80:95], v[180:183], v[228:231], v[80:95]
    v_mfma_f32_32x32x16_bf16 v[128:143], v[184:187], v[228:231], v[128:143]
    v_mfma_f32_32x32x16_bf16 v[144:159], v[188:191], v[228:231], v[144:159]
    ds_read_b64_tr_b16 v[176:177], v20 offset:28672
    ds_read_b64_tr_b16 v[178:179], v20 offset:29696
    ds_read_b64_tr_b16 v[180:181], v21 offset:28672
    ds_read_b64_tr_b16 v[182:183], v21 offset:29696
    ds_read_b64_tr_b16 v[184:185], v22 offset:28672
    ds_read_b64_tr_b16 v[186:187], v22 offset:29696
    ds_read_b64_tr_b16 v[188:189], v23 offset:28672
    ds_read_b64_tr_b16 v[190:191], v23 offset:29696
    s_waitcnt vmcnt(5) lgkmcnt(8)
    v_mfma_f32_32x32x16_bf16 v[64:79], v[160:163], v[232:235], v[64:79]
    v_mfma_f32_32x32x16_bf16 v[80:95], v[164:167], v[232:235], v[80:95]
    v_mfma_f32_32x32x16_bf16 v[128:143], v[168:171], v[232:235], v[128:143]
    v_mfma_f32_32x32x16_bf16 v[144:159], v[172:175], v[232:235], v[144:159]
    s_waitcnt vmcnt(4) lgkmcnt(0)
    v_mfma_f32_32x32x16_bf16 v[64:79], v[176:179], v[236:239], v[64:79]
    v_mfma_f32_32x32x16_bf16 v[80:95], v[180:183], v[236:239], v[80:95]
    v_mfma_f32_32x32x16_bf16 v[128:143], v[184:187], v[236:239], v[128:143]
    v_mfma_f32_32x32x16_bf16 v[144:159], v[188:191], v[236:239], v[144:159]
    s_barrier
    s_lshl_b32 s4, s16, 10
    s_add_u32 s4, s4, 0x10000
    v_lshlrev_b32 v22, 7, v0
    v_add_u32 v22, s4, v22
    v_mov_b32 v7, 0x7f000000
    v_cmp_gt_u32 vcc, 8, v0
    s_nop 1
    v_cndmask_b32 v22, v7, v22, vcc
    v_cndmask_b32 v23, 0, 3, vcc
    buffer_load_dword v21, v22, s[56:59], 0 offen sc1
    s_lshl_b32 s4, s50, 13
    s_add_u32 s5, s4, 131072
    s_add_u32 s6, s4, 0
    s_cmp_eq_u32 s46, 0
    s_cselect_b32 s7, s6, s5
    v_add_u32 v6, s6, v12
    v_add_u32 v252, s5, v12
    v_add_u32 v5, s7, v12
    s_add_u32 s6, s4, 98304
    s_add_u32 s7, s4, 0x4000
    s_cmp_lt_u32 s50, 2
    s_cselect_b32 s6, s6, s7
    s_lshl_b32 s7, s46, 14
    s_add_u32 s6, s6, s7
    v_add_u32 v253, s6, v12
    s_add_u32 s6, s4, 65536
    s_add_u32 s7, s4, 0xffffc000
    s_cmp_lt_u32 s50, 2
    s_cselect_b32 s6, s6, s7
    s_lshl_b32 s7, s46, 14
    s_add_u32 s6, s6, s7
    v_add_u32 v254, s6, v12
    s_mov_b32 s28, 0x3e0293ee
    s_nop 7
    v_pk_mul_f32 v[64:65], v[64:65], s[28:29] op_sel_hi:[1,0]
    v_cvt_pk_bf16_f32 v32, v64, v65
    v_pk_mul_f32 v[66:67], v[66:67], s[28:29] op_sel_hi:[1,0]
    v_cvt_pk_bf16_f32 v33, v66, v67
    v_pk_mul_f32 v[68:69], v[68:69], s[28:29] op_sel_hi:[1,0]
    v_cvt_pk_bf16_f32 v34, v68, v69
    v_pk_mul_f32 v[70:71], v[70:71], s[28:29] op_sel_hi:[1,0]
    v_cvt_pk_bf16_f32 v35, v70, v71
    ds_write_b128 v5, v[32:35] offset:0
    v_pk_mul_f32 v[72:73], v[72:73], s[28:29] op_sel_hi:[1,0]
    v_cvt_pk_bf16_f32 v36, v72, v73
    v_pk_mul_f32 v[74:75], v[74:75], s[28:29] op_sel_hi:[1,0]
    v_cvt_pk_bf16_f32 v37, v74, v75
    v_pk_mul_f32 v[76:77], v[76:77], s[28:29] op_sel_hi:[1,0]
    v_cvt_pk_bf16_f32 v38, v76, v77
    v_pk_mul_f32 v[78:79], v[78:79], s[28:29] op_sel_hi:[1,0]
    v_cvt_pk_bf16_f32 v39, v78, v79
    ds_write_b128 v5, v[36:39] offset:1024
    v_pk_mul_f32 v[80:81], v[80:81], s[28:29] op_sel_hi:[1,0]
    v_cvt_pk_bf16_f32 v40, v80, v81
    v_pk_mul_f32 v[82:83], v[82:83], s[28:29] op_sel_hi:[1,0]
    v_cvt_pk_bf16_f32 v41, v82, v83
    v_pk_mul_f32 v[84:85], v[84:85], s[28:29] op_sel_hi:[1,0]
    v_cvt_pk_bf16_f32 v42, v84, v85
    v_pk_mul_f32 v[86:87], v[86:87], s[28:29] op_sel_hi:[1,0]
    v_cvt_pk_bf16_f32 v43, v86, v87
    ds_write_b128 v5, v[40:43] offset:2048
    v_pk_mul_f32 v[88:89], v[88:89], s[28:29] op_sel_hi:[1,0]
    v_cvt_pk_bf16_f32 v44, v88, v89
    v_pk_mul_f32 v[90:91], v[90:91], s[28:29] op_sel_hi:[1,0]
    v_cvt_pk_bf16_f32 v45, v90, v91
    v_pk_mul_f32 v[92:93], v[92:93], s[28:29] op_sel_hi:[1,0]
    v_cvt_pk_bf16_f32 v46, v92, v93
    v_pk_mul_f32 v[94:95], v[94:95], s[28:29] op_sel_hi:[1,0]
    v_cvt_pk_bf16_f32 v47, v94, v95
    ds_write_b128 v5, v[44:47] offset:3072
    v_pk_mul_f32 v[128:129], v[128:129], s[28:29] op_sel_hi:[1,0]
    v_cvt_pk_bf16_f32 v48, v128, v129
    v_pk_mul_f32 v[130:131], v[130:131], s[28:29] op_sel_hi:[1,0]
    v_cvt_pk_bf16_f32 v49, v130, v131
    v_pk_mul_f32 v[132:133], v[132:133], s[28:29] op_sel_hi:[1,0]
    v_cvt_pk_bf16_f32 v50, v132, v133
    v_pk_mul_f32 v[134:135], v[134:135], s[28:29] op_sel_hi:[1,0]
    v_cvt_pk_bf16_f32 v51, v134, v135
    ds_write_b128 v5, v[48:51] offset:4096
    v_pk_mul_f32 v[136:137], v[136:137], s[28:29] op_sel_hi:[1,0]
    v_cvt_pk_bf16_f32 v52, v136, v137
    v_pk_mul_f32 v[138:139], v[138:139], s[28:29] op_sel_hi:[1,0]
    v_cvt_pk_bf16_f32 v53, v138, v139
    v_pk_mul_f32 v[140:141], v[140:141], s[28:29] op_sel_hi:[1,0]
    v_cvt_pk_bf16_f32 v54, v140, v141
    v_pk_mul_f32 v[142:143], v[142:143], s[28:29] op_sel_hi:[1,0]
    v_cvt_pk_bf16_f32 v55, v142, v143
    ds_write_b128 v5, v[52:55] offset:5120
    v_pk_mul_f32 v[144:145], v[144:145], s[28:29] op_sel_hi:[1,0]
    v_cvt_pk_bf16_f32 v56, v144, v145
    v_pk_mul_f32 v[146:147], v[146:147], s[28:29] op_sel_hi:[1,0]
    v_cvt_pk_bf16_f32 v57, v146, v147
    v_pk_mul_f32 v[148:149], v[148:149], s[28:29] op_sel_hi:[1,0]
    v_cvt_pk_bf16_f32 v58, v148, v149
    v_pk_mul_f32 v[150:151], v[150:151], s[28:29] op_sel_hi:[1,0]
    v_cvt_pk_bf16_f32 v59, v150, v151
    ds_write_b128 v5, v[56:59] offset:6144
    v_pk_mul_f32 v[152:153], v[152:153], s[28:29] op_sel_hi:[1,0]
    v_cvt_pk_bf16_f32 v60, v152, v153
    v_pk_mul_f32 v[154:155], v[154:155], s[28:29] op_sel_hi:[1,0]
    v_cvt_pk_bf16_f32 v61, v154, v155
    v_pk_mul_f32 v[156:157], v[156:157], s[28:29] op_sel_hi:[1,0]
    v_cvt_pk_bf16_f32 v62, v156, v157
    v_pk_mul_f32 v[158:159], v[158:159], s[28:29] op_sel_hi:[1,0]
    v_cvt_pk_bf16_f32 v63, v158, v159
    ds_write_b128 v5, v[60:63] offset:7168
    s_mov_b32 s28, 0x3f803f80
    s_lshl_b32 s7, s46, 14
    s_add_u32 s6, s7, 65536
    v_add_u32 v20, s6, v12
    s_lshl_b32 s6, s46, 11
    s_add_u32 s5, s7, s6
    v_add_u32 v16, s5, v12
    s_sub_u32 s5, s7, s6
    v_add_u32 v17, s5, v12
    s_mov_b32 s31, 0x41000000
    s_mov_b32 s52, 0x42c80000
    s_mov_b32 s47, 0
    s_sub_u32 s51, 15, s17
    s_mov_b32 s25, 0x7f000000
    s_mov_b32 s19, 2
    s_add_u32 s27, s51, 1
    s_lshl_b32 s22, s51, 7
    s_lshl_b32 s23, s50, 5
    s_add_u32 s22, s22, s23
    v_add_u32 v4, s22, v2
    v_lshlrev_b32 v7, 2, v3
    v_sub_u32 v15, v4, v7
    s_lshl_b32 s22, s17, 7
    s_add_u32 s22, s22, s23
    v_add_u32 v13, s22, v2
    s_lshl_b32 s4, s16, 13
    s_lshl_b32 s5, s46, 12
    s_add_u32 s4, s4, s5
    s_lshl_b32 s5, s50, 18
    s_add_u32 s4, s4, s5
    s_lshl_b32 s5, s51, 20
    s_add_u32 s22, s4, s5
    s_lshl_b32 s5, s17, 20
    s_add_u32 s23, s4, s5
    s_mov_b32 s53, s40
    s_mov_b32 s54, 4
    v_mov_b32 v25, 0x7f000000
    v_cmp_eq_u32 vcc, 0, v9
    s_nop 1
    v_cndmask_b32 v25, v25, 0, vcc
    s_and_b32 s4, s2, 7
    s_lshl_b32 s4, s4, 5
    s_lshr_b32 s5, s2, 3
    s_add_u32 s4, s4, s5
    s_lshr_b32 s5, s4, 4
    s_bfe_u32 s6, s4, 0x10003
    s_lshl_b32 s6, s6, 4
    s_add_u32 s5, s5, s6
    s_and_b32 s4, s4, 7
    s_lshl_b32 s6, s5, 3
    s_add_u32 s6, s6, s20
    s_lshl_b32 s44, s6, 15
    s_lshl_b32 s7, s4, 9
    s_add_u32 s44, s44, s7
    s_lshr_b32 s6, s6, 2
    s_lshl_b32 s48, s6, 17
    s_lshl_b32 s7, s4, 14
    s_add_u32 s48, s48, s7
    s_and_b32 s7, s20, 3
    s_lshl_b32 s7, s7, 7
    s_add_u32 s48, s48, s7
    s_add_u32 s48, s48, 0x37ff000
    s_mov_b32 s45, 0
    s_mov_b32 s55, 0x7f000000
    v_and_b32 v18, 7, v0
    v_lshrrev_b32 v7, 3, v0
    v_lshlrev_b32 v19, 4, v18
    v_lshlrev_b32 v18, 12, v18
    v_lshl_add_u32 v18, v7, 4, v18
    v_lshl_add_u32 v19, v7, 9, v19
    s_mov_b32 s36, s80
    s_mov_b32 s37, s81
    s_mov_b32 s38, 0x800000
    s_mov_b32 s39, 0x00020000
    s_mov_b32 s66, s74
    s_mov_b32 s67, s75
    s_mov_b32 s68, s78
    s_mov_b32 s69, s79
    s_mov_b32 s86, s80
    s_mov_b32 s87, s81
    s_bfe_u32 s4, s2, 0x30003
    s_lshl_b32 s4, s4, 19
    s_add_u32 s4, s4, 0x3000000
    s_bfe_u32 s5, s2, 0x20001
    s_add_u32 s6, s5, 0
    s_and_b32 s6, s6, 3
    s_lshl_b32 s6, s6, 3
    s_add_u32 s70, s20, s6
    s_lshl_b32 s6, s70, 14
    s_add_u32 s74, s4, s6
    s_add_u32 s6, s5, 1
    s_and_b32 s6, s6, 3
    s_lshl_b32 s6, s6, 3
    s_add_u32 s71, s20, s6
    s_lshl_b32 s6, s71, 14
    s_add_u32 s75, s4, s6
    s_add_u32 s6, s5, 2
    s_and_b32 s6, s6, 3
    s_lshl_b32 s6, s6, 3
    s_add_u32 s72, s20, s6
    s_lshl_b32 s6, s72, 14
    s_add_u32 s76, s4, s6
    s_add_u32 s6, s5, 3
    s_and_b32 s6, s6, 3
    s_lshl_b32 s6, s6, 3
    s_add_u32 s73, s20, s6
    s_lshl_b32 s6, s73, 14
    s_add_u32 s77, s4, s6
    s_lshl_b32 s5, s16, 19
    s_sub_u32 s78, s75, s5
    s_sub_u32 s79, s78, 0xffe000
    s_mov_b32 s80, 0x198fe
    v_and_b32 v7, 7, v0
    v_lshlrev_b32 v7, 12, v7
    v_lshrrev_b32 v248, 3, v0
    v_lshl_add_u32 v7, v248, 7, v7
    v_mov_b32 v248, 0x7f000000
    v_cmp_gt_u32 vcc, 32, v0
    s_nop 1
    v_cndmask_b32 v7, v248, v7, vcc
    buffer_load_dword v248, v7, s[36:39], s44 offen
    v_lshlrev_b32 v8, 2, v2
    v_and_b32 v9, 15, v0
    v_bfe_u32 v7, v0, 4, 1
    v_lshl_add_u32 v7, v9, 1, v7
    v_and_b32 v9, 19, v7
    v_bfe_u32 v26, v7, 2, 1
    v_lshl_add_u32 v9, v26, 3, v9
    v_bfe_u32 v26, v7, 3, 1
    v_lshl_add_u32 v9, v26, 2, v9
    v_lshlrev_b32 v9, 4, v9
    v_lshl_add_u32 v9, v3, 9, v9
    s_waitcnt vmcnt(3) lgkmcnt(0)
    s_barrier
    v_mov_b32 v24, 4
    buffer_store_dword v24, v25, s[56:59], s53 offen sc1
    ds_read_b128 v[32:35], v6 offset:0
    ds_read_b128 v[36:39], v6 offset:1024
    ds_read_b128 v[40:43], v6 offset:2048
    ds_read_b128 v[44:47], v6 offset:3072
    ds_read_b128 v[48:51], v6 offset:4096
    ds_read_b128 v[52:55], v6 offset:5120
    ds_read_b128 v[56:59], v6 offset:6144
    ds_read_b128 v[60:63], v6 offset:7168
    v_mov_b32 v14, 0
    v_mov_b32 v28, 0
    s_lshl_b32 s29, s46, 6
    s_sub_u32 s30, s27, 1
    s_mov_b32 s43, 0
    s_lshl_b32 s4, s51, 7
    s_add_u32 s29, s29, s4
    s_cmp_eq_u32 s17, 0
    s_cselect_b32 s30, 1, s30
    s_mov_b32 s43, 1
    ds_read_b128 v[80:83], v20 offset:0
    ds_read_b128 v[84:87], v20 offset:1024
    ds_read_b128 v[88:91], v20 offset:2048
    ds_read_b128 v[92:95], v20 offset:3072
    ds_read_b128 v[96:99], v20 offset:4096
    ds_read_b128 v[100:103], v20 offset:5120
    ds_read_b128 v[104:107], v20 offset:6144
    ds_read_b128 v[108:111], v20 offset:7168
    s_waitcnt lgkmcnt(7)
    v_mfma_f32_32x32x16_bf16 v[176:191], v[80:83], v[32:35], 0
    ds_read_b128 v[80:83], v20 offset:8192
    v_mov_b64 v[112:113], 0
    v_mov_b64 v[114:115], 0
    s_waitcnt lgkmcnt(7)
    v_mfma_f32_32x32x16_bf16 v[176:191], v[84:87], v[36:39], v[176:191]
    ds_read_b128 v[84:87], v20 offset:9216
    v_mov_b64 v[116:117], 0
    v_mov_b64 v[118:119], 0
    s_waitcnt lgkmcnt(7)
    v_mfma_f32_32x32x16_bf16 v[176:191], v[88:91], v[40:43], v[176:191]
    ds_read_b128 v[88:91], v20 offset:10240
    v_mov_b64 v[120:121], 0
    v_mov_b64 v[122:123], 0
    s_waitcnt lgkmcnt(7)
    v_mfma_f32_32x32x16_bf16 v[176:191], v[92:95], v[44:47], v[176:191]
    ds_read_b128 v[92:95], v20 offset:11264
    v_mov_b64 v[124:125], 0
    v_mov_b64 v[126:127], 0
    s_waitcnt lgkmcnt(7)
    v_mfma_f32_32x32x16_bf16 v[176:191], v[96:99], v[48:51], v[176:191]
    ds_read_b128 v[96:99], v20 offset:12288
    v_mov_b64 v[128:129], 0
    v_mov_b64 v[130:131], 0
    s_waitcnt lgkmcnt(7)
    v_mfma_f32_32x32x16_bf16 v[176:191], v[100:103], v[52:55], v[176:191]
    ds_read_b128 v[100:103], v20 offset:13312
    v_mov_b64 v[132:133], 0
    v_mov_b64 v[134:135], 0
    s_waitcnt lgkmcnt(7)
    v_mfma_f32_32x32x16_bf16 v[176:191], v[104:107], v[56:59], v[176:191]
    ds_read_b128 v[104:107], v20 offset:14336
    v_mov_b64 v[136:137], 0
    v_mov_b64 v[138:139], 0
    s_waitcnt lgkmcnt(7)
    v_mfma_f32_32x32x16_bf16 v[176:191], v[108:111], v[60:63], v[176:191]
    ds_read_b128 v[108:111], v20 offset:15360
    v_mov_b64 v[140:141], 0
    v_mov_b64 v[142:143], 0
    s_waitcnt lgkmcnt(7)
    v_mfma_f32_32x32x16_bf16 v[192:207], v[80:83], v[32:35], 0
    v_mov_b64 v[144:145], 0
    v_mov_b64 v[146:147], 0
    s_waitcnt lgkmcnt(6)
    v_mfma_f32_32x32x16_bf16 v[192:207], v[84:87], v[36:39], v[192:207]
    v_mov_b64 v[148:149], 0
    v_mov_b64 v[150:151], 0
    s_waitcnt lgkmcnt(5)
    v_mfma_f32_32x32x16_bf16 v[192:207], v[88:91], v[40:43], v[192:207]
    v_mov_b64 v[152:153], 0
    v_mov_b64 v[154:155], 0
    s_waitcnt lgkmcnt(4)
    v_mfma_f32_32x32x16_bf16 v[192:207], v[92:95], v[44:47], v[192:207]
    v_mov_b64 v[156:157], 0
    v_mov_b64 v[158:159], 0
    s_waitcnt lgkmcnt(3)
    v_mfma_f32_32x32x16_bf16 v[192:207], v[96:99], v[48:51], v[192:207]
    v_mov_b64 v[160:161], 0
    v_mov_b64 v[162:163], 0
    s_waitcnt lgkmcnt(2)
    v_mfma_f32_32x32x16_bf16 v[192:207], v[100:103], v[52:55], v[192:207]
    v_mov_b64 v[164:165], 0
    v_mov_b64 v[166:167], 0
    s_waitcnt lgkmcnt(1)
    v_mfma_f32_32x32x16_bf16 v[192:207], v[104:107], v[56:59], v[192:207]
    v_mov_b64 v[168:169], 0
    v_mov_b64 v[170:171], 0
    s_waitcnt lgkmcnt(0)
    v_mfma_f32_32x32x16_bf16 v[192:207], v[108:111], v[60:63], v[192:207]
    v_mov_b64 v[172:173], 0
    v_mov_b64 v[174:175], 0
    s_waitcnt vmcnt(2)
    s_mov_b32 s7, 0x40000
L_kva_kp_a:
    v_cmp_gt_u32 vcc, v23, v21
    s_sub_u32 s7, s7, 1
    s_nop 2
    s_cbranch_vccz L_kva_kp_e
    s_cmp_eq_u32 s7, 0
    s_cbranch_scc1 L_kva_kp_e
    s_sleep 2
    buffer_load_dword v21, v22, s[56:59], 0 offen sc1
    s_waitcnt vmcnt(0)
    s_branch L_kva_kp_a
L_kva_kp_e:
    s_barrier
    v_add_u32 v23, 1, v23
    v_and_b32 v23, 4, v23
    s_add_u32 m0, s49, 65536
    s_nop 0
    buffer_load_dwordx4 v12, s[32:35], s24 offen sc1 lds
    buffer_load_dwordx4 v12, s[32:35], s24 offen offset:1024 sc1 lds
    buffer_load_dwordx4 v12, s[32:35], s24 offen offset:2048 sc1 lds
    ds_read_b128 v[80:83], v20 offset:32768
    ds_read_b128 v[84:87], v20 offset:33792
    ds_read_b128 v[88:91], v20 offset:34816
    ds_read_b128 v[92:95], v20 offset:35840
    ds_read_b128 v[96:99], v20 offset:36864
    ds_read_b128 v[100:103], v20 offset:37888
    ds_read_b128 v[104:107], v20 offset:38912
    ds_read_b128 v[108:111], v20 offset:39936
    v_max3_f32 v29, v176, v177, v178
    v_max3_f32 v30, v179, v180, v181
    v_max3_f32 v29, v29, v182, v183
    v_max3_f32 v30, v30, v184, v185
    v_max3_f32 v29, v29, v186, v187
    v_max3_f32 v30, v30, v188, v189
    v_max3_f32 v29, v29, v190, v191
    v_max3_f32 v30, v30, v192, v193
    v_max3_f32 v29, v29, v194, v195
    v_max3_f32 v30, v30, v196, v197
    v_max3_f32 v29, v29, v198, v199
    v_max3_f32 v30, v30, v200, v201
    v_max3_f32 v29, v29, v202, v203
    v_max3_f32 v30, v30, v204, v205
    v_max3_f32 v29, v29, v206, v207
    v_max_f32 v29, v29, v30
    v_mov_b32 v30, v29
    s_nop 0
    s_nop 0
    v_permlane32_swap_b32 v29, v30
    s_nop 0
    s_nop 0
    v_max_f32 v29, v29, v30
    v_pk_add_f32 v[64:65], 0, v[28:29] op_sel:[0,1] op_sel_hi:[1,1] neg_lo:[0,1] neg_hi:[0,1]
    v_pk_add_f32 v[66:67], 0, v[28:29] op_sel:[0,1] op_sel_hi:[1,1] neg_lo:[0,1] neg_hi:[0,1]
    v_pk_add_f32 v[68:69], 0, v[28:29] op_sel:[0,1] op_sel_hi:[1,1] neg_lo:[0,1] neg_hi:[0,1]
    v_pk_add_f32 v[70:71], 0, v[28:29] op_sel:[0,1] op_sel_hi:[1,1] neg_lo:[0,1] neg_hi:[0,1]
    v_pk_add_f32 v[72:73], 0, v[28:29] op_sel:[0,1] op_sel_hi:[1,1] neg_lo:[0,1] neg_hi:[0,1]
    v_pk_add_f32 v[74:75], 0, v[28:29] op_sel:[0,1] op_sel_hi:[1,1] neg_lo:[0,1] neg_hi:[0,1]
    v_pk_add_f32 v[76:77], 0, v[28:29] op_sel:[0,1] op_sel_hi:[1,1] neg_lo:[0,1] neg_hi:[0,1]
    v_pk_add_f32 v[78:79], 0, v[28:29] op_sel:[0,1] op_sel_hi:[1,1] neg_lo:[0,1] neg_hi:[0,1]
    v_pk_add_f32 v[176:177], v[176:177], v[28:29] op_sel:[0,1] op_sel_hi:[1,1] neg_lo:[0,1] neg_hi:[0,1]
    v_pk_add_f32 v[178:179], v[178:179], v[28:29] op_sel:[0,1] op_sel_hi:[1,1] neg_lo:[0,1] neg_hi:[0,1]
    v_pk_add_f32 v[180:181], v[180:181], v[28:29] op_sel:[0,1] op_sel_hi:[1,1] neg_lo:[0,1] neg_hi:[0,1]
    v_pk_add_f32 v[182:183], v[182:183], v[28:29] op_sel:[0,1] op_sel_hi:[1,1] neg_lo:[0,1] neg_hi:[0,1]
    v_pk_add_f32 v[184:185], v[184:185], v[28:29] op_sel:[0,1] op_sel_hi:[1,1] neg_lo:[0,1] neg_hi:[0,1]
    v_pk_add_f32 v[186:187], v[186:187], v[28:29] op_sel:[0,1] op_sel_hi:[1,1] neg_lo:[0,1] neg_hi:[0,1]
    v_pk_add_f32 v[188:189], v[188:189], v[28:29] op_sel:[0,1] op_sel_hi:[1,1] neg_lo:[0,1] neg_hi:[0,1]
    v_pk_add_f32 v[190:191], v[190:191], v[28:29] op_sel:[0,1] op_sel_hi:[1,1] neg_lo:[0,1] neg_hi:[0,1]
    v_pk_add_f32 v[192:193], v[192:193], v[28:29] op_sel:[0,1] op_sel_hi:[1,1] neg_lo:[0,1] neg_hi:[0,1]
    v_pk_add_f32 v[194:195], v[194:195], v[28:29] op_sel:[0,1] op_sel_hi:[1,1] neg_lo:[0,1] neg_hi:[0,1]
    v_pk_add_f32 v[196:197], v[196:197], v[28:29] op_sel:[0,1] op_sel_hi:[1,1] neg_lo:[0,1] neg_hi:[0,1]
    v_pk_add_f32 v[198:199], v[198:199], v[28:29] op_sel:[0,1] op_sel_hi:[1,1] neg_lo:[0,1] neg_hi:[0,1]
    v_pk_add_f32 v[200:201], v[200:201], v[28:29] op_sel:[0,1] op_sel_hi:[1,1] neg_lo:[0,1] neg_hi:[0,1]
    v_pk_add_f32 v[202:203], v[202:203], v[28:29] op_sel:[0,1] op_sel_hi:[1,1] neg_lo:[0,1] neg_hi:[0,1]
    v_pk_add_f32 v[204:205], v[204:205], v[28:29] op_sel:[0,1] op_sel_hi:[1,1] neg_lo:[0,1] neg_hi:[0,1]
    v_pk_add_f32 v[206:207], v[206:207], v[28:29] op_sel:[0,1] op_sel_hi:[1,1] neg_lo:[0,1] neg_hi:[0,1]
    s_mov_b64 s[40:41], 0
    s_mov_b32 s42, s27
L_kva_n0:
    s_cmp_lg_u64 s[40:41], 0
    s_cbranch_scc1 L_kva_oa2
L_kva_ob2:
    s_waitcnt lgkmcnt(6)
    v_mfma_f32_32x32x16_bf16 v[208:223], v[80:83], v[32:35], v[64:79]
    ds_read_b128 v[80:83], v20 offset:40960
    buffer_load_dwordx4 v12, s[32:35], s24 offen offset:3072 sc1 lds
    s_mov_b32 s18, s24
    s_and_b32 s24, s92, 15
    s_lshr_b64 s[92:93], s[92:93], 4
    s_lshl_b32 s24, s24, 15
    s_add_u32 s24, s24, s21
    v_exp_f32 v176, v176
    v_exp_f32 v177, v177
    v_add_f32 v14, v14, v176
    v_mfma_f32_32x32x16_bf16 v[208:223], v[84:87], v[36:39], v[208:223]
    ds_read_b128 v[84:87], v20 offset:41984
    v_exp_f32 v178, v178
    v_add_f32 v14, v14, v177
    v_cvt_pk_bf16_f32 v176, v176, v177
    s_waitcnt lgkmcnt(6)
    v_mfma_f32_32x32x16_bf16 v[208:223], v[88:91], v[40:43], v[208:223]
    ds_read_b128 v[88:91], v20 offset:43008
    s_add_u32 m0, s49, 0
    s_nop 0
    buffer_load_dwordx4 v12, s[60:63], s26 offen sc1 lds
    v_exp_f32 v179, v179
    v_add_f32 v14, v14, v178
    v_exp_f32 v180, v180
    v_mfma_f32_32x32x16_bf16 v[208:223], v[92:95], v[44:47], v[208:223]
    ds_read_b128 v[92:95], v20 offset:44032
    v_add_f32 v14, v14, v179
    v_cvt_pk_bf16_f32 v177, v178, v179
    v_exp_f32 v181, v181
    v_add_f32 v14, v14, v180
    s_waitcnt lgkmcnt(6)
    v_mfma_f32_32x32x16_bf16 v[208:223], v[96:99], v[48:51], v[208:223]
    ds_read_b128 v[96:99], v20 offset:45056
    buffer_load_dwordx4 v12, s[60:63], s26 offen offset:1024 sc1 lds
    v_exp_f32 v182, v182
    v_add_f32 v14, v14, v181
    v_cvt_pk_bf16_f32 v178, v180, v181
    v_mfma_f32_32x32x16_bf16 v[208:223], v[100:103], v[52:55], v[208:223]
    s_setprio 2
    ds_read_b128 v[100:103], v20 offset:46080
    v_exp_f32 v183, v183
    v_add_f32 v14, v14, v182
    v_exp_f32 v184, v184
    s_waitcnt lgkmcnt(6)
    v_mfma_f32_32x32x16_bf16 v[208:223], v[104:107], v[56:59], v[208:223]
    ds_read_b128 v[104:107], v20 offset:47104
    buffer_load_dwordx4 v12, s[60:63], s26 offen offset:2048 sc1 lds
    v_add_f32 v14, v14, v183
    v_cvt_pk_bf16_f32 v179, v182, v183
    v_exp_f32 v185, v185
    v_add_f32 v14, v14, v184
    v_mfma_f32_32x32x16_bf16 v[208:223], v[108:111], v[60:63], v[208:223]
    ds_read_b128 v[108:111], v20 offset:48128
    v_exp_f32 v186, v186
    v_add_f32 v14, v14, v185
    v_cvt_pk_bf16_f32 v184, v184, v185
    s_waitcnt lgkmcnt(6)
    v_mfma_f32_32x32x16_bf16 v[224:239], v[80:83], v[32:35], v[64:79]
    ds_read_b128 v[80:83], v16 offset:32768
    buffer_load_dwordx4 v12, s[60:63], s26 offen offset:3072 sc1 lds
    s_mov_b32 s26, s18
    v_exp_f32 v187, v187
    v_add_f32 v14, v14, v186
    v_exp_f32 v188, v188
    v_mfma_f32_32x32x16_bf16 v[224:239], v[84:87], v[36:39], v[224:239]
    ds_read_b128 v[84:87], v16 offset:33792
    v_add_f32 v14, v14, v187
    v_cvt_pk_bf16_f32 v185, v186, v187
    v_exp_f32 v189, v189
    v_add_f32 v14, v14, v188
    s_waitcnt lgkmcnt(6)
    v_mfma_f32_32x32x16_bf16 v[224:239], v[88:91], v[40:43], v[224:239]
    ds_read_b128 v[88:91], v17 offset:34816
    s_waitcnt vmcnt(9)
    s_cmp_lt_u32 s45, 8
    s_cbranch_scc1 L_kva_bg0
L_kva_bg0_i:
    buffer_store_dwordx4 v[248:251], v19, s[8:11], s55 offen sc1
    buffer_load_dwordx4 v[248:251], v18, s[36:39], s44 offen
    s_add_u32 s45, s45, 1
    s_add_u32 s44, s44, 128
    s_add_u32 s48, s48, 4096
    s_cmp_lt_u32 s45, 6
    s_cselect_b32 s44, s44, 0x7f000000
    s_cmp_lt_u32 s45, 7
    s_cselect_b32 s55, s48, 0x7f000000
L_kva_bg0_e:
    v_exp_f32 v190, v190
    v_add_f32 v14, v14, v189
    v_cvt_pk_bf16_f32 v186, v188, v189
    v_mfma_f32_32x32x16_bf16 v[224:239], v[92:95], v[44:47], v[224:239]
    ds_read_b128 v[92:95], v17 offset:35840
    v_exp_f32 v191, v191
    v_add_f32 v14, v14, v190
    v_exp_f32 v192, v192
    s_waitcnt lgkmcnt(6)
    v_mfma_f32_32x32x16_bf16 v[224:239], v[96:99], v[48:51], v[224:239]
    ds_read_b128 v[96:99], v16 offset:36864
    v_add_f32 v14, v14, v191
    v_cvt_pk_bf16_f32 v187, v190, v191
    v_exp_f32 v193, v193
    v_add_f32 v14, v14, v192
    v_mfma_f32_32x32x16_bf16 v[224:239], v[100:103], v[52:55], v[224:239]
    ds_read_b128 v[100:103], v16 offset:37888
    v_exp_f32 v194, v194
    v_add_f32 v14, v14, v193
    v_cvt_pk_bf16_f32 v192, v192, v193
    s_waitcnt lgkmcnt(6)
    v_mfma_f32_32x32x16_bf16 v[224:239], v[104:107], v[56:59], v[224:239]
    ds_read_b128 v[104:107], v17 offset:38912
    v_exp_f32 v195, v195
    v_add_f32 v14, v14, v194
    v_exp_f32 v196, v196
    v_mfma_f32_32x32x16_bf16 v[224:239], v[108:111], v[60:63], v[224:239]
    s_setprio 1
    ds_read_b128 v[108:111], v17 offset:39936
    v_add_f32 v14, v14, v195
    v_cvt_pk_bf16_f32 v193, v194, v195
    v_exp_f32 v197, v197
    v_add_f32 v14, v14, v196
    s_waitcnt lgkmcnt(6)
    v_mfma_f32_32x32x16_bf16 v[112:127], v[80:83], v[176:179], v[112:127]
    ds_read_b128 v[80:83], v16 offset:40960
    v_exp_f32 v198, v198
    v_add_f32 v14, v14, v197
    v_cvt_pk_bf16_f32 v194, v196, v197
    v_mfma_f32_32x32x16_bf16 v[128:143], v[84:87], v[176:179], v[128:143]
    ds_read_b128 v[84:87], v16 offset:41984
    v_exp_f32 v199, v199
    v_add_f32 v14, v14, v198
    v_exp_f32 v200, v200
    s_waitcnt lgkmcnt(6)
    v_mfma_f32_32x32x16_bf16 v[144:159], v[88:91], v[176:179], v[144:159]
    ds_read_b128 v[88:91], v17 offset:43008
    s_cmp_eq_u32 s43, s30
    s_cbranch_scc1 L_kva_oa3
L_kva_ob3:
    s_add_u32 s43, s43, 1
    v_add_f32 v14, v14, v199
    v_cvt_pk_bf16_f32 v195, v198, v199
    v_max3_f32 v29, v208, v209, v210
    v_exp_f32 v201, v201
    v_mfma_f32_32x32x16_bf16 v[160:175], v[92:95], v[176:179], v[160:175]
    ds_read_b128 v[92:95], v17 offset:44032
    v_add_f32 v14, v14, v200
    v_exp_f32 v202, v202
    v_max3_f32 v30, v211, v212, v213
    v_add_f32 v14, v14, v201
    s_waitcnt lgkmcnt(6)
    v_mfma_f32_32x32x16_bf16 v[112:127], v[96:99], v[184:187], v[112:127]
    ds_read_b128 v[96:99], v16 offset:45056
    v_cvt_pk_bf16_f32 v200, v200, v201
    v_exp_f32 v203, v203
    v_max3_f32 v29, v29, v214, v215
    v_add_f32 v14, v14, v202
    v_mfma_f32_32x32x16_bf16 v[128:143], v[100:103], v[184:187], v[128:143]
    s_setprio 0
    ds_read_b128 v[100:103], v16 offset:46080
    v_exp_f32 v204, v204
    v_add_f32 v14, v14, v203
    v_max3_f32 v30, v30, v216, v217
    v_cvt_pk_bf16_f32 v201, v202, v203
    s_waitcnt lgkmcnt(6)
    v_mfma_f32_32x32x16_bf16 v[144:159], v[104:107], v[184:187], v[144:159]
    ds_read_b128 v[104:107], v17 offset:47104
    v_exp_f32 v205, v205
    v_add_f32 v14, v14, v204
    v_max3_f32 v29, v29, v218, v219
    v_mfma_f32_32x32x16_bf16 v[160:175], v[108:111], v[184:187], v[160:175]
    ds_read_b128 v[108:111], v17 offset:48128
    v_exp_f32 v206, v206
    v_add_f32 v14, v14, v205
    v_max3_f32 v30, v30, v220, v221
    v_cvt_pk_bf16_f32 v202, v204, v205
    s_nop 0
    s_waitcnt lgkmcnt(6)
    v_mfma_f32_32x32x16_bf16 v[112:127], v[80:83], v[192:195], v[112:127]
    s_cmp_eq_u32 s42, s19
    s_cbranch_scc1 L_kva_oa4
L_kva_ob4:
    v_exp_f32 v207, v207
    v_add_f32 v14, v14, v206
    v_max3_f32 v29, v29, v222, v223
    v_add_f32 v14, v14, v207
    v_mfma_f32_32x32x16_bf16 v[128:143], v[84:87], v[192:195], v[128:143]
    v_cvt_pk_bf16_f32 v203, v206, v207
    v_max3_f32 v30, v30, v224, v225
    v_max3_f32 v29, v29, v226, v227
    v_max3_f32 v30, v30, v228, v229
    v_max3_f32 v29, v29, v230, v231
    s_bitcmp1_b32 s80, s45
    s_cbranch_scc1 L_kva_oa6
    s_waitcnt vmcnt(2) lgkmcnt(0)
L_kva_ob6:
    s_barrier
    v_mfma_f32_32x32x16_bf16 v[144:159], v[88:91], v[192:195], v[144:159]
    s_setprio 3
    ds_read_b128 v[80:83], v20 offset:0
    ds_read_b128 v[84:87], v20 offset:1024
    ds_read_b128 v[88:91], v20 offset:2048
    v_mov_b32 v24, s54
    buffer_store_dword v24, v25, s[56:59], s25 offen sc1
    s_mov_b32 s25, 0x7f000000
    s_add_u32 m0, s49, 98304
    s_nop 0
    buffer_load_dwordx4 v12, s[32:35], s24 offen sc1 lds
    v_max3_f32 v30, v30, v232, v233
    v_max3_f32 v29, v29, v234, v235
    v_max3_f32 v30, v30, v236, v237
    v_max3_f32 v29, v29, v238, v239
    v_max_f32 v29, v29, v30
    v_mfma_f32_32x32x16_bf16 v[160:175], v[92:95], v[192:195], v[160:175]
    ds_read_b128 v[92:95], v20 offset:3072
    v_cmp_lt_f32 s[40:41], s31, v29
    v_mfma_f32_32x32x16_bf16 v[112:127], v[96:99], v[200:203], v[112:127]
    ds_read_b128 v[96:99], v20 offset:4096
    buffer_load_dwordx4 v12, s[32:35], s24 offen offset:1024 sc1 lds
    v_mfma_f32_32x32x16_bf16 v[128:143], v[100:103], v[200:203], v[128:143]
    ds_read_b128 v[100:103], v20 offset:5120
    v_mfma_f32_32x32x16_bf16 v[144:159], v[104:107], v[200:203], v[144:159]
    ds_read_b128 v[104:107], v20 offset:6144
    buffer_load_dwordx4 v12, s[32:35], s24 offen offset:2048 sc1 lds
    v_mfma_f32_32x32x16_bf16 v[160:175], v[108:111], v[200:203], v[160:175]
    ds_read_b128 v[108:111], v20 offset:7168
    s_sub_u32 s42, s42, 1
    s_cmp_eq_u32 s42, 1
    s_cbranch_scc1 L_kva_l1
L_kva_n1:
    s_cmp_lg_u64 s[40:41], 0
    s_cbranch_scc1 L_kva_oa7
L_kva_ob7:
    s_waitcnt lgkmcnt(6)
    v_mfma_f32_32x32x16_bf16 v[176:191], v[80:83], v[32:35], v[64:79]
    ds_read_b128 v[80:83], v20 offset:8192
    buffer_load_dwordx4 v12, s[32:35], s24 offen offset:3072 sc1 lds
    s_mov_b32 s18, s24
    s_and_b32 s24, s92, 15
    s_lshr_b64 s[92:93], s[92:93], 4
    s_lshl_b32 s24, s24, 15
    s_add_u32 s24, s24, s21
    v_exp_f32 v208, v208
    v_exp_f32 v209, v209
    v_add_f32 v14, v14, v208
    v_mfma_f32_32x32x16_bf16 v[176:191], v[84:87], v[36:39], v[176:191]
    ds_read_b128 v[84:87], v20 offset:9216
    v_exp_f32 v210, v210
    v_add_f32 v14, v14, v209
    v_cvt_pk_bf16_f32 v208, v208, v209
    s_waitcnt lgkmcnt(6)
    v_mfma_f32_32x32x16_bf16 v[176:191], v[88:91], v[40:43], v[176:191]
    ds_read_b128 v[88:91], v20 offset:10240
    s_add_u32 m0, s49, 32768
    s_nop 0
    buffer_load_dwordx4 v12, s[60:63], s26 offen sc1 lds
    v_exp_f32 v211, v211
    v_add_f32 v14, v14, v210
    v_exp_f32 v212, v212
    v_mfma_f32_32x32x16_bf16 v[176:191], v[92:95], v[44:47], v[176:191]
    ds_read_b128 v[92:95], v20 offset:11264
    v_add_f32 v14, v14, v211
    v_cvt_pk_bf16_f32 v209, v210, v211
    v_exp_f32 v213, v213
    v_add_f32 v14, v14, v212
    s_waitcnt lgkmcnt(6)
    v_mfma_f32_32x32x16_bf16 v[176:191], v[96:99], v[48:51], v[176:191]
    ds_read_b128 v[96:99], v20 offset:12288
    buffer_load_dwordx4 v12, s[60:63], s26 offen offset:1024 sc1 lds
    v_exp_f32 v214, v214
    v_add_f32 v14, v14, v213
    v_cvt_pk_bf16_f32 v210, v212, v213
    v_mfma_f32_32x32x16_bf16 v[176:191], v[100:103], v[52:55], v[176:191]
    s_setprio 2
    ds_read_b128 v[100:103], v20 offset:13312
    v_exp_f32 v215, v215
    v_add_f32 v14, v14, v214
    v_exp_f32 v216, v216
    s_waitcnt lgkmcnt(6)
    v_mfma_f32_32x32x16_bf16 v[176:191], v[104:107], v[56:59], v[176:191]
    ds_read_b128 v[104:107], v20 offset:14336
    buffer_load_dwordx4 v12, s[60:63], s26 offen offset:2048 sc1 lds
    v_add_f32 v14, v14, v215
    v_cvt_pk_bf16_f32 v211, v214, v215
    v_exp_f32 v217, v217
    v_add_f32 v14, v14, v216
    v_mfma_f32_32x32x16_bf16 v[176:191], v[108:111], v[60:63], v[176:191]
    ds_read_b128 v[108:111], v20 offset:15360
    v_exp_f32 v218, v218
    v_add_f32 v14, v14, v217
    v_cvt_pk_bf16_f32 v216, v216, v217
    s_waitcnt lgkmcnt(6)
    v_mfma_f32_32x32x16_bf16 v[192:207], v[80:83], v[32:35], v[64:79]
    ds_read_b128 v[80:83], v16 offset:0
    buffer_load_dwordx4 v12, s[60:63], s26 offen offset:3072 sc1 lds
    s_mov_b32 s26, s18
    v_exp_f32 v219, v219
    v_add_f32 v14, v14, v218
    v_exp_f32 v220, v220
    v_mfma_f32_32x32x16_bf16 v[192:207], v[84:87], v[36:39], v[192:207]
    ds_read_b128 v[84:87], v16 offset:1024
    v_add_f32 v14, v14, v219
    v_cvt_pk_bf16_f32 v217, v218, v219
    v_exp_f32 v221, v221
    v_add_f32 v14, v14, v220
    s_waitcnt lgkmcnt(6)
    v_mfma_f32_32x32x16_bf16 v[192:207], v[88:91], v[40:43], v[192:207]
    ds_read_b128 v[88:91], v17 offset:2048
    s_waitcnt vmcnt(9)
    s_cmp_lt_u32 s45, 8
    s_cbranch_scc1 L_kva_bg1
L_kva_bg1_i:
    buffer_store_dwordx4 v[248:251], v19, s[8:11], s55 offen sc1
    buffer_load_dwordx4 v[248:251], v18, s[36:39], s44 offen
    s_add_u32 s45, s45, 1
    s_add_u32 s44, s44, 128
    s_add_u32 s48, s48, 4096
    s_cmp_lt_u32 s45, 6
    s_cselect_b32 s44, s44, 0x7f000000
    s_cmp_lt_u32 s45, 7
    s_cselect_b32 s55, s48, 0x7f000000
L_kva_bg1_e:
    v_exp_f32 v222, v222
    v_add_f32 v14, v14, v221
    v_cvt_pk_bf16_f32 v218, v220, v221
    v_mfma_f32_32x32x16_bf16 v[192:207], v[92:95], v[44:47], v[192:207]
    ds_read_b128 v[92:95], v17 offset:3072
    v_exp_f32 v223, v223
    v_add_f32 v14, v14, v222
    v_exp_f32 v224, v224
    s_waitcnt lgkmcnt(6)
    v_mfma_f32_32x32x16_bf16 v[192:207], v[96:99], v[48:51], v[192:207]
    ds_read_b128 v[96:99], v16 offset:4096
    v_add_f32 v14, v14, v223
    v_cvt_pk_bf16_f32 v219, v222, v223
    v_exp_f32 v225, v225
    v_add_f32 v14, v14, v224
    v_mfma_f32_32x32x16_bf16 v[192:207], v[100:103], v[52:55], v[192:207]
    ds_read_b128 v[100:103], v16 offset:5120
    v_exp_f32 v226, v226
    v_add_f32 v14, v14, v225
    v_cvt_pk_bf16_f32 v224, v224, v225
    s_waitcnt lgkmcnt(6)
    v_mfma_f32_32x32x16_bf16 v[192:207], v[104:107], v[56:59], v[192:207]
    ds_read_b128 v[104:107], v17 offset:6144
    v_exp_f32 v227, v227
    v_add_f32 v14, v14, v226
    v_exp_f32 v228, v228
    v_mfma_f32_32x32x16_bf16 v[192:207], v[108:111], v[60:63], v[192:207]
    s_setprio 1
    ds_read_b128 v[108:111], v17 offset:7168
    v_add_f32 v14, v14, v227
    v_cvt_pk_bf16_f32 v225, v226, v227
    v_exp_f32 v229, v229
    v_add_f32 v14, v14, v228
    s_waitcnt lgkmcnt(6)
    v_mfma_f32_32x32x16_bf16 v[112:127], v[80:83], v[208:211], v[112:127]
    ds_read_b128 v[80:83], v16 offset:8192
    v_exp_f32 v230, v230
    v_add_f32 v14, v14, v229
    v_cvt_pk_bf16_f32 v226, v228, v229
    v_mfma_f32_32x32x16_bf16 v[128:143], v[84:87], v[208:211], v[128:143]
    ds_read_b128 v[84:87], v16 offset:9216
    v_exp_f32 v231, v231
    v_add_f32 v14, v14, v230
    v_exp_f32 v232, v232
    s_waitcnt lgkmcnt(6)
    v_mfma_f32_32x32x16_bf16 v[144:159], v[88:91], v[208:211], v[144:159]
    ds_read_b128 v[88:91], v17 offset:10240
    s_cmp_eq_u32 s43, s30
    s_cbranch_scc1 L_kva_oa8
L_kva_ob8:
    s_add_u32 s43, s43, 1
    v_add_f32 v14, v14, v231
    v_cvt_pk_bf16_f32 v227, v230, v231
    v_max3_f32 v29, v176, v177, v178
    v_exp_f32 v233, v233
    v_mfma_f32_32x32x16_bf16 v[160:175], v[92:95], v[208:211], v[160:175]
    ds_read_b128 v[92:95], v17 offset:11264
    v_add_f32 v14, v14, v232
    v_exp_f32 v234, v234
    v_max3_f32 v30, v179, v180, v181
    v_add_f32 v14, v14, v233
    s_waitcnt lgkmcnt(6)
    v_mfma_f32_32x32x16_bf16 v[112:127], v[96:99], v[216:219], v[112:127]
    ds_read_b128 v[96:99], v16 offset:12288
    v_cvt_pk_bf16_f32 v232, v232, v233
    v_exp_f32 v235, v235
    v_max3_f32 v29, v29, v182, v183
    v_add_f32 v14, v14, v234
    v_mfma_f32_32x32x16_bf16 v[128:143], v[100:103], v[216:219], v[128:143]
    s_setprio 0
    ds_read_b128 v[100:103], v16 offset:13312
    v_exp_f32 v236, v236
    v_add_f32 v14, v14, v235
    v_max3_f32 v30, v30, v184, v185
    v_cvt_pk_bf16_f32 v233, v234, v235
    s_waitcnt lgkmcnt(6)
    v_mfma_f32_32x32x16_bf16 v[144:159], v[104:107], v[216:219], v[144:159]
    ds_read_b128 v[104:107], v17 offset:14336
    v_exp_f32 v237, v237
    v_add_f32 v14, v14, v236
    v_max3_f32 v29, v29, v186, v187
    v_mfma_f32_32x32x16_bf16 v[160:175], v[108:111], v[216:219], v[160:175]
    ds_read_b128 v[108:111], v17 offset:15360
    v_exp_f32 v238, v238
    v_add_f32 v14, v14, v237
    v_max3_f32 v30, v30, v188, v189
    v_cvt_pk_bf16_f32 v234, v236, v237
    s_nop 0
    s_waitcnt lgkmcnt(6)
    v_mfma_f32_32x32x16_bf16 v[112:127], v[80:83], v[224:227], v[112:127]
    s_cmp_eq_u32 s42, s19
    s_cbranch_scc1 L_kva_oa9
L_kva_ob9:
    v_exp_f32 v239, v239
    v_add_f32 v14, v14, v238
    v_max3_f32 v29, v29, v190, v191
    v_add_f32 v14, v14, v239
    v_mfma_f32_32x32x16_bf16 v[128:143], v[84:87], v[224:227], v[128:143]
    v_cvt_pk_bf16_f32 v235, v238, v239
    v_max3_f32 v30, v30, v192, v193
    v_max3_f32 v29, v29, v194, v195
    v_max3_f32 v30, v30, v196, v197
    v_max3_f32 v29, v29, v198, v199
    s_bitcmp1_b32 s80, s45
    s_cbranch_scc1 L_kva_oa11
    s_waitcnt vmcnt(2) lgkmcnt(0)
L_kva_ob11:
    s_barrier
    v_mfma_f32_32x32x16_bf16 v[144:159], v[88:91], v[224:227], v[144:159]
    s_setprio 3
    ds_read_b128 v[80:83], v20 offset:32768
    ds_read_b128 v[84:87], v20 offset:33792
    ds_read_b128 v[88:91], v20 offset:34816
    v_mov_b32 v24, s54
    buffer_store_dword v24, v25, s[56:59], s25 offen sc1
    s_mov_b32 s25, 0x7f000000
    s_add_u32 m0, s49, 65536
    s_nop 0
    buffer_load_dwordx4 v12, s[32:35], s24 offen sc1 lds
    v_max3_f32 v30, v30, v200, v201
    v_max3_f32 v29, v29, v202, v203
    v_max3_f32 v30, v30, v204, v205
    v_max3_f32 v29, v29, v206, v207
    v_max_f32 v29, v29, v30
    v_mfma_f32_32x32x16_bf16 v[160:175], v[92:95], v[224:227], v[160:175]
    ds_read_b128 v[92:95], v20 offset:35840
    v_cmp_lt_f32 s[40:41], s31, v29
    v_mfma_f32_32x32x16_bf16 v[112:127], v[96:99], v[232:235], v[112:127]
    ds_read_b128 v[96:99], v20 offset:36864
    buffer_load_dwordx4 v12, s[32:35], s24 offen offset:1024 sc1 lds
    v_mfma_f32_32x32x16_bf16 v[128:143], v[100:103], v[232:235], v[128:143]
    ds_read_b128 v[100:103], v20 offset:37888
    v_mfma_f32_32x32x16_bf16 v[144:159], v[104:107], v[232:235], v[144:159]
    ds_read_b128 v[104:107], v20 offset:38912
    buffer_load_dwordx4 v12, s[32:35], s24 offen offset:2048 sc1 lds
    v_mfma_f32_32x32x16_bf16 v[160:175], v[108:111], v[232:235], v[160:175]
    ds_read_b128 v[108:111], v20 offset:39936
    s_sub_u32 s42, s42, 1
    s_cmp_eq_u32 s42, 1
    s_cbranch_scc1 L_kva_l0
    s_branch L_kva_n0
L_kva_l0:
    s_cmp_lg_u32 s47, 0
    s_cbranch_scc1 L_kva_fin
    s_cmp_lg_u64 s[40:41], 0
    s_cbranch_scc1 L_kva_oa12
L_kva_ob12:
    v_mov_b32 v240, v64
    v_mov_b64 v[64:65], 0
    v_mov_b64 v[66:67], 0
    v_mov_b64 v[68:69], 0
    v_mov_b64 v[70:71], 0
    v_mov_b64 v[72:73], 0
    v_mov_b64 v[74:75], 0
    v_mov_b64 v[76:77], 0
    v_mov_b64 v[78:79], 0
    v_lshlrev_b32 v7, 2, v3
    v_sub_u32 v15, v13, v7
    s_lshl_b32 s29, s46, 6
    s_lshl_b32 s30, s17, 7
    s_add_u32 s29, s29, s30
    s_mov_b32 s30, s17
    s_mov_b32 s43, 0
    s_waitcnt lgkmcnt(6)
    v_mfma_f32_32x32x16_bf16 v[208:223], v[80:83], v[32:35], v[64:79]
    ds_read_b128 v[80:83], v20 offset:40960
    buffer_load_dwordx4 v12, s[32:35], s24 offen offset:3072 sc1 lds
    s_mov_b32 s18, s24
    s_and_b32 s24, s92, 15
    s_lshr_b64 s[92:93], s[92:93], 4
    s_lshl_b32 s24, s24, 15
    s_add_u32 s24, s24, s21
    v_exp_f32 v176, v176
    v_exp_f32 v177, v177
    v_add_f32 v14, v14, v176
    v_mfma_f32_32x32x16_bf16 v[208:223], v[84:87], v[36:39], v[208:223]
    ds_read_b128 v[84:87], v20 offset:41984
    v_exp_f32 v178, v178
    v_add_f32 v14, v14, v177
    v_cvt_pk_bf16_f32 v176, v176, v177
    s_waitcnt lgkmcnt(6)
    v_mfma_f32_32x32x16_bf16 v[208:223], v[88:91], v[40:43], v[208:223]
    ds_read_b128 v[88:91], v20 offset:43008
    s_add_u32 m0, s49, 0
    s_nop 0
    buffer_load_dwordx4 v12, s[60:63], s26 offen sc1 lds
    v_exp_f32 v179, v179
    v_add_f32 v14, v14, v178
    v_exp_f32 v180, v180
    v_mfma_f32_32x32x16_bf16 v[208:223], v[92:95], v[44:47], v[208:223]
    ds_read_b128 v[92:95], v20 offset:44032
    v_add_f32 v14, v14, v179
    v_cvt_pk_bf16_f32 v177, v178, v179
    v_exp_f32 v181, v181
    v_add_f32 v14, v14, v180
    s_waitcnt lgkmcnt(6)
    v_mfma_f32_32x32x16_bf16 v[208:223], v[96:99], v[48:51], v[208:223]
    ds_read_b128 v[96:99], v20 offset:45056
    buffer_load_dwordx4 v12, s[60:63], s26 offen offset:1024 sc1 lds
    v_exp_f32 v182, v182
    v_add_f32 v14, v14, v181
    v_cvt_pk_bf16_f32 v178, v180, v181
    v_mfma_f32_32x32x16_bf16 v[208:223], v[100:103], v[52:55], v[208:223]
    s_setprio 2
    ds_read_b128 v[100:103], v20 offset:46080
    v_exp_f32 v183, v183
    v_add_f32 v14, v14, v182
    v_exp_f32 v184, v184
    s_waitcnt lgkmcnt(6)
    v_mfma_f32_32x32x16_bf16 v[208:223], v[104:107], v[56:59], v[208:223]
    ds_read_b128 v[104:107], v20 offset:47104
    buffer_load_dwordx4 v12, s[60:63], s26 offen offset:2048 sc1 lds
    v_add_f32 v14, v14, v183
    v_cvt_pk_bf16_f32 v179, v182, v183
    v_exp_f32 v185, v185
    v_add_f32 v14, v14, v184
    v_mfma_f32_32x32x16_bf16 v[208:223], v[108:111], v[60:63], v[208:223]
    ds_read_b128 v[108:111], v20 offset:48128
    v_exp_f32 v186, v186
    v_add_f32 v14, v14, v185
    v_cvt_pk_bf16_f32 v184, v184, v185
    s_waitcnt lgkmcnt(6)
    v_mfma_f32_32x32x16_bf16 v[224:239], v[80:83], v[32:35], v[64:79]
    ds_read_b128 v[80:83], v16 offset:32768
    buffer_load_dwordx4 v12, s[60:63], s26 offen offset:3072 sc1 lds
    s_mov_b32 s26, s18
    v_exp_f32 v187, v187
    v_add_f32 v14, v14, v186
    v_exp_f32 v188, v188
    v_mfma_f32_32x32x16_bf16 v[224:239], v[84:87], v[36:39], v[224:239]
    ds_read_b128 v[84:87], v16 offset:33792
    v_add_f32 v14, v14, v187
    v_cvt_pk_bf16_f32 v185, v186, v187
    v_exp_f32 v189, v189
    v_add_f32 v14, v14, v188
    s_waitcnt lgkmcnt(6)
    v_mfma_f32_32x32x16_bf16 v[224:239], v[88:91], v[40:43], v[224:239]
    ds_read_b128 v[88:91], v17 offset:34816
    s_waitcnt vmcnt(9)
    buffer_store_dwordx4 v[248:251], v19, s[8:11], s55 offen sc1
    buffer_load_dwordx4 v[248:251], v18, s[36:39], s44 offen
    s_add_u32 s45, s45, 1
    s_add_u32 s44, s44, 128
    s_add_u32 s48, s48, 4096
    s_cmp_lt_u32 s45, 6
    s_cselect_b32 s44, s44, 0x7f000000
    s_cmp_lt_u32 s45, 7
    s_cselect_b32 s55, s48, 0x7f000000
    v_exp_f32 v190, v190
    v_add_f32 v14, v14, v189
    v_cvt_pk_bf16_f32 v186, v188, v189
    v_mfma_f32_32x32x16_bf16 v[224:239], v[92:95], v[44:47], v[224:239]
    ds_read_b128 v[92:95], v17 offset:35840
    v_exp_f32 v191, v191
    v_add_f32 v14, v14, v190
    v_exp_f32 v192, v192
    s_waitcnt lgkmcnt(6)
    v_mfma_f32_32x32x16_bf16 v[224:239], v[96:99], v[48:51], v[224:239]
    ds_read_b128 v[96:99], v16 offset:36864
    v_add_f32 v14, v14, v191
    v_cvt_pk_bf16_f32 v187, v190, v191
    v_exp_f32 v193, v193
    v_add_f32 v14, v14, v192
    v_mfma_f32_32x32x16_bf16 v[224:239], v[100:103], v[52:55], v[224:239]
    ds_read_b128 v[100:103], v16 offset:37888
    v_exp_f32 v194, v194
    v_add_f32 v14, v14, v193
    v_cvt_pk_bf16_f32 v192, v192, v193
    s_waitcnt lgkmcnt(6)
    v_mfma_f32_32x32x16_bf16 v[224:239], v[104:107], v[56:59], v[224:239]
    ds_read_b128 v[104:107], v17 offset:38912
    v_exp_f32 v195, v195
    v_add_f32 v14, v14, v194
    v_exp_f32 v196, v196
    v_mfma_f32_32x32x16_bf16 v[224:239], v[108:111], v[60:63], v[224:239]
    s_setprio 1
    ds_read_b128 v[108:111], v17 offset:39936
    v_add_f32 v14, v14, v195
    v_cvt_pk_bf16_f32 v193, v194, v195
    v_exp_f32 v197, v197
    v_add_f32 v14, v14, v196
    s_waitcnt lgkmcnt(6)
    v_mfma_f32_32x32x16_bf16 v[112:127], v[80:83], v[176:179], v[112:127]
    ds_read_b128 v[80:83], v16 offset:40960
    v_exp_f32 v198, v198
    v_add_f32 v14, v14, v197
    v_cvt_pk_bf16_f32 v194, v196, v197
    v_mfma_f32_32x32x16_bf16 v[128:143], v[84:87], v[176:179], v[128:143]
    ds_read_b128 v[84:87], v16 offset:41984
    v_exp_f32 v199, v199
    v_add_f32 v14, v14, v198
    v_exp_f32 v200, v200
    s_waitcnt lgkmcnt(6)
    v_mfma_f32_32x32x16_bf16 v[144:159], v[88:91], v[176:179], v[144:159]
    ds_read_b128 v[88:91], v17 offset:43008
    s_cmp_eq_u32 s43, s30
    s_cbranch_scc1 L_kva_oa13
L_kva_ob13:
    s_add_u32 s43, s43, 1
    v_add_f32 v14, v14, v199
    v_cvt_pk_bf16_f32 v195, v198, v199
    v_max3_f32 v29, v208, v209, v210
    v_exp_f32 v201, v201
    v_mfma_f32_32x32x16_bf16 v[160:175], v[92:95], v[176:179], v[160:175]
    ds_read_b128 v[92:95], v17 offset:44032
    v_add_f32 v14, v14, v200
    v_exp_f32 v202, v202
    v_max3_f32 v30, v211, v212, v213
    v_add_f32 v14, v14, v201
    s_waitcnt lgkmcnt(6)
    v_mfma_f32_32x32x16_bf16 v[112:127], v[96:99], v[184:187], v[112:127]
    ds_read_b128 v[96:99], v16 offset:45056
    v_cvt_pk_bf16_f32 v200, v200, v201
    v_exp_f32 v203, v203
    v_max3_f32 v29, v29, v214, v215
    v_add_f32 v14, v14, v202
    v_mfma_f32_32x32x16_bf16 v[128:143], v[100:103], v[184:187], v[128:143]
    s_setprio 0
    ds_read_b128 v[100:103], v16 offset:46080
    v_exp_f32 v204, v204
    v_add_f32 v14, v14, v203
    v_max3_f32 v30, v30, v216, v217
    v_cvt_pk_bf16_f32 v201, v202, v203
    s_waitcnt lgkmcnt(6)
    v_mfma_f32_32x32x16_bf16 v[144:159], v[104:107], v[184:187], v[144:159]
    ds_read_b128 v[104:107], v17 offset:47104
    v_exp_f32 v205, v205
    v_add_f32 v14, v14, v204
    v_max3_f32 v29, v29, v218, v219
    v_mfma_f32_32x32x16_bf16 v[160:175], v[108:111], v[184:187], v[160:175]
    ds_read_b128 v[108:111], v17 offset:48128
    v_exp_f32 v206, v206
    v_add_f32 v14, v14, v205
    v_max3_f32 v30, v30, v220, v221
    v_cvt_pk_bf16_f32 v202, v204, v205
    s_nop 0
    s_waitcnt lgkmcnt(6)
    v_mfma_f32_32x32x16_bf16 v[112:127], v[80:83], v[192:195], v[112:127]
    v_exp_f32 v207, v207
    v_add_f32 v14, v14, v206
    v_max3_f32 v29, v29, v222, v223
    v_add_f32 v14, v14, v207
    v_mfma_f32_32x32x16_bf16 v[128:143], v[84:87], v[192:195], v[128:143]
    v_cvt_pk_bf16_f32 v203, v206, v207
    v_max3_f32 v30, v30, v224, v225
    v_max3_f32 v29, v29, v226, v227
    v_max3_f32 v30, v30, v228, v229
    v_max3_f32 v29, v29, v230, v231
    s_bitcmp1_b32 s80, s45
    s_cbranch_scc1 L_kva_oa15
    s_waitcnt vmcnt(2) lgkmcnt(0)
L_kva_ob15:
    s_barrier
    v_mfma_f32_32x32x16_bf16 v[144:159], v[88:91], v[192:195], v[144:159]
    s_setprio 3
    ds_read_b128 v[80:83], v20 offset:0
    ds_read_b128 v[84:87], v20 offset:1024
    ds_read_b128 v[88:91], v20 offset:2048
    v_mov_b32 v24, s54
    buffer_store_dword v24, v25, s[56:59], s25 offen sc1
    s_mov_b32 s25, 0x7f000000
    v_max3_f32 v30, v30, v232, v233
    v_max3_f32 v29, v29, v234, v235
    v_max3_f32 v30, v30, v236, v237
    v_max3_f32 v29, v29, v238, v239
    v_max_f32 v29, v29, v30
    v_mfma_f32_32x32x16_bf16 v[160:175], v[92:95], v[192:195], v[160:175]
    ds_read_b128 v[92:95], v20 offset:3072
    v_cmp_lt_f32 s[40:41], s31, v29
    v_mfma_f32_32x32x16_bf16 v[112:127], v[96:99], v[200:203], v[112:127]
    ds_read_b128 v[96:99], v20 offset:4096
    v_mfma_f32_32x32x16_bf16 v[128:143], v[100:103], v[200:203], v[128:143]
    ds_read_b128 v[100:103], v20 offset:5120
    v_mfma_f32_32x32x16_bf16 v[144:159], v[104:107], v[200:203], v[144:159]
    ds_read_b128 v[104:107], v20 offset:6144
    v_mfma_f32_32x32x16_bf16 v[160:175], v[108:111], v[200:203], v[160:175]
    ds_read_b128 v[108:111], v20 offset:7168
    s_lshl_b32 s4, s46, 14
    s_lshl_b32 s5, s50, 9
    s_add_u32 s4, s4, s5
    s_add_u32 s4, s4, 131072
    v_lshlrev_b32 v5, 3, v0
    v_add_u32 v5, s4, v5
    v_mov_b32 v241, v14
    v_xor_b32 v6, 0x4000, v253
    ds_write_b64 v5, v[240:241]
    v_xor_b32 v5, 0x4000, v5
    v_mov_b32 v30, v29
    s_nop 1
    v_permlane32_swap_b32 v29, v30
    s_nop 1
    v_max_f32 v29, v29, v30
    v_max_f32 v29, 0xf149f2ca, v29
    v_pk_add_f32 v[64:65], 0, v[28:29] op_sel:[0,1] op_sel_hi:[1,1] neg_lo:[0,1] neg_hi:[0,1]
    v_pk_add_f32 v[66:67], 0, v[28:29] op_sel:[0,1] op_sel_hi:[1,1] neg_lo:[0,1] neg_hi:[0,1]
    v_pk_add_f32 v[68:69], 0, v[28:29] op_sel:[0,1] op_sel_hi:[1,1] neg_lo:[0,1] neg_hi:[0,1]
    v_pk_add_f32 v[70:71], 0, v[28:29] op_sel:[0,1] op_sel_hi:[1,1] neg_lo:[0,1] neg_hi:[0,1]
    v_pk_add_f32 v[72:73], 0, v[28:29] op_sel:[0,1] op_sel_hi:[1,1] neg_lo:[0,1] neg_hi:[0,1]
    v_pk_add_f32 v[74:75], 0, v[28:29] op_sel:[0,1] op_sel_hi:[1,1] neg_lo:[0,1] neg_hi:[0,1]
    v_pk_add_f32 v[76:77], 0, v[28:29] op_sel:[0,1] op_sel_hi:[1,1] neg_lo:[0,1] neg_hi:[0,1]
    v_pk_add_f32 v[78:79], 0, v[28:29] op_sel:[0,1] op_sel_hi:[1,1] neg_lo:[0,1] neg_hi:[0,1]
    v_pk_add_f32 v[208:209], v[208:209], v[28:29] op_sel:[0,1] op_sel_hi:[1,1] neg_lo:[0,1] neg_hi:[0,1]
    v_pk_add_f32 v[210:211], v[210:211], v[28:29] op_sel:[0,1] op_sel_hi:[1,1] neg_lo:[0,1] neg_hi:[0,1]
    v_pk_add_f32 v[212:213], v[212:213], v[28:29] op_sel:[0,1] op_sel_hi:[1,1] neg_lo:[0,1] neg_hi:[0,1]
    v_pk_add_f32 v[214:215], v[214:215], v[28:29] op_sel:[0,1] op_sel_hi:[1,1] neg_lo:[0,1] neg_hi:[0,1]
    v_pk_add_f32 v[216:217], v[216:217], v[28:29] op_sel:[0,1] op_sel_hi:[1,1] neg_lo:[0,1] neg_hi:[0,1]
    v_pk_add_f32 v[218:219], v[218:219], v[28:29] op_sel:[0,1] op_sel_hi:[1,1] neg_lo:[0,1] neg_hi:[0,1]
    v_pk_add_f32 v[220:221], v[220:221], v[28:29] op_sel:[0,1] op_sel_hi:[1,1] neg_lo:[0,1] neg_hi:[0,1]
    v_pk_add_f32 v[222:223], v[222:223], v[28:29] op_sel:[0,1] op_sel_hi:[1,1] neg_lo:[0,1] neg_hi:[0,1]
    v_pk_add_f32 v[224:225], v[224:225], v[28:29] op_sel:[0,1] op_sel_hi:[1,1] neg_lo:[0,1] neg_hi:[0,1]
    v_pk_add_f32 v[226:227], v[226:227], v[28:29] op_sel:[0,1] op_sel_hi:[1,1] neg_lo:[0,1] neg_hi:[0,1]
    v_pk_add_f32 v[228:229], v[228:229], v[28:29] op_sel:[0,1] op_sel_hi:[1,1] neg_lo:[0,1] neg_hi:[0,1]
    v_pk_add_f32 v[230:231], v[230:231], v[28:29] op_sel:[0,1] op_sel_hi:[1,1] neg_lo:[0,1] neg_hi:[0,1]
    v_pk_add_f32 v[232:233], v[232:233], v[28:29] op_sel:[0,1] op_sel_hi:[1,1] neg_lo:[0,1] neg_hi:[0,1]
    v_pk_add_f32 v[234:235], v[234:235], v[28:29] op_sel:[0,1] op_sel_hi:[1,1] neg_lo:[0,1] neg_hi:[0,1]
    v_pk_add_f32 v[236:237], v[236:237], v[28:29] op_sel:[0,1] op_sel_hi:[1,1] neg_lo:[0,1] neg_hi:[0,1]
    v_pk_add_f32 v[238:239], v[238:239], v[28:29] op_sel:[0,1] op_sel_hi:[1,1] neg_lo:[0,1] neg_hi:[0,1]
    s_mov_b64 s[40:41], 0
    ds_write_b128 v253, v[144:147] offset:0
    ds_write_b128 v253, v[148:151] offset:1024
    ds_write_b128 v253, v[152:155] offset:2048
    ds_write_b128 v253, v[156:159] offset:3072
    ds_write_b128 v253, v[160:163] offset:4096
    ds_write_b128 v253, v[164:167] offset:5120
    ds_write_b128 v253, v[168:171] offset:6144
    ds_write_b128 v253, v[172:175] offset:7168
    s_waitcnt lgkmcnt(0)
    s_barrier
    ds_read_b64 v[242:243], v5
    ds_read_b128 v[176:179], v6 offset:0
    ds_read_b128 v[180:183], v6 offset:1024
    ds_read_b128 v[184:187], v6 offset:2048
    ds_read_b128 v[188:191], v6 offset:3072
    ds_read_b128 v[192:195], v6 offset:4096
    ds_read_b128 v[196:199], v6 offset:5120
    ds_read_b128 v[200:203], v6 offset:6144
    ds_read_b128 v[204:207], v6 offset:7168
    v_mov_b64 v[144:145], 0
    v_mov_b64 v[146:147], 0
    v_mov_b64 v[148:149], 0
    v_mov_b64 v[150:151], 0
    v_mov_b64 v[152:153], 0
    v_mov_b64 v[154:155], 0
    v_mov_b64 v[156:157], 0
    v_mov_b64 v[158:159], 0
    v_mov_b64 v[160:161], 0
    v_mov_b64 v[162:163], 0
    v_mov_b64 v[164:165], 0
    v_mov_b64 v[166:167], 0
    v_mov_b64 v[168:169], 0
    v_mov_b64 v[170:171], 0
    v_mov_b64 v[172:173], 0
    v_mov_b64 v[174:175], 0
    s_waitcnt lgkmcnt(8)
    v_min_f32 v246, v240, v242
    v_sub_f32 v244, v246, v240
    v_sub_f32 v245, v246, v242
    v_exp_f32 v244, v244
    v_exp_f32 v245, v245
    s_nop 0
    v_mul_f32 v246, v14, v244
    v_fmac_f32 v246, v243, v245
    v_mov_b32 v247, v246
    s_nop 1
    v_permlane32_swap_b32 v246, v247
    s_nop 1
    v_add_f32 v246, v246, v247
    v_rcp_f32 v246, v246
    s_nop 0
    v_mul_f32 v244, v244, v246
    v_mul_f32 v245, v245, v246
    s_waitcnt lgkmcnt(0)
    s_barrier
    s_add_u32 m0, s49, 98304
    s_nop 0
    buffer_load_dwordx4 v12, s[32:35], s24 offen sc1 lds
    buffer_load_dwordx4 v12, s[32:35], s24 offen offset:1024 sc1 lds
    buffer_load_dwordx4 v12, s[32:35], s24 offen offset:2048 sc1 lds
    v_pk_mul_f32 v[112:113], v[112:113], v[244:245] op_sel:[0,0] op_sel_hi:[1,0]
    v_pk_mul_f32 v[114:115], v[114:115], v[244:245] op_sel:[0,0] op_sel_hi:[1,0]
    v_pk_mul_f32 v[116:117], v[116:117], v[244:245] op_sel:[0,0] op_sel_hi:[1,0]
    v_pk_mul_f32 v[118:119], v[118:119], v[244:245] op_sel:[0,0] op_sel_hi:[1,0]
    v_pk_fma_f32 v[112:113], v[176:177], v[244:245], v[112:113] op_sel:[0,1,0] op_sel_hi:[1,1,1]
    v_pk_fma_f32 v[114:115], v[178:179], v[244:245], v[114:115] op_sel:[0,1,0] op_sel_hi:[1,1,1]
    v_pk_fma_f32 v[116:117], v[180:181], v[244:245], v[116:117] op_sel:[0,1,0] op_sel_hi:[1,1,1]
    v_pk_fma_f32 v[118:119], v[182:183], v[244:245], v[118:119] op_sel:[0,1,0] op_sel_hi:[1,1,1]
    v_cvt_pk_bf16_f32 v176, v112, v113
    v_cvt_pk_bf16_f32 v177, v114, v115
    v_cvt_pk_bf16_f32 v178, v116, v117
    v_cvt_pk_bf16_f32 v179, v118, v119
    buffer_store_dwordx4 v[176:179], v12, s[12:15], s22 offen offset:0 sc1
    v_pk_mul_f32 v[120:121], v[120:121], v[244:245] op_sel:[0,0] op_sel_hi:[1,0]
    v_pk_mul_f32 v[122:123], v[122:123], v[244:245] op_sel:[0,0] op_sel_hi:[1,0]
    v_pk_mul_f32 v[124:125], v[124:125], v[244:245] op_sel:[0,0] op_sel_hi:[1,0]
    v_pk_mul_f32 v[126:127], v[126:127], v[244:245] op_sel:[0,0] op_sel_hi:[1,0]
    v_pk_fma_f32 v[120:121], v[184:185], v[244:245], v[120:121] op_sel:[0,1,0] op_sel_hi:[1,1,1]
    v_pk_fma_f32 v[122:123], v[186:187], v[244:245], v[122:123] op_sel:[0,1,0] op_sel_hi:[1,1,1]
    v_pk_fma_f32 v[124:125], v[188:189], v[244:245], v[124:125] op_sel:[0,1,0] op_sel_hi:[1,1,1]
    v_pk_fma_f32 v[126:127], v[190:191], v[244:245], v[126:127] op_sel:[0,1,0] op_sel_hi:[1,1,1]
    v_cvt_pk_bf16_f32 v184, v120, v121
    v_cvt_pk_bf16_f32 v185, v122, v123
    v_cvt_pk_bf16_f32 v186, v124, v125
    v_cvt_pk_bf16_f32 v187, v126, v127
    buffer_store_dwordx4 v[184:187], v12, s[12:15], s22 offen offset:1024 sc1
    v_pk_mul_f32 v[128:129], v[128:129], v[244:245] op_sel:[0,0] op_sel_hi:[1,0]
    v_pk_mul_f32 v[130:131], v[130:131], v[244:245] op_sel:[0,0] op_sel_hi:[1,0]
    v_pk_mul_f32 v[132:133], v[132:133], v[244:245] op_sel:[0,0] op_sel_hi:[1,0]
    v_pk_mul_f32 v[134:135], v[134:135], v[244:245] op_sel:[0,0] op_sel_hi:[1,0]
    v_pk_fma_f32 v[128:129], v[192:193], v[244:245], v[128:129] op_sel:[0,1,0] op_sel_hi:[1,1,1]
    v_pk_fma_f32 v[130:131], v[194:195], v[244:245], v[130:131] op_sel:[0,1,0] op_sel_hi:[1,1,1]
    v_pk_fma_f32 v[132:133], v[196:197], v[244:245], v[132:133] op_sel:[0,1,0] op_sel_hi:[1,1,1]
    v_pk_fma_f32 v[134:135], v[198:199], v[244:245], v[134:135] op_sel:[0,1,0] op_sel_hi:[1,1,1]
    v_cvt_pk_bf16_f32 v192, v128, v129
    v_cvt_pk_bf16_f32 v193, v130, v131
    v_cvt_pk_bf16_f32 v194, v132, v133
    v_cvt_pk_bf16_f32 v195, v134, v135
    buffer_store_dwordx4 v[192:195], v12, s[12:15], s22 offen offset:2048 sc1
    v_pk_mul_f32 v[136:137], v[136:137], v[244:245] op_sel:[0,0] op_sel_hi:[1,0]
    v_pk_mul_f32 v[138:139], v[138:139], v[244:245] op_sel:[0,0] op_sel_hi:[1,0]
    v_pk_mul_f32 v[140:141], v[140:141], v[244:245] op_sel:[0,0] op_sel_hi:[1,0]
    v_pk_mul_f32 v[142:143], v[142:143], v[244:245] op_sel:[0,0] op_sel_hi:[1,0]
    v_pk_fma_f32 v[136:137], v[200:201], v[244:245], v[136:137] op_sel:[0,1,0] op_sel_hi:[1,1,1]
    v_pk_fma_f32 v[138:139], v[202:203], v[244:245], v[138:139] op_sel:[0,1,0] op_sel_hi:[1,1,1]
    v_pk_fma_f32 v[140:141], v[204:205], v[244:245], v[140:141] op_sel:[0,1,0] op_sel_hi:[1,1,1]
    v_pk_fma_f32 v[142:143], v[206:207], v[244:245], v[142:143] op_sel:[0,1,0] op_sel_hi:[1,1,1]
    v_cvt_pk_bf16_f32 v200, v136, v137
    v_cvt_pk_bf16_f32 v201, v138, v139
    v_cvt_pk_bf16_f32 v202, v140, v141
    v_cvt_pk_bf16_f32 v203, v142, v143
    buffer_store_dwordx4 v[200:203], v12, s[12:15], s22 offen offset:3072 sc1
    v_mov_b64 v[112:113], 0
    v_mov_b64 v[114:115], 0
    v_mov_b64 v[116:117], 0
    v_mov_b64 v[118:119], 0
    v_mov_b64 v[120:121], 0
    v_mov_b64 v[122:123], 0
    v_mov_b64 v[124:125], 0
    v_mov_b64 v[126:127], 0
    v_mov_b64 v[128:129], 0
    v_mov_b64 v[130:131], 0
    v_mov_b64 v[132:133], 0
    v_mov_b64 v[134:135], 0
    v_mov_b64 v[136:137], 0
    v_mov_b64 v[138:139], 0
    v_mov_b64 v[140:141], 0
    v_mov_b64 v[142:143], 0
    v_mov_b32 v14, 0
    s_mov_b32 s47, 1
    s_mov_b32 s19, 0
    s_add_u32 s42, s17, 1
    s_mov_b32 s22, s23
    s_mov_b32 s54, 6
    s_mov_b32 s25, s53
    s_cmp_eq_u32 s42, 1
    s_cbranch_scc1 L_kva_l1
    s_branch L_kva_n1
L_kva_l1:
    s_cmp_lg_u64 s[40:41], 0
    s_cbranch_scc1 L_kva_oa16
L_kva_ob16:
    v_mov_b32 v240, v64
    v_mov_b64 v[64:65], 0
    v_mov_b64 v[66:67], 0
    v_mov_b64 v[68:69], 0
    v_mov_b64 v[70:71], 0
    v_mov_b64 v[72:73], 0
    v_mov_b64 v[74:75], 0
    v_mov_b64 v[76:77], 0
    v_mov_b64 v[78:79], 0
    v_lshlrev_b32 v7, 2, v3
    v_sub_u32 v15, v13, v7
    s_lshl_b32 s29, s46, 6
    s_lshl_b32 s30, s17, 7
    s_add_u32 s29, s29, s30
    s_mov_b32 s30, s17
    s_mov_b32 s43, 0
    s_waitcnt lgkmcnt(6)
    v_mfma_f32_32x32x16_bf16 v[176:191], v[80:83], v[32:35], v[64:79]
    ds_read_b128 v[80:83], v20 offset:8192
    buffer_load_dwordx4 v12, s[32:35], s24 offen offset:3072 sc1 lds
    s_mov_b32 s18, s24
    s_and_b32 s24, s92, 15
    s_lshr_b64 s[92:93], s[92:93], 4
    s_lshl_b32 s24, s24, 15
    s_add_u32 s24, s24, s21
    v_exp_f32 v208, v208
    v_exp_f32 v209, v209
    v_add_f32 v14, v14, v208
    v_mfma_f32_32x32x16_bf16 v[176:191], v[84:87], v[36:39], v[176:191]
    ds_read_b128 v[84:87], v20 offset:9216
    v_exp_f32 v210, v210
    v_add_f32 v14, v14, v209
    v_cvt_pk_bf16_f32 v208, v208, v209
    s_waitcnt lgkmcnt(6)
    v_mfma_f32_32x32x16_bf16 v[176:191], v[88:91], v[40:43], v[176:191]
    ds_read_b128 v[88:91], v20 offset:10240
    s_add_u32 m0, s49, 32768
    s_nop 0
    buffer_load_dwordx4 v12, s[60:63], s26 offen sc1 lds
    v_exp_f32 v211, v211
    v_add_f32 v14, v14, v210
    v_exp_f32 v212, v212
    v_mfma_f32_32x32x16_bf16 v[176:191], v[92:95], v[44:47], v[176:191]
    ds_read_b128 v[92:95], v20 offset:11264
    v_add_f32 v14, v14, v211
    v_cvt_pk_bf16_f32 v209, v210, v211
    v_exp_f32 v213, v213
    v_add_f32 v14, v14, v212
    s_waitcnt lgkmcnt(6)
    v_mfma_f32_32x32x16_bf16 v[176:191], v[96:99], v[48:51], v[176:191]
    ds_read_b128 v[96:99], v20 offset:12288
    buffer_load_dwordx4 v12, s[60:63], s26 offen offset:1024 sc1 lds
    v_exp_f32 v214, v214
    v_add_f32 v14, v14, v213
    v_cvt_pk_bf16_f32 v210, v212, v213
    v_mfma_f32_32x32x16_bf16 v[176:191], v[100:103], v[52:55], v[176:191]
    s_setprio 2
    ds_read_b128 v[100:103], v20 offset:13312
    v_exp_f32 v215, v215
    v_add_f32 v14, v14, v214
    v_exp_f32 v216, v216
    s_waitcnt lgkmcnt(6)
    v_mfma_f32_32x32x16_bf16 v[176:191], v[104:107], v[56:59], v[176:191]
    ds_read_b128 v[104:107], v20 offset:14336
    buffer_load_dwordx4 v12, s[60:63], s26 offen offset:2048 sc1 lds
    v_add_f32 v14, v14, v215
    v_cvt_pk_bf16_f32 v211, v214, v215
    v_exp_f32 v217, v217
    v_add_f32 v14, v14, v216
    v_mfma_f32_32x32x16_bf16 v[176:191], v[108:111], v[60:63], v[176:191]
    ds_read_b128 v[108:111], v20 offset:15360
    v_exp_f32 v218, v218
    v_add_f32 v14, v14, v217
    v_cvt_pk_bf16_f32 v216, v216, v217
    s_waitcnt lgkmcnt(6)
    v_mfma_f32_32x32x16_bf16 v[192:207], v[80:83], v[32:35], v[64:79]
    ds_read_b128 v[80:83], v16 offset:0
    buffer_load_dwordx4 v12, s[60:63], s26 offen offset:3072 sc1 lds
    s_mov_b32 s26, s18
    v_exp_f32 v219, v219
    v_add_f32 v14, v14, v218
    v_exp_f32 v220, v220
    v_mfma_f32_32x32x16_bf16 v[192:207], v[84:87], v[36:39], v[192:207]
    ds_read_b128 v[84:87], v16 offset:1024
    v_add_f32 v14, v14, v219
    v_cvt_pk_bf16_f32 v217, v218, v219
    v_exp_f32 v221, v221
    v_add_f32 v14, v14, v220
    s_waitcnt lgkmcnt(6)
    v_mfma_f32_32x32x16_bf16 v[192:207], v[88:91], v[40:43], v[192:207]
    ds_read_b128 v[88:91], v17 offset:2048
    s_waitcnt vmcnt(9)
    buffer_store_dwordx4 v[248:251], v19, s[8:11], s55 offen sc1
    buffer_load_dwordx4 v[248:251], v18, s[36:39], s44 offen
    s_add_u32 s45, s45, 1
    s_add_u32 s44, s44, 128
    s_add_u32 s48, s48, 4096
    s_cmp_lt_u32 s45, 6
    s_cselect_b32 s44, s44, 0x7f000000
    s_cmp_lt_u32 s45, 7
    s_cselect_b32 s55, s48, 0x7f000000
    v_exp_f32 v222, v222
    v_add_f32 v14, v14, v221
    v_cvt_pk_bf16_f32 v218, v220, v221
    v_mfma_f32_32x32x16_bf16 v[192:207], v[92:95], v[44:47], v[192:207]
    ds_read_b128 v[92:95], v17 offset:3072
    v_exp_f32 v223, v223
    v_add_f32 v14, v14, v222
    v_exp_f32 v224, v224
    s_waitcnt lgkmcnt(6)
    v_mfma_f32_32x32x16_bf16 v[192:207], v[96:99], v[48:51], v[192:207]
    ds_read_b128 v[96:99], v16 offset:4096
    v_add_f32 v14, v14, v223
    v_cvt_pk_bf16_f32 v219, v222, v223
    v_exp_f32 v225, v225
    v_add_f32 v14, v14, v224
    v_mfma_f32_32x32x16_bf16 v[192:207], v[100:103], v[52:55], v[192:207]
    ds_read_b128 v[100:103], v16 offset:5120
    v_exp_f32 v226, v226
    v_add_f32 v14, v14, v225
    v_cvt_pk_bf16_f32 v224, v224, v225
    s_waitcnt lgkmcnt(6)
    v_mfma_f32_32x32x16_bf16 v[192:207], v[104:107], v[56:59], v[192:207]
    ds_read_b128 v[104:107], v17 offset:6144
    v_exp_f32 v227, v227
    v_add_f32 v14, v14, v226
    v_exp_f32 v228, v228
    v_mfma_f32_32x32x16_bf16 v[192:207], v[108:111], v[60:63], v[192:207]
    s_setprio 1
    ds_read_b128 v[108:111], v17 offset:7168
    v_add_f32 v14, v14, v227
    v_cvt_pk_bf16_f32 v225, v226, v227
    v_exp_f32 v229, v229
    v_add_f32 v14, v14, v228
    s_waitcnt lgkmcnt(6)
    v_mfma_f32_32x32x16_bf16 v[112:127], v[80:83], v[208:211], v[112:127]
    ds_read_b128 v[80:83], v16 offset:8192
    v_exp_f32 v230, v230
    v_add_f32 v14, v14, v229
    v_cvt_pk_bf16_f32 v226, v228, v229
    v_mfma_f32_32x32x16_bf16 v[128:143], v[84:87], v[208:211], v[128:143]
    ds_read_b128 v[84:87], v16 offset:9216
    v_exp_f32 v231, v231
    v_add_f32 v14, v14, v230
    v_exp_f32 v232, v232
    s_waitcnt lgkmcnt(6)
    v_mfma_f32_32x32x16_bf16 v[144:159], v[88:91], v[208:211], v[144:159]
    ds_read_b128 v[88:91], v17 offset:10240
    s_cmp_eq_u32 s43, s30
    s_cbranch_scc1 L_kva_oa17
L_kva_ob17:
    s_add_u32 s43, s43, 1
    v_add_f32 v14, v14, v231
    v_cvt_pk_bf16_f32 v227, v230, v231
    v_max3_f32 v29, v176, v177, v178
    v_exp_f32 v233, v233
    v_mfma_f32_32x32x16_bf16 v[160:175], v[92:95], v[208:211], v[160:175]
    ds_read_b128 v[92:95], v17 offset:11264
    v_add_f32 v14, v14, v232
    v_exp_f32 v234, v234
    v_max3_f32 v30, v179, v180, v181
    v_add_f32 v14, v14, v233
    s_waitcnt lgkmcnt(6)
    v_mfma_f32_32x32x16_bf16 v[112:127], v[96:99], v[216:219], v[112:127]
    ds_read_b128 v[96:99], v16 offset:12288
    v_cvt_pk_bf16_f32 v232, v232, v233
    v_exp_f32 v235, v235
    v_max3_f32 v29, v29, v182, v183
    v_add_f32 v14, v14, v234
    v_mfma_f32_32x32x16_bf16 v[128:143], v[100:103], v[216:219], v[128:143]
    s_setprio 0
    ds_read_b128 v[100:103], v16 offset:13312
    v_exp_f32 v236, v236
    v_add_f32 v14, v14, v235
    v_max3_f32 v30, v30, v184, v185
    v_cvt_pk_bf16_f32 v233, v234, v235
    s_waitcnt lgkmcnt(6)
    v_mfma_f32_32x32x16_bf16 v[144:159], v[104:107], v[216:219], v[144:159]
    ds_read_b128 v[104:107], v17 offset:14336
    v_exp_f32 v237, v237
    v_add_f32 v14, v14, v236
    v_max3_f32 v29, v29, v186, v187
    v_mfma_f32_32x32x16_bf16 v[160:175], v[108:111], v[216:219], v[160:175]
    ds_read_b128 v[108:111], v17 offset:15360
    v_exp_f32 v238, v238
    v_add_f32 v14, v14, v237
    v_max3_f32 v30, v30, v188, v189
    v_cvt_pk_bf16_f32 v234, v236, v237
    s_nop 0
    s_waitcnt lgkmcnt(6)
    v_mfma_f32_32x32x16_bf16 v[112:127], v[80:83], v[224:227], v[112:127]
    v_exp_f32 v239, v239
    v_add_f32 v14, v14, v238
    v_max3_f32 v29, v29, v190, v191
    v_add_f32 v14, v14, v239
    v_mfma_f32_32x32x16_bf16 v[128:143], v[84:87], v[224:227], v[128:143]
    v_cvt_pk_bf16_f32 v235, v238, v239
    v_max3_f32 v30, v30, v192, v193
    v_max3_f32 v29, v29, v194, v195
    v_max3_f32 v30, v30, v196, v197
    v_max3_f32 v29, v29, v198, v199
    s_bitcmp1_b32 s80, s45
    s_cbranch_scc1 L_kva_oa19
    s_waitcnt vmcnt(2) lgkmcnt(0)
L_kva_ob19:
    s_barrier
    v_mfma_f32_32x32x16_bf16 v[144:159], v[88:91], v[224:227], v[144:159]
    s_setprio 3
    ds_read_b128 v[80:83], v20 offset:32768
    ds_read_b128 v[84:87], v20 offset:33792
    ds_read_b128 v[88:91], v20 offset:34816
    v_mov_b32 v24, s54
    buffer_store_dword v24, v25, s[56:59], s25 offen sc1
    s_mov_b32 s25, 0x7f000000
    v_max3_f32 v30, v30, v200, v201
    v_max3_f32 v29, v29, v202, v203
    v_max3_f32 v30, v30, v204, v205
    v_max3_f32 v29, v29, v206, v207
    v_max_f32 v29, v29, v30
    v_mfma_f32_32x32x16_bf16 v[160:175], v[92:95], v[224:227], v[160:175]
    ds_read_b128 v[92:95], v20 offset:35840
    v_cmp_lt_f32 s[40:41], s31, v29
    v_mfma_f32_32x32x16_bf16 v[112:127], v[96:99], v[232:235], v[112:127]
    ds_read_b128 v[96:99], v20 offset:36864
    v_mfma_f32_32x32x16_bf16 v[128:143], v[100:103], v[232:235], v[128:143]
    ds_read_b128 v[100:103], v20 offset:37888
    v_mfma_f32_32x32x16_bf16 v[144:159], v[104:107], v[232:235], v[144:159]
    ds_read_b128 v[104:107], v20 offset:38912
    v_mfma_f32_32x32x16_bf16 v[160:175], v[108:111], v[232:235], v[160:175]
    ds_read_b128 v[108:111], v20 offset:39936
    s_lshl_b32 s4, s46, 14
    s_lshl_b32 s5, s50, 9
    s_add_u32 s4, s4, s5
    s_add_u32 s4, s4, 131072
    v_lshlrev_b32 v5, 3, v0
    v_add_u32 v5, s4, v5
    v_mov_b32 v241, v14
    v_xor_b32 v6, 0x4000, v254
    ds_write_b64 v5, v[240:241]
    v_xor_b32 v5, 0x4000, v5
    v_mov_b32 v30, v29
    s_nop 1
    v_permlane32_swap_b32 v29, v30
    s_nop 1
    v_max_f32 v29, v29, v30
    v_max_f32 v29, 0xf149f2ca, v29
    v_pk_add_f32 v[64:65], 0, v[28:29] op_sel:[0,1] op_sel_hi:[1,1] neg_lo:[0,1] neg_hi:[0,1]
    v_pk_add_f32 v[66:67], 0, v[28:29] op_sel:[0,1] op_sel_hi:[1,1] neg_lo:[0,1] neg_hi:[0,1]
    v_pk_add_f32 v[68:69], 0, v[28:29] op_sel:[0,1] op_sel_hi:[1,1] neg_lo:[0,1] neg_hi:[0,1]
    v_pk_add_f32 v[70:71], 0, v[28:29] op_sel:[0,1] op_sel_hi:[1,1] neg_lo:[0,1] neg_hi:[0,1]
    v_pk_add_f32 v[72:73], 0, v[28:29] op_sel:[0,1] op_sel_hi:[1,1] neg_lo:[0,1] neg_hi:[0,1]
    v_pk_add_f32 v[74:75], 0, v[28:29] op_sel:[0,1] op_sel_hi:[1,1] neg_lo:[0,1] neg_hi:[0,1]
    v_pk_add_f32 v[76:77], 0, v[28:29] op_sel:[0,1] op_sel_hi:[1,1] neg_lo:[0,1] neg_hi:[0,1]
    v_pk_add_f32 v[78:79], 0, v[28:29] op_sel:[0,1] op_sel_hi:[1,1] neg_lo:[0,1] neg_hi:[0,1]
    v_pk_add_f32 v[176:177], v[176:177], v[28:29] op_sel:[0,1] op_sel_hi:[1,1] neg_lo:[0,1] neg_hi:[0,1]
    v_pk_add_f32 v[178:179], v[178:179], v[28:29] op_sel:[0,1] op_sel_hi:[1,1] neg_lo:[0,1] neg_hi:[0,1]
    v_pk_add_f32 v[180:181], v[180:181], v[28:29] op_sel:[0,1] op_sel_hi:[1,1] neg_lo:[0,1] neg_hi:[0,1]
    v_pk_add_f32 v[182:183], v[182:183], v[28:29] op_sel:[0,1] op_sel_hi:[1,1] neg_lo:[0,1] neg_hi:[0,1]
    v_pk_add_f32 v[184:185], v[184:185], v[28:29] op_sel:[0,1] op_sel_hi:[1,1] neg_lo:[0,1] neg_hi:[0,1]
    v_pk_add_f32 v[186:187], v[186:187], v[28:29] op_sel:[0,1] op_sel_hi:[1,1] neg_lo:[0,1] neg_hi:[0,1]
    v_pk_add_f32 v[188:189], v[188:189], v[28:29] op_sel:[0,1] op_sel_hi:[1,1] neg_lo:[0,1] neg_hi:[0,1]
    v_pk_add_f32 v[190:191], v[190:191], v[28:29] op_sel:[0,1] op_sel_hi:[1,1] neg_lo:[0,1] neg_hi:[0,1]
    v_pk_add_f32 v[192:193], v[192:193], v[28:29] op_sel:[0,1] op_sel_hi:[1,1] neg_lo:[0,1] neg_hi:[0,1]
    v_pk_add_f32 v[194:195], v[194:195], v[28:29] op_sel:[0,1] op_sel_hi:[1,1] neg_lo:[0,1] neg_hi:[0,1]
    v_pk_add_f32 v[196:197], v[196:197], v[28:29] op_sel:[0,1] op_sel_hi:[1,1] neg_lo:[0,1] neg_hi:[0,1]
    v_pk_add_f32 v[198:199], v[198:199], v[28:29] op_sel:[0,1] op_sel_hi:[1,1] neg_lo:[0,1] neg_hi:[0,1]
    v_pk_add_f32 v[200:201], v[200:201], v[28:29] op_sel:[0,1] op_sel_hi:[1,1] neg_lo:[0,1] neg_hi:[0,1]
    v_pk_add_f32 v[202:203], v[202:203], v[28:29] op_sel:[0,1] op_sel_hi:[1,1] neg_lo:[0,1] neg_hi:[0,1]
    v_pk_add_f32 v[204:205], v[204:205], v[28:29] op_sel:[0,1] op_sel_hi:[1,1] neg_lo:[0,1] neg_hi:[0,1]
    v_pk_add_f32 v[206:207], v[206:207], v[28:29] op_sel:[0,1] op_sel_hi:[1,1] neg_lo:[0,1] neg_hi:[0,1]
    s_mov_b64 s[40:41], 0
    ds_write_b128 v254, v[144:147] offset:0
    ds_write_b128 v254, v[148:151] offset:1024
    ds_write_b128 v254, v[152:155] offset:2048
    ds_write_b128 v254, v[156:159] offset:3072
    ds_write_b128 v254, v[160:163] offset:4096
    ds_write_b128 v254, v[164:167] offset:5120
    ds_write_b128 v254, v[168:171] offset:6144
    ds_write_b128 v254, v[172:175] offset:7168
    s_waitcnt lgkmcnt(0)
    s_barrier
    ds_read_b64 v[242:243], v5
    ds_read_b128 v[208:211], v6 offset:0
    ds_read_b128 v[212:215], v6 offset:1024
    ds_read_b128 v[216:219], v6 offset:2048
    ds_read_b128 v[220:223], v6 offset:3072
    ds_read_b128 v[224:227], v6 offset:4096
    ds_read_b128 v[228:231], v6 offset:5120
    ds_read_b128 v[232:235], v6 offset:6144
    ds_read_b128 v[236:239], v6 offset:7168
    v_mov_b64 v[144:145], 0
    v_mov_b64 v[146:147], 0
    v_mov_b64 v[148:149], 0
    v_mov_b64 v[150:151], 0
    v_mov_b64 v[152:153], 0
    v_mov_b64 v[154:155], 0
    v_mov_b64 v[156:157], 0
    v_mov_b64 v[158:159], 0
    v_mov_b64 v[160:161], 0
    v_mov_b64 v[162:163], 0
    v_mov_b64 v[164:165], 0
    v_mov_b64 v[166:167], 0
    v_mov_b64 v[168:169], 0
    v_mov_b64 v[170:171], 0
    v_mov_b64 v[172:173], 0
    v_mov_b64 v[174:175], 0
    s_waitcnt lgkmcnt(8)
    v_min_f32 v246, v240, v242
    v_sub_f32 v244, v246, v240
    v_sub_f32 v245, v246, v242
    v_exp_f32 v244, v244
    v_exp_f32 v245, v245
    s_nop 0
    v_mul_f32 v246, v14, v244
    v_fmac_f32 v246, v243, v245
    v_mov_b32 v247, v246
    s_nop 1
    v_permlane32_swap_b32 v246, v247
    s_nop 1
    v_add_f32 v246, v246, v247
    v_rcp_f32 v246, v246
    s_nop 0
    v_mul_f32 v244, v244, v246
    v_mul_f32 v245, v245, v246
    s_waitcnt lgkmcnt(0)
    s_barrier
    s_add_u32 m0, s49, 65536
    s_nop 0
    buffer_load_dwordx4 v12, s[32:35], s24 offen sc1 lds
    buffer_load_dwordx4 v12, s[32:35], s24 offen offset:1024 sc1 lds
    buffer_load_dwordx4 v12, s[32:35], s24 offen offset:2048 sc1 lds
    v_pk_mul_f32 v[112:113], v[112:113], v[244:245] op_sel:[0,0] op_sel_hi:[1,0]
    v_pk_mul_f32 v[114:115], v[114:115], v[244:245] op_sel:[0,0] op_sel_hi:[1,0]
    v_pk_mul_f32 v[116:117], v[116:117], v[244:245] op_sel:[0,0] op_sel_hi:[1,0]
    v_pk_mul_f32 v[118:119], v[118:119], v[244:245] op_sel:[0,0] op_sel_hi:[1,0]
    v_pk_fma_f32 v[112:113], v[208:209], v[244:245], v[112:113] op_sel:[0,1,0] op_sel_hi:[1,1,1]
    v_pk_fma_f32 v[114:115], v[210:211], v[244:245], v[114:115] op_sel:[0,1,0] op_sel_hi:[1,1,1]
    v_pk_fma_f32 v[116:117], v[212:213], v[244:245], v[116:117] op_sel:[0,1,0] op_sel_hi:[1,1,1]
    v_pk_fma_f32 v[118:119], v[214:215], v[244:245], v[118:119] op_sel:[0,1,0] op_sel_hi:[1,1,1]
    v_cvt_pk_bf16_f32 v208, v112, v113
    v_cvt_pk_bf16_f32 v209, v114, v115
    v_cvt_pk_bf16_f32 v210, v116, v117
    v_cvt_pk_bf16_f32 v211, v118, v119
    buffer_store_dwordx4 v[208:211], v12, s[12:15], s22 offen offset:0 sc1
    v_pk_mul_f32 v[120:121], v[120:121], v[244:245] op_sel:[0,0] op_sel_hi:[1,0]
    v_pk_mul_f32 v[122:123], v[122:123], v[244:245] op_sel:[0,0] op_sel_hi:[1,0]
    v_pk_mul_f32 v[124:125], v[124:125], v[244:245] op_sel:[0,0] op_sel_hi:[1,0]
    v_pk_mul_f32 v[126:127], v[126:127], v[244:245] op_sel:[0,0] op_sel_hi:[1,0]
    v_pk_fma_f32 v[120:121], v[216:217], v[244:245], v[120:121] op_sel:[0,1,0] op_sel_hi:[1,1,1]
    v_pk_fma_f32 v[122:123], v[218:219], v[244:245], v[122:123] op_sel:[0,1,0] op_sel_hi:[1,1,1]
    v_pk_fma_f32 v[124:125], v[220:221], v[244:245], v[124:125] op_sel:[0,1,0] op_sel_hi:[1,1,1]
    v_pk_fma_f32 v[126:127], v[222:223], v[244:245], v[126:127] op_sel:[0,1,0] op_sel_hi:[1,1,1]
    v_cvt_pk_bf16_f32 v216, v120, v121
    v_cvt_pk_bf16_f32 v217, v122, v123
    v_cvt_pk_bf16_f32 v218, v124, v125
    v_cvt_pk_bf16_f32 v219, v126, v127
    buffer_store_dwordx4 v[216:219], v12, s[12:15], s22 offen offset:1024 sc1
    v_pk_mul_f32 v[128:129], v[128:129], v[244:245] op_sel:[0,0] op_sel_hi:[1,0]
    v_pk_mul_f32 v[130:131], v[130:131], v[244:245] op_sel:[0,0] op_sel_hi:[1,0]
    v_pk_mul_f32 v[132:133], v[132:133], v[244:245] op_sel:[0,0] op_sel_hi:[1,0]
    v_pk_mul_f32 v[134:135], v[134:135], v[244:245] op_sel:[0,0] op_sel_hi:[1,0]
    v_pk_fma_f32 v[128:129], v[224:225], v[244:245], v[128:129] op_sel:[0,1,0] op_sel_hi:[1,1,1]
    v_pk_fma_f32 v[130:131], v[226:227], v[244:245], v[130:131] op_sel:[0,1,0] op_sel_hi:[1,1,1]
    v_pk_fma_f32 v[132:133], v[228:229], v[244:245], v[132:133] op_sel:[0,1,0] op_sel_hi:[1,1,1]
    v_pk_fma_f32 v[134:135], v[230:231], v[244:245], v[134:135] op_sel:[0,1,0] op_sel_hi:[1,1,1]
    v_cvt_pk_bf16_f32 v224, v128, v129
    v_cvt_pk_bf16_f32 v225, v130, v131
    v_cvt_pk_bf16_f32 v226, v132, v133
    v_cvt_pk_bf16_f32 v227, v134, v135
    buffer_store_dwordx4 v[224:227], v12, s[12:15], s22 offen offset:2048 sc1
    v_pk_mul_f32 v[136:137], v[136:137], v[244:245] op_sel:[0,0] op_sel_hi:[1,0]
    v_pk_mul_f32 v[138:139], v[138:139], v[244:245] op_sel:[0,0] op_sel_hi:[1,0]
    v_pk_mul_f32 v[140:141], v[140:141], v[244:245] op_sel:[0,0] op_sel_hi:[1,0]
    v_pk_mul_f32 v[142:143], v[142:143], v[244:245] op_sel:[0,0] op_sel_hi:[1,0]
    v_pk_fma_f32 v[136:137], v[232:233], v[244:245], v[136:137] op_sel:[0,1,0] op_sel_hi:[1,1,1]
    v_pk_fma_f32 v[138:139], v[234:235], v[244:245], v[138:139] op_sel:[0,1,0] op_sel_hi:[1,1,1]
    v_pk_fma_f32 v[140:141], v[236:237], v[244:245], v[140:141] op_sel:[0,1,0] op_sel_hi:[1,1,1]
    v_pk_fma_f32 v[142:143], v[238:239], v[244:245], v[142:143] op_sel:[0,1,0] op_sel_hi:[1,1,1]
    v_cvt_pk_bf16_f32 v232, v136, v137
    v_cvt_pk_bf16_f32 v233, v138, v139
    v_cvt_pk_bf16_f32 v234, v140, v141
    v_cvt_pk_bf16_f32 v235, v142, v143
    buffer_store_dwordx4 v[232:235], v12, s[12:15], s22 offen offset:3072 sc1
    v_mov_b64 v[112:113], 0
    v_mov_b64 v[114:115], 0
    v_mov_b64 v[116:117], 0
    v_mov_b64 v[118:119], 0
    v_mov_b64 v[120:121], 0
    v_mov_b64 v[122:123], 0
    v_mov_b64 v[124:125], 0
    v_mov_b64 v[126:127], 0
    v_mov_b64 v[128:129], 0
    v_mov_b64 v[130:131], 0
    v_mov_b64 v[132:133], 0
    v_mov_b64 v[134:135], 0
    v_mov_b64 v[136:137], 0
    v_mov_b64 v[138:139], 0
    v_mov_b64 v[140:141], 0
    v_mov_b64 v[142:143], 0
    v_mov_b32 v14, 0
    s_mov_b32 s47, 1
    s_mov_b32 s19, 0
    s_add_u32 s42, s17, 1
    s_mov_b32 s22, s23
    s_mov_b32 s54, 6
    s_mov_b32 s25, s53
    s_cmp_eq_u32 s42, 1
    s_cbranch_scc1 L_kva_l0
    s_branch L_kva_n0
L_kva_oa2:
    s_nop 7
    v_mov_b32 v30, v29
    s_nop 1
    v_permlane32_swap_b32 v29, v30
    s_nop 1
    v_max_f32 v29, v29, v30
    v_max_f32 v29, v29, v28
    v_min_f32 v30, s52, -v29
    v_exp_f32 v30, v30
    v_mov_b32 v28, 0
    v_mul_f32 v14, v14, v30
    v_pk_add_f32 v[176:177], v[176:177], v[28:29] op_sel:[0,1] op_sel_hi:[1,1] neg_lo:[0,1] neg_hi:[0,1]
    v_pk_add_f32 v[178:179], v[178:179], v[28:29] op_sel:[0,1] op_sel_hi:[1,1] neg_lo:[0,1] neg_hi:[0,1]
    v_pk_add_f32 v[180:181], v[180:181], v[28:29] op_sel:[0,1] op_sel_hi:[1,1] neg_lo:[0,1] neg_hi:[0,1]
    v_pk_add_f32 v[182:183], v[182:183], v[28:29] op_sel:[0,1] op_sel_hi:[1,1] neg_lo:[0,1] neg_hi:[0,1]
    v_pk_add_f32 v[184:185], v[184:185], v[28:29] op_sel:[0,1] op_sel_hi:[1,1] neg_lo:[0,1] neg_hi:[0,1]
    v_pk_add_f32 v[186:187], v[186:187], v[28:29] op_sel:[0,1] op_sel_hi:[1,1] neg_lo:[0,1] neg_hi:[0,1]
    v_pk_add_f32 v[188:189], v[188:189], v[28:29] op_sel:[0,1] op_sel_hi:[1,1] neg_lo:[0,1] neg_hi:[0,1]
    v_pk_add_f32 v[190:191], v[190:191], v[28:29] op_sel:[0,1] op_sel_hi:[1,1] neg_lo:[0,1] neg_hi:[0,1]
    v_pk_add_f32 v[192:193], v[192:193], v[28:29] op_sel:[0,1] op_sel_hi:[1,1] neg_lo:[0,1] neg_hi:[0,1]
    v_pk_add_f32 v[194:195], v[194:195], v[28:29] op_sel:[0,1] op_sel_hi:[1,1] neg_lo:[0,1] neg_hi:[0,1]
    v_pk_add_f32 v[196:197], v[196:197], v[28:29] op_sel:[0,1] op_sel_hi:[1,1] neg_lo:[0,1] neg_hi:[0,1]
    v_pk_add_f32 v[198:199], v[198:199], v[28:29] op_sel:[0,1] op_sel_hi:[1,1] neg_lo:[0,1] neg_hi:[0,1]
    v_pk_add_f32 v[200:201], v[200:201], v[28:29] op_sel:[0,1] op_sel_hi:[1,1] neg_lo:[0,1] neg_hi:[0,1]
    v_pk_add_f32 v[202:203], v[202:203], v[28:29] op_sel:[0,1] op_sel_hi:[1,1] neg_lo:[0,1] neg_hi:[0,1]
    v_pk_add_f32 v[204:205], v[204:205], v[28:29] op_sel:[0,1] op_sel_hi:[1,1] neg_lo:[0,1] neg_hi:[0,1]
    v_pk_add_f32 v[206:207], v[206:207], v[28:29] op_sel:[0,1] op_sel_hi:[1,1] neg_lo:[0,1] neg_hi:[0,1]
    v_pk_add_f32 v[64:65], v[64:65], v[28:29] op_sel:[0,1] op_sel_hi:[1,1] neg_lo:[0,1] neg_hi:[0,1]
    v_pk_add_f32 v[66:67], v[66:67], v[28:29] op_sel:[0,1] op_sel_hi:[1,1] neg_lo:[0,1] neg_hi:[0,1]
    v_pk_add_f32 v[68:69], v[68:69], v[28:29] op_sel:[0,1] op_sel_hi:[1,1] neg_lo:[0,1] neg_hi:[0,1]
    v_pk_add_f32 v[70:71], v[70:71], v[28:29] op_sel:[0,1] op_sel_hi:[1,1] neg_lo:[0,1] neg_hi:[0,1]
    v_pk_add_f32 v[72:73], v[72:73], v[28:29] op_sel:[0,1] op_sel_hi:[1,1] neg_lo:[0,1] neg_hi:[0,1]
    v_pk_add_f32 v[74:75], v[74:75], v[28:29] op_sel:[0,1] op_sel_hi:[1,1] neg_lo:[0,1] neg_hi:[0,1]
    v_pk_add_f32 v[76:77], v[76:77], v[28:29] op_sel:[0,1] op_sel_hi:[1,1] neg_lo:[0,1] neg_hi:[0,1]
    v_pk_add_f32 v[78:79], v[78:79], v[28:29] op_sel:[0,1] op_sel_hi:[1,1] neg_lo:[0,1] neg_hi:[0,1]
    v_pk_mul_f32 v[112:113], v[112:113], v[30:31] op_sel:[0,0] op_sel_hi:[1,0]
    v_pk_mul_f32 v[114:115], v[114:115], v[30:31] op_sel:[0,0] op_sel_hi:[1,0]
    v_pk_mul_f32 v[116:117], v[116:117], v[30:31] op_sel:[0,0] op_sel_hi:[1,0]
    v_pk_mul_f32 v[118:119], v[118:119], v[30:31] op_sel:[0,0] op_sel_hi:[1,0]
    v_pk_mul_f32 v[120:121], v[120:121], v[30:31] op_sel:[0,0] op_sel_hi:[1,0]
    v_pk_mul_f32 v[122:123], v[122:123], v[30:31] op_sel:[0,0] op_sel_hi:[1,0]
    v_pk_mul_f32 v[124:125], v[124:125], v[30:31] op_sel:[0,0] op_sel_hi:[1,0]
    v_pk_mul_f32 v[126:127], v[126:127], v[30:31] op_sel:[0,0] op_sel_hi:[1,0]
    v_pk_mul_f32 v[128:129], v[128:129], v[30:31] op_sel:[0,0] op_sel_hi:[1,0]
    v_pk_mul_f32 v[130:131], v[130:131], v[30:31] op_sel:[0,0] op_sel_hi:[1,0]
    v_pk_mul_f32 v[132:133], v[132:133], v[30:31] op_sel:[0,0] op_sel_hi:[1,0]
    v_pk_mul_f32 v[134:135], v[134:135], v[30:31] op_sel:[0,0] op_sel_hi:[1,0]
    v_pk_mul_f32 v[136:137], v[136:137], v[30:31] op_sel:[0,0] op_sel_hi:[1,0]
    v_pk_mul_f32 v[138:139], v[138:139], v[30:31] op_sel:[0,0] op_sel_hi:[1,0]
    v_pk_mul_f32 v[140:141], v[140:141], v[30:31] op_sel:[0,0] op_sel_hi:[1,0]
    v_pk_mul_f32 v[142:143], v[142:143], v[30:31] op_sel:[0,0] op_sel_hi:[1,0]
    v_pk_mul_f32 v[144:145], v[144:145], v[30:31] op_sel:[0,0] op_sel_hi:[1,0]
    v_pk_mul_f32 v[146:147], v[146:147], v[30:31] op_sel:[0,0] op_sel_hi:[1,0]
    v_pk_mul_f32 v[148:149], v[148:149], v[30:31] op_sel:[0,0] op_sel_hi:[1,0]
    v_pk_mul_f32 v[150:151], v[150:151], v[30:31] op_sel:[0,0] op_sel_hi:[1,0]
    v_pk_mul_f32 v[152:153], v[152:153], v[30:31] op_sel:[0,0] op_sel_hi:[1,0]
    v_pk_mul_f32 v[154:155], v[154:155], v[30:31] op_sel:[0,0] op_sel_hi:[1,0]
    v_pk_mul_f32 v[156:157], v[156:157], v[30:31] op_sel:[0,0] op_sel_hi:[1,0]
    v_pk_mul_f32 v[158:159], v[158:159], v[30:31] op_sel:[0,0] op_sel_hi:[1,0]
    v_pk_mul_f32 v[160:161], v[160:161], v[30:31] op_sel:[0,0] op_sel_hi:[1,0]
    v_pk_mul_f32 v[162:163], v[162:163], v[30:31] op_sel:[0,0] op_sel_hi:[1,0]
    v_pk_mul_f32 v[164:165], v[164:165], v[30:31] op_sel:[0,0] op_sel_hi:[1,0]
    v_pk_mul_f32 v[166:167], v[166:167], v[30:31] op_sel:[0,0] op_sel_hi:[1,0]
    v_pk_mul_f32 v[168:169], v[168:169], v[30:31] op_sel:[0,0] op_sel_hi:[1,0]
    v_pk_mul_f32 v[170:171], v[170:171], v[30:31] op_sel:[0,0] op_sel_hi:[1,0]
    v_pk_mul_f32 v[172:173], v[172:173], v[30:31] op_sel:[0,0] op_sel_hi:[1,0]
    v_pk_mul_f32 v[174:175], v[174:175], v[30:31] op_sel:[0,0] op_sel_hi:[1,0]
    s_branch L_kva_ob2
L_kva_oa3:
    v_subrev_u32 v6, s29, v15
    v_mov_b32 v7, 0xff800000
    v_cmp_gt_i32 s[4:5], 0, v6
    v_cmp_gt_i32 s[6:7], 1, v6
    v_cmp_gt_i32 vcc, 2, v6
    v_cndmask_b32 v208, v208, v7, s[4:5]
    v_cmp_gt_i32 s[4:5], 3, v6
    v_cndmask_b32 v209, v209, v7, s[6:7]
    v_cmp_gt_i32 s[6:7], 8, v6
    v_cndmask_b32 v210, v210, v7, vcc
    v_cmp_gt_i32 vcc, 9, v6
    v_cndmask_b32 v211, v211, v7, s[4:5]
    v_cmp_gt_i32 s[4:5], 10, v6
    v_cndmask_b32 v212, v212, v7, s[6:7]
    v_cmp_gt_i32 s[6:7], 11, v6
    v_cndmask_b32 v213, v213, v7, vcc
    v_cmp_gt_i32 vcc, 16, v6
    v_cndmask_b32 v214, v214, v7, s[4:5]
    v_cmp_gt_i32 s[4:5], 17, v6
    v_cndmask_b32 v215, v215, v7, s[6:7]
    v_cmp_gt_i32 s[6:7], 18, v6
    v_cndmask_b32 v216, v216, v7, vcc
    v_cmp_gt_i32 vcc, 19, v6
    v_cndmask_b32 v217, v217, v7, s[4:5]
    v_cmp_gt_i32 s[4:5], 24, v6
    v_cndmask_b32 v218, v218, v7, s[6:7]
    v_cmp_gt_i32 s[6:7], 25, v6
    v_cndmask_b32 v219, v219, v7, vcc
    v_cmp_gt_i32 vcc, 26, v6
    v_cndmask_b32 v220, v220, v7, s[4:5]
    v_cmp_gt_i32 s[4:5], 27, v6
    v_cndmask_b32 v221, v221, v7, s[6:7]
    v_cmp_gt_i32 s[6:7], 32, v6
    v_cndmask_b32 v222, v222, v7, vcc
    v_cmp_gt_i32 vcc, 33, v6
    v_cndmask_b32 v223, v223, v7, s[4:5]
    v_cmp_gt_i32 s[4:5], 34, v6
    v_cndmask_b32 v224, v224, v7, s[6:7]
    v_cmp_gt_i32 s[6:7], 35, v6
    v_cndmask_b32 v225, v225, v7, vcc
    v_cmp_gt_i32 vcc, 40, v6
    v_cndmask_b32 v226, v226, v7, s[4:5]
    v_cmp_gt_i32 s[4:5], 41, v6
    v_cndmask_b32 v227, v227, v7, s[6:7]
    v_cmp_gt_i32 s[6:7], 42, v6
    v_cndmask_b32 v228, v228, v7, vcc
    v_cmp_gt_i32 vcc, 43, v6
    v_cndmask_b32 v229, v229, v7, s[4:5]
    v_cmp_gt_i32 s[4:5], 48, v6
    v_cndmask_b32 v230, v230, v7, s[6:7]
    v_cmp_gt_i32 s[6:7], 49, v6
    v_cndmask_b32 v231, v231, v7, vcc
    v_cmp_gt_i32 vcc, 50, v6
    v_cndmask_b32 v232, v232, v7, s[4:5]
    v_cmp_gt_i32 s[4:5], 51, v6
    v_cndmask_b32 v233, v233, v7, s[6:7]
    v_cmp_gt_i32 s[6:7], 56, v6
    v_cndmask_b32 v234, v234, v7, vcc
    v_cmp_gt_i32 vcc, 57, v6
    v_cndmask_b32 v235, v235, v7, s[4:5]
    v_cmp_gt_i32 s[4:5], 58, v6
    v_cndmask_b32 v236, v236, v7, s[6:7]
    v_cmp_gt_i32 s[6:7], 59, v6
    v_cndmask_b32 v237, v237, v7, vcc
    v_cndmask_b32 v238, v238, v7, s[4:5]
    v_cndmask_b32 v239, v239, v7, s[6:7]
    s_branch L_kva_ob3
L_kva_oa4:
    ds_read_b128 v[32:35], v252 offset:0
    ds_read_b128 v[36:39], v252 offset:1024
    ds_read_b128 v[40:43], v252 offset:2048
    ds_read_b128 v[44:47], v252 offset:3072
    ds_read_b128 v[48:51], v252 offset:4096
    ds_read_b128 v[52:55], v252 offset:5120
    ds_read_b128 v[56:59], v252 offset:6144
    ds_read_b128 v[60:63], v252 offset:7168
    s_branch L_kva_ob4
L_kva_oa6:
    s_cmp_gt_u32 s45, 7
    s_cbranch_scc1 L_kva_ev5_w
    s_cmp_lt_u32 s45, 4
    s_cbranch_scc1 L_kva_ev5_3
    s_waitcnt vmcnt(3) lgkmcnt(0)
    s_branch L_kva_ev5_e
L_kva_ev5_3:
    s_cmp_lt_u32 s45, 3
    s_cbranch_scc1 L_kva_ev5_2
    s_waitcnt vmcnt(4) lgkmcnt(0)
    s_branch L_kva_ev5_e
L_kva_ev5_2:
    s_cmp_lt_u32 s45, 2
    s_cbranch_scc1 L_kva_ev5_1
    s_waitcnt vmcnt(10) lgkmcnt(0)
    s_branch L_kva_ev5_e
L_kva_ev5_1:
    s_waitcnt vmcnt(8) lgkmcnt(0)
    s_branch L_kva_ev5_p
L_kva_ev5_w:
    s_waitcnt vmcnt(2) lgkmcnt(0)
    s_cmp_lt_u32 s45, 15
    s_cbranch_scc1 L_kva_ev5_p
    s_mov_b32 s24, s78
    s_add_u32 s78, s78, 4096
    s_cmp_eq_u32 s45, 16
    s_cselect_b32 s26, s79, s26
    s_branch L_kva_ev5_e
L_kva_ev5_p:
    s_cmp_eq_u32 s45, 11
    s_cbranch_scc1 L_kva_ev5_i
    s_mov_b32 s7, 0x40000
L_kva_ev5_a:
    v_cmp_gt_u32 vcc, v23, v21
    s_sub_u32 s7, s7, 1
    s_nop 2
    s_cbranch_vccz L_kva_ev5_e
    s_cmp_eq_u32 s7, 0
    s_cbranch_scc1 L_kva_ev5_e
    s_sleep 2
    buffer_load_dword v21, v22, s[56:59], 0 offen sc1
    s_waitcnt vmcnt(0)
    s_branch L_kva_ev5_a
L_kva_ev5_i:
    s_lshl_b32 s4, s20, 12
    s_add_u32 s4, s4, 0x10000
    v_lshlrev_b32 v22, 7, v0
    v_add_u32 v22, s4, v22
    v_mov_b32 v7, 0x7f000000
    v_cmp_gt_u32 vcc, 32, v0
    s_nop 1
    v_cndmask_b32 v22, v7, v22, vcc
    v_cndmask_b32 v23, 0, 5, vcc
    buffer_load_dword v21, v22, s[56:59], 0 offen sc1
L_kva_ev5_e:
    s_branch L_kva_ob6
L_kva_oa7:
    s_nop 7
    v_mov_b32 v30, v29
    s_nop 1
    v_permlane32_swap_b32 v29, v30
    s_nop 1
    v_max_f32 v29, v29, v30
    v_max_f32 v29, v29, v28
    v_min_f32 v30, s52, -v29
    v_exp_f32 v30, v30
    v_mov_b32 v28, 0
    v_mul_f32 v14, v14, v30
    v_pk_add_f32 v[208:209], v[208:209], v[28:29] op_sel:[0,1] op_sel_hi:[1,1] neg_lo:[0,1] neg_hi:[0,1]
    v_pk_add_f32 v[210:211], v[210:211], v[28:29] op_sel:[0,1] op_sel_hi:[1,1] neg_lo:[0,1] neg_hi:[0,1]
    v_pk_add_f32 v[212:213], v[212:213], v[28:29] op_sel:[0,1] op_sel_hi:[1,1] neg_lo:[0,1] neg_hi:[0,1]
    v_pk_add_f32 v[214:215], v[214:215], v[28:29] op_sel:[0,1] op_sel_hi:[1,1] neg_lo:[0,1] neg_hi:[0,1]
    v_pk_add_f32 v[216:217], v[216:217], v[28:29] op_sel:[0,1] op_sel_hi:[1,1] neg_lo:[0,1] neg_hi:[0,1]
    v_pk_add_f32 v[218:219], v[218:219], v[28:29] op_sel:[0,1] op_sel_hi:[1,1] neg_lo:[0,1] neg_hi:[0,1]
    v_pk_add_f32 v[220:221], v[220:221], v[28:29] op_sel:[0,1] op_sel_hi:[1,1] neg_lo:[0,1] neg_hi:[0,1]
    v_pk_add_f32 v[222:223], v[222:223], v[28:29] op_sel:[0,1] op_sel_hi:[1,1] neg_lo:[0,1] neg_hi:[0,1]
    v_pk_add_f32 v[224:225], v[224:225], v[28:29] op_sel:[0,1] op_sel_hi:[1,1] neg_lo:[0,1] neg_hi:[0,1]
    v_pk_add_f32 v[226:227], v[226:227], v[28:29] op_sel:[0,1] op_sel_hi:[1,1] neg_lo:[0,1] neg_hi:[0,1]
    v_pk_add_f32 v[228:229], v[228:229], v[28:29] op_sel:[0,1] op_sel_hi:[1,1] neg_lo:[0,1] neg_hi:[0,1]
    v_pk_add_f32 v[230:231], v[230:231], v[28:29] op_sel:[0,1] op_sel_hi:[1,1] neg_lo:[0,1] neg_hi:[0,1]
    v_pk_add_f32 v[232:233], v[232:233], v[28:29] op_sel:[0,1] op_sel_hi:[1,1] neg_lo:[0,1] neg_hi:[0,1]
    v_pk_add_f32 v[234:235], v[234:235], v[28:29] op_sel:[0,1] op_sel_hi:[1,1] neg_lo:[0,1] neg_hi:[0,1]
    v_pk_add_f32 v[236:237], v[236:237], v[28:29] op_sel:[0,1] op_sel_hi:[1,1] neg_lo:[0,1] neg_hi:[0,1]
    v_pk_add_f32 v[238:239], v[238:239], v[28:29] op_sel:[0,1] op_sel_hi:[1,1] neg_lo:[0,1] neg_hi:[0,1]
    v_pk_add_f32 v[64:65], v[64:65], v[28:29] op_sel:[0,1] op_sel_hi:[1,1] neg_lo:[0,1] neg_hi:[0,1]
    v_pk_add_f32 v[66:67], v[66:67], v[28:29] op_sel:[0,1] op_sel_hi:[1,1] neg_lo:[0,1] neg_hi:[0,1]
    v_pk_add_f32 v[68:69], v[68:69], v[28:29] op_sel:[0,1] op_sel_hi:[1,1] neg_lo:[0,1] neg_hi:[0,1]
    v_pk_add_f32 v[70:71], v[70:71], v[28:29] op_sel:[0,1] op_sel_hi:[1,1] neg_lo:[0,1] neg_hi:[0,1]
    v_pk_add_f32 v[72:73], v[72:73], v[28:29] op_sel:[0,1] op_sel_hi:[1,1] neg_lo:[0,1] neg_hi:[0,1]
    v_pk_add_f32 v[74:75], v[74:75], v[28:29] op_sel:[0,1] op_sel_hi:[1,1] neg_lo:[0,1] neg_hi:[0,1]
    v_pk_add_f32 v[76:77], v[76:77], v[28:29] op_sel:[0,1] op_sel_hi:[1,1] neg_lo:[0,1] neg_hi:[0,1]
    v_pk_add_f32 v[78:79], v[78:79], v[28:29] op_sel:[0,1] op_sel_hi:[1,1] neg_lo:[0,1] neg_hi:[0,1]
    v_pk_mul_f32 v[112:113], v[112:113], v[30:31] op_sel:[0,0] op_sel_hi:[1,0]
    v_pk_mul_f32 v[114:115], v[114:115], v[30:31] op_sel:[0,0] op_sel_hi:[1,0]
    v_pk_mul_f32 v[116:117], v[116:117], v[30:31] op_sel:[0,0] op_sel_hi:[1,0]
    v_pk_mul_f32 v[118:119], v[118:119], v[30:31] op_sel:[0,0] op_sel_hi:[1,0]
    v_pk_mul_f32 v[120:121], v[120:121], v[30:31] op_sel:[0,0] op_sel_hi:[1,0]
    v_pk_mul_f32 v[122:123], v[122:123], v[30:31] op_sel:[0,0] op_sel_hi:[1,0]
    v_pk_mul_f32 v[124:125], v[124:125], v[30:31] op_sel:[0,0] op_sel_hi:[1,0]
    v_pk_mul_f32 v[126:127], v[126:127], v[30:31] op_sel:[0,0] op_sel_hi:[1,0]
    v_pk_mul_f32 v[128:129], v[128:129], v[30:31] op_sel:[0,0] op_sel_hi:[1,0]
    v_pk_mul_f32 v[130:131], v[130:131], v[30:31] op_sel:[0,0] op_sel_hi:[1,0]
    v_pk_mul_f32 v[132:133], v[132:133], v[30:31] op_sel:[0,0] op_sel_hi:[1,0]
    v_pk_mul_f32 v[134:135], v[134:135], v[30:31] op_sel:[0,0] op_sel_hi:[1,0]
    v_pk_mul_f32 v[136:137], v[136:137], v[30:31] op_sel:[0,0] op_sel_hi:[1,0]
    v_pk_mul_f32 v[138:139], v[138:139], v[30:31] op_sel:[0,0] op_sel_hi:[1,0]
    v_pk_mul_f32 v[140:141], v[140:141], v[30:31] op_sel:[0,0] op_sel_hi:[1,0]
    v_pk_mul_f32 v[142:143], v[142:143], v[30:31] op_sel:[0,0] op_sel_hi:[1,0]
    v_pk_mul_f32 v[144:145], v[144:145], v[30:31] op_sel:[0,0] op_sel_hi:[1,0]
    v_pk_mul_f32 v[146:147], v[146:147], v[30:31] op_sel:[0,0] op_sel_hi:[1,0]
    v_pk_mul_f32 v[148:149], v[148:149], v[30:31] op_sel:[0,0] op_sel_hi:[1,0]
    v_pk_mul_f32 v[150:151], v[150:151], v[30:31] op_sel:[0,0] op_sel_hi:[1,0]
    v_pk_mul_f32 v[152:153], v[152:153], v[30:31] op_sel:[0,0] op_sel_hi:[1,0]
    v_pk_mul_f32 v[154:155], v[154:155], v[30:31] op_sel:[0,0] op_sel_hi:[1,0]
    v_pk_mul_f32 v[156:157], v[156:157], v[30:31] op_sel:[0,0] op_sel_hi:[1,0]
    v_pk_mul_f32 v[158:159], v[158:159], v[30:31] op_sel:[0,0] op_sel_hi:[1,0]
    v_pk_mul_f32 v[160:161], v[160:161], v[30:31] op_sel:[0,0] op_sel_hi:[1,0]
    v_pk_mul_f32 v[162:163], v[162:163], v[30:31] op_sel:[0,0] op_sel_hi:[1,0]
    v_pk_mul_f32 v[164:165], v[164:165], v[30:31] op_sel:[0,0] op_sel_hi:[1,0]
    v_pk_mul_f32 v[166:167], v[166:167], v[30:31] op_sel:[0,0] op_sel_hi:[1,0]
    v_pk_mul_f32 v[168:169], v[168:169], v[30:31] op_sel:[0,0] op_sel_hi:[1,0]
    v_pk_mul_f32 v[170:171], v[170:171], v[30:31] op_sel:[0,0] op_sel_hi:[1,0]
    v_pk_mul_f32 v[172:173], v[172:173], v[30:31] op_sel:[0,0] op_sel_hi:[1,0]
    v_pk_mul_f32 v[174:175], v[174:175], v[30:31] op_sel:[0,0] op_sel_hi:[1,0]
    s_branch L_kva_ob7
L_kva_oa8:
    v_subrev_u32 v6, s29, v15
    v_mov_b32 v7, 0xff800000
    v_cmp_gt_i32 s[4:5], 0, v6
    v_cmp_gt_i32 s[6:7], 1, v6
    v_cmp_gt_i32 vcc, 2, v6
    v_cndmask_b32 v176, v176, v7, s[4:5]
    v_cmp_gt_i32 s[4:5], 3, v6
    v_cndmask_b32 v177, v177, v7, s[6:7]
    v_cmp_gt_i32 s[6:7], 8, v6
    v_cndmask_b32 v178, v178, v7, vcc
    v_cmp_gt_i32 vcc, 9, v6
    v_cndmask_b32 v179, v179, v7, s[4:5]
    v_cmp_gt_i32 s[4:5], 10, v6
    v_cndmask_b32 v180, v180, v7, s[6:7]
    v_cmp_gt_i32 s[6:7], 11, v6
    v_cndmask_b32 v181, v181, v7, vcc
    v_cmp_gt_i32 vcc, 16, v6
    v_cndmask_b32 v182, v182, v7, s[4:5]
    v_cmp_gt_i32 s[4:5], 17, v6
    v_cndmask_b32 v183, v183, v7, s[6:7]
    v_cmp_gt_i32 s[6:7], 18, v6
    v_cndmask_b32 v184, v184, v7, vcc
    v_cmp_gt_i32 vcc, 19, v6
    v_cndmask_b32 v185, v185, v7, s[4:5]
    v_cmp_gt_i32 s[4:5], 24, v6
    v_cndmask_b32 v186, v186, v7, s[6:7]
    v_cmp_gt_i32 s[6:7], 25, v6
    v_cndmask_b32 v187, v187, v7, vcc
    v_cmp_gt_i32 vcc, 26, v6
    v_cndmask_b32 v188, v188, v7, s[4:5]
    v_cmp_gt_i32 s[4:5], 27, v6
    v_cndmask_b32 v189, v189, v7, s[6:7]
    v_cmp_gt_i32 s[6:7], 32, v6
    v_cndmask_b32 v190, v190, v7, vcc
    v_cmp_gt_i32 vcc, 33, v6
    v_cndmask_b32 v191, v191, v7, s[4:5]
    v_cmp_gt_i32 s[4:5], 34, v6
    v_cndmask_b32 v192, v192, v7, s[6:7]
    v_cmp_gt_i32 s[6:7], 35, v6
    v_cndmask_b32 v193, v193, v7, vcc
    v_cmp_gt_i32 vcc, 40, v6
    v_cndmask_b32 v194, v194, v7, s[4:5]
    v_cmp_gt_i32 s[4:5], 41, v6
    v_cndmask_b32 v195, v195, v7, s[6:7]
    v_cmp_gt_i32 s[6:7], 42, v6
    v_cndmask_b32 v196, v196, v7, vcc
    v_cmp_gt_i32 vcc, 43, v6
    v_cndmask_b32 v197, v197, v7, s[4:5]
    v_cmp_gt_i32 s[4:5], 48, v6
    v_cndmask_b32 v198, v198, v7, s[6:7]
    v_cmp_gt_i32 s[6:7], 49, v6
    v_cndmask_b32 v199, v199, v7, vcc
    v_cmp_gt_i32 vcc, 50, v6
    v_cndmask_b32 v200, v200, v7, s[4:5]
    v_cmp_gt_i32 s[4:5], 51, v6
    v_cndmask_b32 v201, v201, v7, s[6:7]
    v_cmp_gt_i32 s[6:7], 56, v6
    v_cndmask_b32 v202, v202, v7, vcc
    v_cmp_gt_i32 vcc, 57, v6
    v_cndmask_b32 v203, v203, v7, s[4:5]
    v_cmp_gt_i32 s[4:5], 58, v6
    v_cndmask_b32 v204, v204, v7, s[6:7]
    v_cmp_gt_i32 s[6:7], 59, v6
    v_cndmask_b32 v205, v205, v7, vcc
    v_cndmask_b32 v206, v206, v7, s[4:5]
    v_cndmask_b32 v207, v207, v7, s[6:7]
    s_branch L_kva_ob8
L_kva_oa9:
    ds_read_b128 v[32:35], v252 offset:0
    ds_read_b128 v[36:39], v252 offset:1024
    ds_read_b128 v[40:43], v252 offset:2048
    ds_read_b128 v[44:47], v252 offset:3072
    ds_read_b128 v[48:51], v252 offset:4096
    ds_read_b128 v[52:55], v252 offset:5120
    ds_read_b128 v[56:59], v252 offset:6144
    ds_read_b128 v[60:63], v252 offset:7168
    s_branch L_kva_ob9
L_kva_oa11:
    s_cmp_gt_u32 s45, 7
    s_cbranch_scc1 L_kva_ev10_w
    s_cmp_lt_u32 s45, 4
    s_cbranch_scc1 L_kva_ev10_3
    s_waitcnt vmcnt(3) lgkmcnt(0)
    s_branch L_kva_ev10_e
L_kva_ev10_3:
    s_cmp_lt_u32 s45, 3
    s_cbranch_scc1 L_kva_ev10_2
    s_waitcnt vmcnt(4) lgkmcnt(0)
    s_branch L_kva_ev10_e
L_kva_ev10_2:
    s_cmp_lt_u32 s45, 2
    s_cbranch_scc1 L_kva_ev10_1
    s_waitcnt vmcnt(10) lgkmcnt(0)
    s_branch L_kva_ev10_e
L_kva_ev10_1:
    s_waitcnt vmcnt(8) lgkmcnt(0)
    s_branch L_kva_ev10_p
L_kva_ev10_w:
    s_waitcnt vmcnt(2) lgkmcnt(0)
    s_cmp_lt_u32 s45, 15
    s_cbranch_scc1 L_kva_ev10_p
    s_mov_b32 s24, s78
    s_add_u32 s78, s78, 4096
    s_cmp_eq_u32 s45, 16
    s_cselect_b32 s26, s79, s26
    s_branch L_kva_ev10_e
L_kva_ev10_p:
    s_cmp_eq_u32 s45, 11
    s_cbranch_scc1 L_kva_ev10_i
    s_mov_b32 s7, 0x40000
L_kva_ev10_a:
    v_cmp_gt_u32 vcc, v23, v21
    s_sub_u32 s7, s7, 1
    s_nop 2
    s_cbranch_vccz L_kva_ev10_e
    s_cmp_eq_u32 s7, 0
    s_cbranch_scc1 L_kva_ev10_e
    s_sleep 2
    buffer_load_dword v21, v22, s[56:59], 0 offen sc1
    s_waitcnt vmcnt(0)
    s_branch L_kva_ev10_a
L_kva_ev10_i:
    s_lshl_b32 s4, s20, 12
    s_add_u32 s4, s4, 0x10000
    v_lshlrev_b32 v22, 7, v0
    v_add_u32 v22, s4, v22
    v_mov_b32 v7, 0x7f000000
    v_cmp_gt_u32 vcc, 32, v0
    s_nop 1
    v_cndmask_b32 v22, v7, v22, vcc
    v_cndmask_b32 v23, 0, 5, vcc
    buffer_load_dword v21, v22, s[56:59], 0 offen sc1
L_kva_ev10_e:
    s_branch L_kva_ob11
L_kva_oa12:
    s_nop 7
    v_mov_b32 v30, v29
    s_nop 1
    v_permlane32_swap_b32 v29, v30
    s_nop 1
    v_max_f32 v29, v29, v30
    v_max_f32 v29, v29, v28
    v_min_f32 v30, s52, -v29
    v_exp_f32 v30, v30
    v_mov_b32 v28, 0
    v_mul_f32 v14, v14, v30
    v_pk_add_f32 v[176:177], v[176:177], v[28:29] op_sel:[0,1] op_sel_hi:[1,1] neg_lo:[0,1] neg_hi:[0,1]
    v_pk_add_f32 v[178:179], v[178:179], v[28:29] op_sel:[0,1] op_sel_hi:[1,1] neg_lo:[0,1] neg_hi:[0,1]
    v_pk_add_f32 v[180:181], v[180:181], v[28:29] op_sel:[0,1] op_sel_hi:[1,1] neg_lo:[0,1] neg_hi:[0,1]
    v_pk_add_f32 v[182:183], v[182:183], v[28:29] op_sel:[0,1] op_sel_hi:[1,1] neg_lo:[0,1] neg_hi:[0,1]
    v_pk_add_f32 v[184:185], v[184:185], v[28:29] op_sel:[0,1] op_sel_hi:[1,1] neg_lo:[0,1] neg_hi:[0,1]
    v_pk_add_f32 v[186:187], v[186:187], v[28:29] op_sel:[0,1] op_sel_hi:[1,1] neg_lo:[0,1] neg_hi:[0,1]
    v_pk_add_f32 v[188:189], v[188:189], v[28:29] op_sel:[0,1] op_sel_hi:[1,1] neg_lo:[0,1] neg_hi:[0,1]
    v_pk_add_f32 v[190:191], v[190:191], v[28:29] op_sel:[0,1] op_sel_hi:[1,1] neg_lo:[0,1] neg_hi:[0,1]
    v_pk_add_f32 v[192:193], v[192:193], v[28:29] op_sel:[0,1] op_sel_hi:[1,1] neg_lo:[0,1] neg_hi:[0,1]
    v_pk_add_f32 v[194:195], v[194:195], v[28:29] op_sel:[0,1] op_sel_hi:[1,1] neg_lo:[0,1] neg_hi:[0,1]
    v_pk_add_f32 v[196:197], v[196:197], v[28:29] op_sel:[0,1] op_sel_hi:[1,1] neg_lo:[0,1] neg_hi:[0,1]
    v_pk_add_f32 v[198:199], v[198:199], v[28:29] op_sel:[0,1] op_sel_hi:[1,1] neg_lo:[0,1] neg_hi:[0,1]
    v_pk_add_f32 v[200:201], v[200:201], v[28:29] op_sel:[0,1] op_sel_hi:[1,1] neg_lo:[0,1] neg_hi:[0,1]
    v_pk_add_f32 v[202:203], v[202:203], v[28:29] op_sel:[0,1] op_sel_hi:[1,1] neg_lo:[0,1] neg_hi:[0,1]
    v_pk_add_f32 v[204:205], v[204:205], v[28:29] op_sel:[0,1] op_sel_hi:[1,1] neg_lo:[0,1] neg_hi:[0,1]
    v_pk_add_f32 v[206:207], v[206:207], v[28:29] op_sel:[0,1] op_sel_hi:[1,1] neg_lo:[0,1] neg_hi:[0,1]
    v_pk_add_f32 v[64:65], v[64:65], v[28:29] op_sel:[0,1] op_sel_hi:[1,1] neg_lo:[0,1] neg_hi:[0,1]
    v_pk_add_f32 v[66:67], v[66:67], v[28:29] op_sel:[0,1] op_sel_hi:[1,1] neg_lo:[0,1] neg_hi:[0,1]
    v_pk_add_f32 v[68:69], v[68:69], v[28:29] op_sel:[0,1] op_sel_hi:[1,1] neg_lo:[0,1] neg_hi:[0,1]
    v_pk_add_f32 v[70:71], v[70:71], v[28:29] op_sel:[0,1] op_sel_hi:[1,1] neg_lo:[0,1] neg_hi:[0,1]
    v_pk_add_f32 v[72:73], v[72:73], v[28:29] op_sel:[0,1] op_sel_hi:[1,1] neg_lo:[0,1] neg_hi:[0,1]
    v_pk_add_f32 v[74:75], v[74:75], v[28:29] op_sel:[0,1] op_sel_hi:[1,1] neg_lo:[0,1] neg_hi:[0,1]
    v_pk_add_f32 v[76:77], v[76:77], v[28:29] op_sel:[0,1] op_sel_hi:[1,1] neg_lo:[0,1] neg_hi:[0,1]
    v_pk_add_f32 v[78:79], v[78:79], v[28:29] op_sel:[0,1] op_sel_hi:[1,1] neg_lo:[0,1] neg_hi:[0,1]
    v_pk_mul_f32 v[112:113], v[112:113], v[30:31] op_sel:[0,0] op_sel_hi:[1,0]
    v_pk_mul_f32 v[114:115], v[114:115], v[30:31] op_sel:[0,0] op_sel_hi:[1,0]
    v_pk_mul_f32 v[116:117], v[116:117], v[30:31] op_sel:[0,0] op_sel_hi:[1,0]
    v_pk_mul_f32 v[118:119], v[118:119], v[30:31] op_sel:[0,0] op_sel_hi:[1,0]
    v_pk_mul_f32 v[120:121], v[120:121], v[30:31] op_sel:[0,0] op_sel_hi:[1,0]
    v_pk_mul_f32 v[122:123], v[122:123], v[30:31] op_sel:[0,0] op_sel_hi:[1,0]
    v_pk_mul_f32 v[124:125], v[124:125], v[30:31] op_sel:[0,0] op_sel_hi:[1,0]
    v_pk_mul_f32 v[126:127], v[126:127], v[30:31] op_sel:[0,0] op_sel_hi:[1,0]
    v_pk_mul_f32 v[128:129], v[128:129], v[30:31] op_sel:[0,0] op_sel_hi:[1,0]
    v_pk_mul_f32 v[130:131], v[130:131], v[30:31] op_sel:[0,0] op_sel_hi:[1,0]
    v_pk_mul_f32 v[132:133], v[132:133], v[30:31] op_sel:[0,0] op_sel_hi:[1,0]
    v_pk_mul_f32 v[134:135], v[134:135], v[30:31] op_sel:[0,0] op_sel_hi:[1,0]
    v_pk_mul_f32 v[136:137], v[136:137], v[30:31] op_sel:[0,0] op_sel_hi:[1,0]
    v_pk_mul_f32 v[138:139], v[138:139], v[30:31] op_sel:[0,0] op_sel_hi:[1,0]
    v_pk_mul_f32 v[140:141], v[140:141], v[30:31] op_sel:[0,0] op_sel_hi:[1,0]
    v_pk_mul_f32 v[142:143], v[142:143], v[30:31] op_sel:[0,0] op_sel_hi:[1,0]
    v_pk_mul_f32 v[144:145], v[144:145], v[30:31] op_sel:[0,0] op_sel_hi:[1,0]
    v_pk_mul_f32 v[146:147], v[146:147], v[30:31] op_sel:[0,0] op_sel_hi:[1,0]
    v_pk_mul_f32 v[148:149], v[148:149], v[30:31] op_sel:[0,0] op_sel_hi:[1,0]
    v_pk_mul_f32 v[150:151], v[150:151], v[30:31] op_sel:[0,0] op_sel_hi:[1,0]
    v_pk_mul_f32 v[152:153], v[152:153], v[30:31] op_sel:[0,0] op_sel_hi:[1,0]
    v_pk_mul_f32 v[154:155], v[154:155], v[30:31] op_sel:[0,0] op_sel_hi:[1,0]
    v_pk_mul_f32 v[156:157], v[156:157], v[30:31] op_sel:[0,0] op_sel_hi:[1,0]
    v_pk_mul_f32 v[158:159], v[158:159], v[30:31] op_sel:[0,0] op_sel_hi:[1,0]
    v_pk_mul_f32 v[160:161], v[160:161], v[30:31] op_sel:[0,0] op_sel_hi:[1,0]
    v_pk_mul_f32 v[162:163], v[162:163], v[30:31] op_sel:[0,0] op_sel_hi:[1,0]
    v_pk_mul_f32 v[164:165], v[164:165], v[30:31] op_sel:[0,0] op_sel_hi:[1,0]
    v_pk_mul_f32 v[166:167], v[166:167], v[30:31] op_sel:[0,0] op_sel_hi:[1,0]
    v_pk_mul_f32 v[168:169], v[168:169], v[30:31] op_sel:[0,0] op_sel_hi:[1,0]
    v_pk_mul_f32 v[170:171], v[170:171], v[30:31] op_sel:[0,0] op_sel_hi:[1,0]
    v_pk_mul_f32 v[172:173], v[172:173], v[30:31] op_sel:[0,0] op_sel_hi:[1,0]
    v_pk_mul_f32 v[174:175], v[174:175], v[30:31] op_sel:[0,0] op_sel_hi:[1,0]
    s_branch L_kva_ob12
L_kva_oa13:
    v_subrev_u32 v6, s29, v15
    v_mov_b32 v7, 0xff800000
    v_cmp_gt_i32 s[4:5], 0, v6
    v_cmp_gt_i32 s[6:7], 1, v6
    v_cmp_gt_i32 vcc, 2, v6
    v_cndmask_b32 v208, v208, v7, s[4:5]
    v_cmp_gt_i32 s[4:5], 3, v6
    v_cndmask_b32 v209, v209, v7, s[6:7]
    v_cmp_gt_i32 s[6:7], 8, v6
    v_cndmask_b32 v210, v210, v7, vcc
    v_cmp_gt_i32 vcc, 9, v6
    v_cndmask_b32 v211, v211, v7, s[4:5]
    v_cmp_gt_i32 s[4:5], 10, v6
    v_cndmask_b32 v212, v212, v7, s[6:7]
    v_cmp_gt_i32 s[6:7], 11, v6
    v_cndmask_b32 v213, v213, v7, vcc
    v_cmp_gt_i32 vcc, 16, v6
    v_cndmask_b32 v214, v214, v7, s[4:5]
    v_cmp_gt_i32 s[4:5], 17, v6
    v_cndmask_b32 v215, v215, v7, s[6:7]
    v_cmp_gt_i32 s[6:7], 18, v6
    v_cndmask_b32 v216, v216, v7, vcc
    v_cmp_gt_i32 vcc, 19, v6
    v_cndmask_b32 v217, v217, v7, s[4:5]
    v_cmp_gt_i32 s[4:5], 24, v6
    v_cndmask_b32 v218, v218, v7, s[6:7]
    v_cmp_gt_i32 s[6:7], 25, v6
    v_cndmask_b32 v219, v219, v7, vcc
    v_cmp_gt_i32 vcc, 26, v6
    v_cndmask_b32 v220, v220, v7, s[4:5]
    v_cmp_gt_i32 s[4:5], 27, v6
    v_cndmask_b32 v221, v221, v7, s[6:7]
    v_cmp_gt_i32 s[6:7], 32, v6
    v_cndmask_b32 v222, v222, v7, vcc
    v_cmp_gt_i32 vcc, 33, v6
    v_cndmask_b32 v223, v223, v7, s[4:5]
    v_cmp_gt_i32 s[4:5], 34, v6
    v_cndmask_b32 v224, v224, v7, s[6:7]
    v_cmp_gt_i32 s[6:7], 35, v6
    v_cndmask_b32 v225, v225, v7, vcc
    v_cmp_gt_i32 vcc, 40, v6
    v_cndmask_b32 v226, v226, v7, s[4:5]
    v_cmp_gt_i32 s[4:5], 41, v6
    v_cndmask_b32 v227, v227, v7, s[6:7]
    v_cmp_gt_i32 s[6:7], 42, v6
    v_cndmask_b32 v228, v228, v7, vcc
    v_cmp_gt_i32 vcc, 43, v6
    v_cndmask_b32 v229, v229, v7, s[4:5]
    v_cmp_gt_i32 s[4:5], 48, v6
    v_cndmask_b32 v230, v230, v7, s[6:7]
    v_cmp_gt_i32 s[6:7], 49, v6
    v_cndmask_b32 v231, v231, v7, vcc
    v_cmp_gt_i32 vcc, 50, v6
    v_cndmask_b32 v232, v232, v7, s[4:5]
    v_cmp_gt_i32 s[4:5], 51, v6
    v_cndmask_b32 v233, v233, v7, s[6:7]
    v_cmp_gt_i32 s[6:7], 56, v6
    v_cndmask_b32 v234, v234, v7, vcc
    v_cmp_gt_i32 vcc, 57, v6
    v_cndmask_b32 v235, v235, v7, s[4:5]
    v_cmp_gt_i32 s[4:5], 58, v6
    v_cndmask_b32 v236, v236, v7, s[6:7]
    v_cmp_gt_i32 s[6:7], 59, v6
    v_cndmask_b32 v237, v237, v7, vcc
    v_cndmask_b32 v238, v238, v7, s[4:5]
    v_cndmask_b32 v239, v239, v7, s[6:7]
    s_branch L_kva_ob13
L_kva_oa15:
    s_cmp_gt_u32 s45, 7
    s_cbranch_scc1 L_kva_ev14_w
    s_cmp_lt_u32 s45, 4
    s_cbranch_scc1 L_kva_ev14_3
    s_waitcnt vmcnt(3) lgkmcnt(0)
    s_branch L_kva_ev14_e
L_kva_ev14_3:
    s_cmp_lt_u32 s45, 3
    s_cbranch_scc1 L_kva_ev14_2
    s_waitcnt vmcnt(4) lgkmcnt(0)
    s_branch L_kva_ev14_e
L_kva_ev14_2:
    s_cmp_lt_u32 s45, 2
    s_cbranch_scc1 L_kva_ev14_1
    s_waitcnt vmcnt(10) lgkmcnt(0)
    s_branch L_kva_ev14_e
L_kva_ev14_1:
    s_waitcnt vmcnt(8) lgkmcnt(0)
    s_branch L_kva_ev14_p
L_kva_ev14_w:
    s_waitcnt vmcnt(2) lgkmcnt(0)
    s_cmp_lt_u32 s45, 15
    s_cbranch_scc1 L_kva_ev14_p
    s_mov_b32 s24, s78
    s_add_u32 s78, s78, 4096
    s_cmp_eq_u32 s45, 16
    s_cselect_b32 s26, s79, s26
    s_branch L_kva_ev14_e
L_kva_ev14_p:
    s_cmp_eq_u32 s45, 11
    s_cbranch_scc1 L_kva_ev14_i
    s_mov_b32 s7, 0x40000
L_kva_ev14_a:
    v_cmp_gt_u32 vcc, v23, v21
    s_sub_u32 s7, s7, 1
    s_nop 2
    s_cbranch_vccz L_kva_ev14_e
    s_cmp_eq_u32 s7, 0
    s_cbranch_scc1 L_kva_ev14_e
    s_sleep 2
    buffer_load_dword v21, v22, s[56:59], 0 offen sc1
    s_waitcnt vmcnt(0)
    s_branch L_kva_ev14_a
L_kva_ev14_i:
    s_lshl_b32 s4, s20, 12
    s_add_u32 s4, s4, 0x10000
    v_lshlrev_b32 v22, 7, v0
    v_add_u32 v22, s4, v22
    v_mov_b32 v7, 0x7f000000
    v_cmp_gt_u32 vcc, 32, v0
    s_nop 1
    v_cndmask_b32 v22, v7, v22, vcc
    v_cndmask_b32 v23, 0, 5, vcc
    buffer_load_dword v21, v22, s[56:59], 0 offen sc1
L_kva_ev14_e:
    s_branch L_kva_ob15
L_kva_oa16:
    s_nop 7
    v_mov_b32 v30, v29
    s_nop 1
    v_permlane32_swap_b32 v29, v30
    s_nop 1
    v_max_f32 v29, v29, v30
    v_max_f32 v29, v29, v28
    v_min_f32 v30, s52, -v29
    v_exp_f32 v30, v30
    v_mov_b32 v28, 0
    v_mul_f32 v14, v14, v30
    v_pk_add_f32 v[208:209], v[208:209], v[28:29] op_sel:[0,1] op_sel_hi:[1,1] neg_lo:[0,1] neg_hi:[0,1]
    v_pk_add_f32 v[210:211], v[210:211], v[28:29] op_sel:[0,1] op_sel_hi:[1,1] neg_lo:[0,1] neg_hi:[0,1]
    v_pk_add_f32 v[212:213], v[212:213], v[28:29] op_sel:[0,1] op_sel_hi:[1,1] neg_lo:[0,1] neg_hi:[0,1]
    v_pk_add_f32 v[214:215], v[214:215], v[28:29] op_sel:[0,1] op_sel_hi:[1,1] neg_lo:[0,1] neg_hi:[0,1]
    v_pk_add_f32 v[216:217], v[216:217], v[28:29] op_sel:[0,1] op_sel_hi:[1,1] neg_lo:[0,1] neg_hi:[0,1]
    v_pk_add_f32 v[218:219], v[218:219], v[28:29] op_sel:[0,1] op_sel_hi:[1,1] neg_lo:[0,1] neg_hi:[0,1]
    v_pk_add_f32 v[220:221], v[220:221], v[28:29] op_sel:[0,1] op_sel_hi:[1,1] neg_lo:[0,1] neg_hi:[0,1]
    v_pk_add_f32 v[222:223], v[222:223], v[28:29] op_sel:[0,1] op_sel_hi:[1,1] neg_lo:[0,1] neg_hi:[0,1]
    v_pk_add_f32 v[224:225], v[224:225], v[28:29] op_sel:[0,1] op_sel_hi:[1,1] neg_lo:[0,1] neg_hi:[0,1]
    v_pk_add_f32 v[226:227], v[226:227], v[28:29] op_sel:[0,1] op_sel_hi:[1,1] neg_lo:[0,1] neg_hi:[0,1]
    v_pk_add_f32 v[228:229], v[228:229], v[28:29] op_sel:[0,1] op_sel_hi:[1,1] neg_lo:[0,1] neg_hi:[0,1]
    v_pk_add_f32 v[230:231], v[230:231], v[28:29] op_sel:[0,1] op_sel_hi:[1,1] neg_lo:[0,1] neg_hi:[0,1]
    v_pk_add_f32 v[232:233], v[232:233], v[28:29] op_sel:[0,1] op_sel_hi:[1,1] neg_lo:[0,1] neg_hi:[0,1]
    v_pk_add_f32 v[234:235], v[234:235], v[28:29] op_sel:[0,1] op_sel_hi:[1,1] neg_lo:[0,1] neg_hi:[0,1]
    v_pk_add_f32 v[236:237], v[236:237], v[28:29] op_sel:[0,1] op_sel_hi:[1,1] neg_lo:[0,1] neg_hi:[0,1]
    v_pk_add_f32 v[238:239], v[238:239], v[28:29] op_sel:[0,1] op_sel_hi:[1,1] neg_lo:[0,1] neg_hi:[0,1]
    v_pk_add_f32 v[64:65], v[64:65], v[28:29] op_sel:[0,1] op_sel_hi:[1,1] neg_lo:[0,1] neg_hi:[0,1]
    v_pk_add_f32 v[66:67], v[66:67], v[28:29] op_sel:[0,1] op_sel_hi:[1,1] neg_lo:[0,1] neg_hi:[0,1]
    v_pk_add_f32 v[68:69], v[68:69], v[28:29] op_sel:[0,1] op_sel_hi:[1,1] neg_lo:[0,1] neg_hi:[0,1]
    v_pk_add_f32 v[70:71], v[70:71], v[28:29] op_sel:[0,1] op_sel_hi:[1,1] neg_lo:[0,1] neg_hi:[0,1]
    v_pk_add_f32 v[72:73], v[72:73], v[28:29] op_sel:[0,1] op_sel_hi:[1,1] neg_lo:[0,1] neg_hi:[0,1]
    v_pk_add_f32 v[74:75], v[74:75], v[28:29] op_sel:[0,1] op_sel_hi:[1,1] neg_lo:[0,1] neg_hi:[0,1]
    v_pk_add_f32 v[76:77], v[76:77], v[28:29] op_sel:[0,1] op_sel_hi:[1,1] neg_lo:[0,1] neg_hi:[0,1]
    v_pk_add_f32 v[78:79], v[78:79], v[28:29] op_sel:[0,1] op_sel_hi:[1,1] neg_lo:[0,1] neg_hi:[0,1]
    v_pk_mul_f32 v[112:113], v[112:113], v[30:31] op_sel:[0,0] op_sel_hi:[1,0]
    v_pk_mul_f32 v[114:115], v[114:115], v[30:31] op_sel:[0,0] op_sel_hi:[1,0]
    v_pk_mul_f32 v[116:117], v[116:117], v[30:31] op_sel:[0,0] op_sel_hi:[1,0]
    v_pk_mul_f32 v[118:119], v[118:119], v[30:31] op_sel:[0,0] op_sel_hi:[1,0]
    v_pk_mul_f32 v[120:121], v[120:121], v[30:31] op_sel:[0,0] op_sel_hi:[1,0]
    v_pk_mul_f32 v[122:123], v[122:123], v[30:31] op_sel:[0,0] op_sel_hi:[1,0]
    v_pk_mul_f32 v[124:125], v[124:125], v[30:31] op_sel:[0,0] op_sel_hi:[1,0]
    v_pk_mul_f32 v[126:127], v[126:127], v[30:31] op_sel:[0,0] op_sel_hi:[1,0]
    v_pk_mul_f32 v[128:129], v[128:129], v[30:31] op_sel:[0,0] op_sel_hi:[1,0]
    v_pk_mul_f32 v[130:131], v[130:131], v[30:31] op_sel:[0,0] op_sel_hi:[1,0]
    v_pk_mul_f32 v[132:133], v[132:133], v[30:31] op_sel:[0,0] op_sel_hi:[1,0]
    v_pk_mul_f32 v[134:135], v[134:135], v[30:31] op_sel:[0,0] op_sel_hi:[1,0]
    v_pk_mul_f32 v[136:137], v[136:137], v[30:31] op_sel:[0,0] op_sel_hi:[1,0]
    v_pk_mul_f32 v[138:139], v[138:139], v[30:31] op_sel:[0,0] op_sel_hi:[1,0]
    v_pk_mul_f32 v[140:141], v[140:141], v[30:31] op_sel:[0,0] op_sel_hi:[1,0]
    v_pk_mul_f32 v[142:143], v[142:143], v[30:31] op_sel:[0,0] op_sel_hi:[1,0]
    v_pk_mul_f32 v[144:145], v[144:145], v[30:31] op_sel:[0,0] op_sel_hi:[1,0]
    v_pk_mul_f32 v[146:147], v[146:147], v[30:31] op_sel:[0,0] op_sel_hi:[1,0]
    v_pk_mul_f32 v[148:149], v[148:149], v[30:31] op_sel:[0,0] op_sel_hi:[1,0]
    v_pk_mul_f32 v[150:151], v[150:151], v[30:31] op_sel:[0,0] op_sel_hi:[1,0]
    v_pk_mul_f32 v[152:153], v[152:153], v[30:31] op_sel:[0,0] op_sel_hi:[1,0]
    v_pk_mul_f32 v[154:155], v[154:155], v[30:31] op_sel:[0,0] op_sel_hi:[1,0]
    v_pk_mul_f32 v[156:157], v[156:157], v[30:31] op_sel:[0,0] op_sel_hi:[1,0]
    v_pk_mul_f32 v[158:159], v[158:159], v[30:31] op_sel:[0,0] op_sel_hi:[1,0]
    v_pk_mul_f32 v[160:161], v[160:161], v[30:31] op_sel:[0,0] op_sel_hi:[1,0]
    v_pk_mul_f32 v[162:163], v[162:163], v[30:31] op_sel:[0,0] op_sel_hi:[1,0]
    v_pk_mul_f32 v[164:165], v[164:165], v[30:31] op_sel:[0,0] op_sel_hi:[1,0]
    v_pk_mul_f32 v[166:167], v[166:167], v[30:31] op_sel:[0,0] op_sel_hi:[1,0]
    v_pk_mul_f32 v[168:169], v[168:169], v[30:31] op_sel:[0,0] op_sel_hi:[1,0]
    v_pk_mul_f32 v[170:171], v[170:171], v[30:31] op_sel:[0,0] op_sel_hi:[1,0]
    v_pk_mul_f32 v[172:173], v[172:173], v[30:31] op_sel:[0,0] op_sel_hi:[1,0]
    v_pk_mul_f32 v[174:175], v[174:175], v[30:31] op_sel:[0,0] op_sel_hi:[1,0]
    s_branch L_kva_ob16
L_kva_oa17:
    v_subrev_u32 v6, s29, v15
    v_mov_b32 v7, 0xff800000
    v_cmp_gt_i32 s[4:5], 0, v6
    v_cmp_gt_i32 s[6:7], 1, v6
    v_cmp_gt_i32 vcc, 2, v6
    v_cndmask_b32 v176, v176, v7, s[4:5]
    v_cmp_gt_i32 s[4:5], 3, v6
    v_cndmask_b32 v177, v177, v7, s[6:7]
    v_cmp_gt_i32 s[6:7], 8, v6
    v_cndmask_b32 v178, v178, v7, vcc
    v_cmp_gt_i32 vcc, 9, v6
    v_cndmask_b32 v179, v179, v7, s[4:5]
    v_cmp_gt_i32 s[4:5], 10, v6
    v_cndmask_b32 v180, v180, v7, s[6:7]
    v_cmp_gt_i32 s[6:7], 11, v6
    v_cndmask_b32 v181, v181, v7, vcc
    v_cmp_gt_i32 vcc, 16, v6
    v_cndmask_b32 v182, v182, v7, s[4:5]
    v_cmp_gt_i32 s[4:5], 17, v6
    v_cndmask_b32 v183, v183, v7, s[6:7]
    v_cmp_gt_i32 s[6:7], 18, v6
    v_cndmask_b32 v184, v184, v7, vcc
    v_cmp_gt_i32 vcc, 19, v6
    v_cndmask_b32 v185, v185, v7, s[4:5]
    v_cmp_gt_i32 s[4:5], 24, v6
    v_cndmask_b32 v186, v186, v7, s[6:7]
    v_cmp_gt_i32 s[6:7], 25, v6
    v_cndmask_b32 v187, v187, v7, vcc
    v_cmp_gt_i32 vcc, 26, v6
    v_cndmask_b32 v188, v188, v7, s[4:5]
    v_cmp_gt_i32 s[4:5], 27, v6
    v_cndmask_b32 v189, v189, v7, s[6:7]
    v_cmp_gt_i32 s[6:7], 32, v6
    v_cndmask_b32 v190, v190, v7, vcc
    v_cmp_gt_i32 vcc, 33, v6
    v_cndmask_b32 v191, v191, v7, s[4:5]
    v_cmp_gt_i32 s[4:5], 34, v6
    v_cndmask_b32 v192, v192, v7, s[6:7]
    v_cmp_gt_i32 s[6:7], 35, v6
    v_cndmask_b32 v193, v193, v7, vcc
    v_cmp_gt_i32 vcc, 40, v6
    v_cndmask_b32 v194, v194, v7, s[4:5]
    v_cmp_gt_i32 s[4:5], 41, v6
    v_cndmask_b32 v195, v195, v7, s[6:7]
    v_cmp_gt_i32 s[6:7], 42, v6
    v_cndmask_b32 v196, v196, v7, vcc
    v_cmp_gt_i32 vcc, 43, v6
    v_cndmask_b32 v197, v197, v7, s[4:5]
    v_cmp_gt_i32 s[4:5], 48, v6
    v_cndmask_b32 v198, v198, v7, s[6:7]
    v_cmp_gt_i32 s[6:7], 49, v6
    v_cndmask_b32 v199, v199, v7, vcc
    v_cmp_gt_i32 vcc, 50, v6
    v_cndmask_b32 v200, v200, v7, s[4:5]
    v_cmp_gt_i32 s[4:5], 51, v6
    v_cndmask_b32 v201, v201, v7, s[6:7]
    v_cmp_gt_i32 s[6:7], 56, v6
    v_cndmask_b32 v202, v202, v7, vcc
    v_cmp_gt_i32 vcc, 57, v6
    v_cndmask_b32 v203, v203, v7, s[4:5]
    v_cmp_gt_i32 s[4:5], 58, v6
    v_cndmask_b32 v204, v204, v7, s[6:7]
    v_cmp_gt_i32 s[6:7], 59, v6
    v_cndmask_b32 v205, v205, v7, vcc
    v_cndmask_b32 v206, v206, v7, s[4:5]
    v_cndmask_b32 v207, v207, v7, s[6:7]
    s_branch L_kva_ob17
L_kva_oa19:
    s_cmp_gt_u32 s45, 7
    s_cbranch_scc1 L_kva_ev18_w
    s_cmp_lt_u32 s45, 4
    s_cbranch_scc1 L_kva_ev18_3
    s_waitcnt vmcnt(3) lgkmcnt(0)
    s_branch L_kva_ev18_e
L_kva_ev18_3:
    s_cmp_lt_u32 s45, 3
    s_cbranch_scc1 L_kva_ev18_2
    s_waitcnt vmcnt(4) lgkmcnt(0)
    s_branch L_kva_ev18_e
L_kva_ev18_2:
    s_cmp_lt_u32 s45, 2
    s_cbranch_scc1 L_kva_ev18_1
    s_waitcnt vmcnt(10) lgkmcnt(0)
    s_branch L_kva_ev18_e
L_kva_ev18_1:
    s_waitcnt vmcnt(8) lgkmcnt(0)
    s_branch L_kva_ev18_p
L_kva_ev18_w:
    s_waitcnt vmcnt(2) lgkmcnt(0)
    s_cmp_lt_u32 s45, 15
    s_cbranch_scc1 L_kva_ev18_p
    s_mov_b32 s24, s78
    s_add_u32 s78, s78, 4096
    s_cmp_eq_u32 s45, 16
    s_cselect_b32 s26, s79, s26
    s_branch L_kva_ev18_e
L_kva_ev18_p:
    s_cmp_eq_u32 s45, 11
    s_cbranch_scc1 L_kva_ev18_i
    s_mov_b32 s7, 0x40000
L_kva_ev18_a:
    v_cmp_gt_u32 vcc, v23, v21
    s_sub_u32 s7, s7, 1
    s_nop 2
    s_cbranch_vccz L_kva_ev18_e
    s_cmp_eq_u32 s7, 0
    s_cbranch_scc1 L_kva_ev18_e
    s_sleep 2
    buffer_load_dword v21, v22, s[56:59], 0 offen sc1
    s_waitcnt vmcnt(0)
    s_branch L_kva_ev18_a
L_kva_ev18_i:
    s_lshl_b32 s4, s20, 12
    s_add_u32 s4, s4, 0x10000
    v_lshlrev_b32 v22, 7, v0
    v_add_u32 v22, s4, v22
    v_mov_b32 v7, 0x7f000000
    v_cmp_gt_u32 vcc, 32, v0
    s_nop 1
    v_cndmask_b32 v22, v7, v22, vcc
    v_cndmask_b32 v23, 0, 5, vcc
    buffer_load_dword v21, v22, s[56:59], 0 offen sc1
L_kva_ev18_e:
    s_branch L_kva_ob19
L_kva_bg0:
    s_cmp_lg_u32 s45, 0
    s_cbranch_scc1 L_kva_bg0_2
    buffer_load_dword v21, v22, s[56:59], 0 offen sc1
    s_mov_b32 s36, s66
    s_mov_b32 s37, s67
    s_mov_b32 s38, 0x400000
    s_mov_b32 s5, 1024
    s_lshl_b32 s4, s16, 3
    s_add_u32 s4, s4, s20
    s_lshl_b32 s6, s4, 14
    s_lshl_b32 s7, s17, 7
    s_add_u32 s6, s6, s7
    s_lshl_b32 s7, s17, 8
    s_add_u32 s4, s4, s7
    s_lshl_b32 s88, s4, 11
    s_add_u32 s88, s88, 0x3000000
    s_mov_b32 s89, 64
    s_lshl_b32 s7, s5, 3
    v_mad_u32_u24 v26, v3, s7, v8
    s_lshl_b32 s7, s89, 1
    s_add_u32 s7, s7, 64
    v_mov_b32 v7, 0x7f000000
    v_cmp_gt_u32 vcc, s7, v8
    s_nop 1
    v_cndmask_b32 v26, v7, v26, vcc
    buffer_load_dword v244, v26, s[36:39], s6 offen
    s_add_u32 s6, s6, s5
    buffer_load_dword v248, v26, s[36:39], s6 offen
    s_add_u32 s6, s6, s5
    buffer_load_dword v245, v26, s[36:39], s6 offen
    s_add_u32 s6, s6, s5
    buffer_load_dword v249, v26, s[36:39], s6 offen
    s_add_u32 s6, s6, s5
    buffer_load_dword v246, v26, s[36:39], s6 offen
    s_add_u32 s6, s6, s5
    buffer_load_dword v250, v26, s[36:39], s6 offen
    s_add_u32 s6, s6, s5
    buffer_load_dword v247, v26, s[36:39], s6 offen
    s_add_u32 s6, s6, s5
    buffer_load_dword v251, v26, s[36:39], s6 offen
    s_add_u32 s45, s45, 1
    s_branch L_kva_bg0_e
L_kva_bg0_2:
    s_cmp_lg_u32 s45, 2
    s_cbranch_scc1 L_kva_bg0_4
    s_mov_b32 s4, 0x05040100
    s_mov_b32 s5, 0x07060302
    v_perm_b32 v242, v248, v244, s4
    v_perm_b32 v248, v248, v244, s5
    v_perm_b32 v243, v249, v245, s4
    v_perm_b32 v249, v249, v245, s5
    v_perm_b32 v244, v250, v246, s4
    v_perm_b32 v250, v250, v246, s5
    v_perm_b32 v245, v251, v247, s4
    v_perm_b32 v251, v251, v247, s5
    s_nop 1
    v_permlane16_swap_b32 v242, v248
    v_permlane16_swap_b32 v243, v249
    v_permlane16_swap_b32 v244, v250
    v_permlane16_swap_b32 v245, v251
    s_nop 1
    buffer_store_dwordx4 v[242:245], v9, s[8:11], s88 offen sc1
    buffer_store_dwordx4 v[248:251], v9, s[8:11], s88 offen offset:1024 sc1
    s_mov_b32 s36, s86
    s_mov_b32 s37, s87
    s_mov_b32 s38, 0x800000
    s_branch L_kva_bg0_i
L_kva_bg0_4:
    s_cmp_lg_u32 s45, 4
    s_cbranch_scc1 L_kva_bg0_6
    s_and_b32 s4, s2, 7
    s_lshl_b32 s4, s4, 5
    s_lshr_b32 s5, s2, 3
    s_add_u32 s4, s4, s5
    s_lshr_b32 s5, s4, 4
    s_bfe_u32 s6, s4, 0x10003
    s_lshl_b32 s6, s6, 4
    s_add_u32 s5, s5, s6
    s_and_b32 s4, s4, 7
    s_lshl_b32 s6, s5, 1
    s_add_u32 s6, s6, s46
    s_mul_i32 s6, s6, 48
    s_mul_i32 s7, s4, 6
    s_add_u32 s6, s6, s7
    s_add_u32 s6, s6, s50
    s_lshl_b32 s6, s6, 10
    s_add_u32 s6, s6, 0x5400000
    buffer_store_dwordx4 v[244:247], v12, s[8:11], s6 offen offset:0 sc1
    s_branch L_kva_bg0_i
L_kva_bg0_6:
    s_and_b32 s4, s2, 7
    s_lshl_b32 s4, s4, 5
    s_lshr_b32 s5, s2, 3
    s_add_u32 s4, s4, s5
    s_lshr_b32 s5, s4, 4
    s_bfe_u32 s6, s4, 0x10003
    s_lshl_b32 s6, s6, 4
    s_add_u32 s5, s5, s6
    s_and_b32 s4, s4, 7
    s_lshl_b32 s6, s4, 5
    s_add_u32 s6, s6, s5
    s_mul_i32 s6, s6, 12
    s_add_u32 s6, s6, s20
    s_lshl_b32 s6, s6, 10
    s_add_u32 s6, s6, 0x5000000
    buffer_store_dwordx4 v[244:247], v12, s[8:11], s6 offen offset:0 sc1
    s_branch L_kva_bg0_i
L_kva_bg1:
    s_cmp_lg_u32 s45, 1
    s_cbranch_scc1 L_kva_bg1_3
    s_mov_b32 s4, 0x05040100
    s_mov_b32 s5, 0x07060302
    v_perm_b32 v242, v248, v244, s4
    v_perm_b32 v248, v248, v244, s5
    v_perm_b32 v243, v249, v245, s4
    v_perm_b32 v249, v249, v245, s5
    v_perm_b32 v244, v250, v246, s4
    v_perm_b32 v250, v250, v246, s5
    v_perm_b32 v245, v251, v247, s4
    v_perm_b32 v251, v251, v247, s5
    s_nop 1
    v_permlane16_swap_b32 v242, v248
    v_permlane16_swap_b32 v243, v249
    v_permlane16_swap_b32 v244, v250
    v_permlane16_swap_b32 v245, v251
    s_nop 1
    buffer_store_dwordx4 v[242:245], v9, s[8:11], s88 offen sc1
    buffer_store_dwordx4 v[248:251], v9, s[8:11], s88 offen offset:1024 sc1
    s_lshl_b32 s4, s20, 8
    s_add_u32 s4, s4, s2
    s_lshr_b32 s5, s4, 5
    s_and_b32 s6, s4, 31
    s_mul_i32 s6, s6, 44032
    s_lshl_b32 s7, s5, 7
    s_add_u32 s6, s6, s7
    s_cmp_ge_u32 s5, 11
    s_cselect_b32 s7, 0xffffffe0, 0
    s_add_u32 s6, s6, s7
    s_cmp_eq_u32 s5, 21
    s_cselect_b32 s89, 16, 64
    s_lshl_b32 s88, s4, 11
    s_add_u32 s88, s88, 0x3400000
    s_mov_b32 s36, s68
    s_mov_b32 s37, s69
    s_mov_b32 s38, 0x158000
    s_mov_b32 s5, 2752
    s_cmp_lt_u32 s4, 704
    s_cbranch_scc1 L_kva_xf1
    s_sub_u32 s4, s4, 704
    s_mov_b32 s5, 0x5f417d1
    s_mul_hi_u32 s5, s4, s5
    s_mul_i32 s6, s5, 43
    s_sub_u32 s6, s4, s6
    s_lshl_b32 s6, s6, 14
    s_lshl_b32 s5, s5, 7
    s_add_u32 s6, s6, s5
    s_lshl_b32 s88, s4, 11
    s_add_u32 s88, s88, 0x3600000
    s_mov_b32 s89, 64
    s_cmp_lt_u32 s4, 344
    s_cselect_b32 s6, s6, 0x7f000000
    s_cselect_b32 s88, s88, 0x7f000000
    s_mov_b32 s36, s84
    s_mov_b32 s37, s85
    s_mov_b32 s38, 0xac000
    s_mov_b32 s5, 1024
L_kva_xf1:
    s_lshl_b32 s7, s5, 3
    v_mad_u32_u24 v26, v3, s7, v8
    s_lshl_b32 s7, s89, 1
    s_add_u32 s7, s7, 64
    v_mov_b32 v7, 0x7f000000
    v_cmp_gt_u32 vcc, s7, v8
    s_nop 1
    v_cndmask_b32 v26, v7, v26, vcc
    buffer_load_dword v244, v26, s[36:39], s6 offen
    s_add_u32 s6, s6, s5
    buffer_load_dword v248, v26, s[36:39], s6 offen
    s_add_u32 s6, s6, s5
    buffer_load_dword v245, v26, s[36:39], s6 offen
    s_add_u32 s6, s6, s5
    buffer_load_dword v249, v26, s[36:39], s6 offen
    s_add_u32 s6, s6, s5
    buffer_load_dword v246, v26, s[36:39], s6 offen
    s_add_u32 s6, s6, s5
    buffer_load_dword v250, v26, s[36:39], s6 offen
    s_add_u32 s6, s6, s5
    buffer_load_dword v247, v26, s[36:39], s6 offen
    s_add_u32 s6, s6, s5
    buffer_load_dword v251, v26, s[36:39], s6 offen
    s_add_u32 s45, s45, 1
    s_branch L_kva_bg1_e
L_kva_bg1_3:
    s_cmp_lg_u32 s45, 3
    s_cbranch_scc1 L_kva_bg1_5
    v_mov_b32 v244, -1
    v_mov_b32 v245, -1
    v_mov_b32 v246, -1
    v_mov_b32 v247, -1
    s_and_b32 s4, s2, 7
    s_lshl_b32 s4, s4, 5
    s_lshr_b32 s5, s2, 3
    s_add_u32 s4, s4, s5
    s_lshr_b32 s5, s4, 4
    s_bfe_u32 s6, s4, 0x10003
    s_lshl_b32 s6, s6, 4
    s_add_u32 s5, s5, s6
    s_and_b32 s4, s4, 7
    s_lshl_b32 s6, s5, 1
    s_add_u32 s6, s6, s46
    s_lshl_b32 s6, s6, 5
    s_lshl_b32 s7, s4, 2
    s_add_u32 s6, s6, s7
    s_add_u32 s6, s6, s50
    s_lshl_b32 s6, s6, 10
    s_add_u32 s6, s6, 0x4800000
    buffer_store_dwordx4 v[244:247], v12, s[8:11], s6 offen offset:0 sc1
    s_branch L_kva_bg1_i
L_kva_bg1_5:
    s_cmp_lg_u32 s45, 5
    s_cbranch_scc1 L_kva_bg1_7
    s_and_b32 s4, s2, 7
    s_lshl_b32 s4, s4, 5
    s_lshr_b32 s5, s2, 3
    s_add_u32 s4, s4, s5
    s_lshr_b32 s5, s4, 4
    s_bfe_u32 s6, s4, 0x10003
    s_lshl_b32 s6, s6, 4
    s_add_u32 s5, s5, s6
    s_and_b32 s4, s4, 7
    s_lshl_b32 s6, s5, 1
    s_add_u32 s6, s6, s46
    s_mul_i32 s6, s6, 48
    s_mul_i32 s7, s4, 6
    s_add_u32 s6, s6, s7
    s_add_u32 s6, s6, s50
    s_lshl_b32 s6, s6, 10
    s_add_u32 s6, s6, 0x5400000
    s_add_u32 s6, s6, 4096
    s_cmp_lt_u32 s50, 2
    s_cselect_b32 s6, s6, 0x7f000000
    buffer_store_dwordx4 v[244:247], v12, s[8:11], s6 offen offset:0 sc1
    s_branch L_kva_bg1_i
L_kva_bg1_7:
    s_and_b32 s4, s2, 7
    s_lshl_b32 s4, s4, 5
    s_lshr_b32 s5, s2, 3
    s_add_u32 s4, s4, s5
    s_lshr_b32 s5, s4, 4
    s_bfe_u32 s6, s4, 0x10003
    s_lshl_b32 s6, s6, 4
    s_add_u32 s5, s5, s6
    s_and_b32 s4, s4, 7
    s_lshl_b32 s6, s4, 5
    s_add_u32 s6, s6, s5
    s_mul_i32 s6, s6, 12
    s_add_u32 s6, s6, s20
    s_lshl_b32 s6, s6, 10
    s_add_u32 s6, s6, 0x5000000
    s_add_u32 s6, s6, 8192
    s_cmp_lt_u32 s20, 4
    s_cselect_b32 s6, s6, 0x7f000000
    buffer_store_dwordx4 v[244:247], v12, s[8:11], s6 offen offset:0 sc1
    s_mov_b32 s54, 5
    s_mov_b32 s25, s53
    s_branch L_kva_bg1_i
L_kva_fin:
    v_mov_b32 v240, v64
    s_cmp_eq_u64 s[40:41], 0
    s_cbranch_scc1 L_kva_fsp
    s_nop 7
    v_mov_b32 v30, v29
    s_nop 1
    v_permlane32_swap_b32 v29, v30
    s_nop 1
    v_max_f32 v29, v29, v30
    v_max_f32 v29, v29, v28
    v_min_f32 v30, s52, -v29
    v_exp_f32 v30, v30
    v_mov_b32 v28, 0
    v_mul_f32 v14, v14, v30
    v_pk_add_f32 v[176:177], v[176:177], v[28:29] op_sel:[0,1] op_sel_hi:[1,1] neg_lo:[0,1] neg_hi:[0,1]
    v_pk_add_f32 v[178:179], v[178:179], v[28:29] op_sel:[0,1] op_sel_hi:[1,1] neg_lo:[0,1] neg_hi:[0,1]
    v_pk_add_f32 v[180:181], v[180:181], v[28:29] op_sel:[0,1] op_sel_hi:[1,1] neg_lo:[0,1] neg_hi:[0,1]
    v_pk_add_f32 v[182:183], v[182:183], v[28:29] op_sel:[0,1] op_sel_hi:[1,1] neg_lo:[0,1] neg_hi:[0,1]
    v_pk_add_f32 v[184:185], v[184:185], v[28:29] op_sel:[0,1] op_sel_hi:[1,1] neg_lo:[0,1] neg_hi:[0,1]
    v_pk_add_f32 v[186:187], v[186:187], v[28:29] op_sel:[0,1] op_sel_hi:[1,1] neg_lo:[0,1] neg_hi:[0,1]
    v_pk_add_f32 v[188:189], v[188:189], v[28:29] op_sel:[0,1] op_sel_hi:[1,1] neg_lo:[0,1] neg_hi:[0,1]
    v_pk_add_f32 v[190:191], v[190:191], v[28:29] op_sel:[0,1] op_sel_hi:[1,1] neg_lo:[0,1] neg_hi:[0,1]
    v_pk_add_f32 v[192:193], v[192:193], v[28:29] op_sel:[0,1] op_sel_hi:[1,1] neg_lo:[0,1] neg_hi:[0,1]
    v_pk_add_f32 v[194:195], v[194:195], v[28:29] op_sel:[0,1] op_sel_hi:[1,1] neg_lo:[0,1] neg_hi:[0,1]
    v_pk_add_f32 v[196:197], v[196:197], v[28:29] op_sel:[0,1] op_sel_hi:[1,1] neg_lo:[0,1] neg_hi:[0,1]
    v_pk_add_f32 v[198:199], v[198:199], v[28:29] op_sel:[0,1] op_sel_hi:[1,1] neg_lo:[0,1] neg_hi:[0,1]
    v_pk_add_f32 v[200:201], v[200:201], v[28:29] op_sel:[0,1] op_sel_hi:[1,1] neg_lo:[0,1] neg_hi:[0,1]
    v_pk_add_f32 v[202:203], v[202:203], v[28:29] op_sel:[0,1] op_sel_hi:[1,1] neg_lo:[0,1] neg_hi:[0,1]
    v_pk_add_f32 v[204:205], v[204:205], v[28:29] op_sel:[0,1] op_sel_hi:[1,1] neg_lo:[0,1] neg_hi:[0,1]
    v_pk_add_f32 v[206:207], v[206:207], v[28:29] op_sel:[0,1] op_sel_hi:[1,1] neg_lo:[0,1] neg_hi:[0,1]
    v_sub_f32 v240, v240, v29
    v_pk_mul_f32 v[112:113], v[112:113], v[30:31] op_sel:[0,0] op_sel_hi:[1,0]
    v_pk_mul_f32 v[114:115], v[114:115], v[30:31] op_sel:[0,0] op_sel_hi:[1,0]
    v_pk_mul_f32 v[116:117], v[116:117], v[30:31] op_sel:[0,0] op_sel_hi:[1,0]
    v_pk_mul_f32 v[118:119], v[118:119], v[30:31] op_sel:[0,0] op_sel_hi:[1,0]
    v_pk_mul_f32 v[120:121], v[120:121], v[30:31] op_sel:[0,0] op_sel_hi:[1,0]
    v_pk_mul_f32 v[122:123], v[122:123], v[30:31] op_sel:[0,0] op_sel_hi:[1,0]
    v_pk_mul_f32 v[124:125], v[124:125], v[30:31] op_sel:[0,0] op_sel_hi:[1,0]
    v_pk_mul_f32 v[126:127], v[126:127], v[30:31] op_sel:[0,0] op_sel_hi:[1,0]
    v_pk_mul_f32 v[128:129], v[128:129], v[30:31] op_sel:[0,0] op_sel_hi:[1,0]
    v_pk_mul_f32 v[130:131], v[130:131], v[30:31] op_sel:[0,0] op_sel_hi:[1,0]
    v_pk_mul_f32 v[132:133], v[132:133], v[30:31] op_sel:[0,0] op_sel_hi:[1,0]
    v_pk_mul_f32 v[134:135], v[134:135], v[30:31] op_sel:[0,0] op_sel_hi:[1,0]
    v_pk_mul_f32 v[136:137], v[136:137], v[30:31] op_sel:[0,0] op_sel_hi:[1,0]
    v_pk_mul_f32 v[138:139], v[138:139], v[30:31] op_sel:[0,0] op_sel_hi:[1,0]
    v_pk_mul_f32 v[140:141], v[140:141], v[30:31] op_sel:[0,0] op_sel_hi:[1,0]
    v_pk_mul_f32 v[142:143], v[142:143], v[30:31] op_sel:[0,0] op_sel_hi:[1,0]
    v_pk_mul_f32 v[144:145], v[144:145], v[30:31] op_sel:[0,0] op_sel_hi:[1,0]
    v_pk_mul_f32 v[146:147], v[146:147], v[30:31] op_sel:[0,0] op_sel_hi:[1,0]
    v_pk_mul_f32 v[148:149], v[148:149], v[30:31] op_sel:[0,0] op_sel_hi:[1,0]
    v_pk_mul_f32 v[150:151], v[150:151], v[30:31] op_sel:[0,0] op_sel_hi:[1,0]
    v_pk_mul_f32 v[152:153], v[152:153], v[30:31] op_sel:[0,0] op_sel_hi:[1,0]
    v_pk_mul_f32 v[154:155], v[154:155], v[30:31] op_sel:[0,0] op_sel_hi:[1,0]
    v_pk_mul_f32 v[156:157], v[156:157], v[30:31] op_sel:[0,0] op_sel_hi:[1,0]
    v_pk_mul_f32 v[158:159], v[158:159], v[30:31] op_sel:[0,0] op_sel_hi:[1,0]
    v_pk_mul_f32 v[160:161], v[160:161], v[30:31] op_sel:[0,0] op_sel_hi:[1,0]
    v_pk_mul_f32 v[162:163], v[162:163], v[30:31] op_sel:[0,0] op_sel_hi:[1,0]
    v_pk_mul_f32 v[164:165], v[164:165], v[30:31] op_sel:[0,0] op_sel_hi:[1,0]
    v_pk_mul_f32 v[166:167], v[166:167], v[30:31] op_sel:[0,0] op_sel_hi:[1,0]
    v_pk_mul_f32 v[168:169], v[168:169], v[30:31] op_sel:[0,0] op_sel_hi:[1,0]
    v_pk_mul_f32 v[170:171], v[170:171], v[30:31] op_sel:[0,0] op_sel_hi:[1,0]
    v_pk_mul_f32 v[172:173], v[172:173], v[30:31] op_sel:[0,0] op_sel_hi:[1,0]
    v_pk_mul_f32 v[174:175], v[174:175], v[30:31] op_sel:[0,0] op_sel_hi:[1,0]
L_kva_fsp:
    ds_read_b128 v[80:83], v16 offset:32768
    ds_read_b128 v[84:87], v16 offset:33792
    ds_read_b128 v[88:91], v17 offset:34816
    ds_read_b128 v[92:95], v17 offset:35840
    ds_read_b128 v[96:99], v16 offset:36864
    ds_read_b128 v[100:103], v16 offset:37888
    ds_read_b128 v[104:107], v17 offset:38912
    ds_read_b128 v[108:111], v17 offset:39936
    s_and_b32 s4, s20, 1
    s_lshl_b32 s4, s4, 8
    v_xor_b32 v4, s4, v12
    s_bfe_u32 s4, s20, 0x10001
    s_lshl_b32 s4, s4, 10
    v_add_u32 v10, s4, v4
    s_xor_b32 s4, s4, 1024
    v_add_u32 v11, s4, v4
    s_lshl_b32 s4, s20, 9
    s_add_u32 s4, s4, 131072
    v_lshlrev_b32 v5, 3, v0
    v_add_u32 v5, s4, v5
    s_lshl_b32 s4, s50, 13
    s_add_u32 s5, s4, 131072
    s_add_u32 s4, s4, 32768
    s_cmp_eq_u32 s46, 0
    s_cselect_b32 s6, s4, s5
    s_cselect_b32 s81, s5, s4
    v_add_u32 v4, s6, v12
    v_add_u32 v6, s81, v12
    v_exp_f32 v176, v176
    v_exp_f32 v177, v177
    v_add_f32 v14, v14, v176
    v_exp_f32 v178, v178
    v_add_f32 v14, v14, v177
    v_cvt_pk_bf16_f32 v176, v176, v177
    buffer_load_dwordx4 v12, s[32:35], s24 offen offset:3072 sc1 lds
    s_mov_b32 s18, s24
    s_and_b32 s24, s92, 15
    s_lshr_b64 s[92:93], s[92:93], 4
    s_lshl_b32 s24, s24, 15
    s_add_u32 s24, s24, s21
    v_exp_f32 v179, v179
    v_add_f32 v14, v14, v178
    v_exp_f32 v180, v180
    v_add_f32 v14, v14, v179
    v_cvt_pk_bf16_f32 v177, v178, v179
    v_exp_f32 v181, v181
    s_add_u32 m0, s49, 0
    s_nop 0
    buffer_load_dwordx4 v12, s[60:63], s26 offen sc1 lds
    v_add_f32 v14, v14, v180
    v_exp_f32 v182, v182
    v_add_f32 v14, v14, v181
    v_cvt_pk_bf16_f32 v178, v180, v181
    v_exp_f32 v183, v183
    v_add_f32 v14, v14, v182
    buffer_load_dwordx4 v12, s[60:63], s26 offen offset:1024 sc1 lds
    v_exp_f32 v184, v184
    v_add_f32 v14, v14, v183
    v_cvt_pk_bf16_f32 v179, v182, v183
    s_nop 1
    s_waitcnt lgkmcnt(7)
    v_mfma_f32_32x32x16_bf16 v[112:127], v[80:83], v[176:179], v[112:127]
    ds_read_b128 v[80:83], v16 offset:40960
    v_exp_f32 v185, v185
    v_add_f32 v14, v14, v184
    v_exp_f32 v186, v186
    buffer_load_dwordx4 v12, s[60:63], s26 offen offset:2048 sc1 lds
    v_add_f32 v14, v14, v185
    v_cvt_pk_bf16_f32 v184, v184, v185
    s_waitcnt lgkmcnt(7)
    v_mfma_f32_32x32x16_bf16 v[128:143], v[84:87], v[176:179], v[128:143]
    ds_read_b128 v[84:87], v16 offset:41984
    v_exp_f32 v187, v187
    v_add_f32 v14, v14, v186
    v_exp_f32 v188, v188
    v_add_f32 v14, v14, v187
    buffer_load_dwordx4 v12, s[60:63], s26 offen offset:3072 sc1 lds
    s_mov_b32 s26, s18
    v_cvt_pk_bf16_f32 v185, v186, v187
    s_waitcnt lgkmcnt(7)
    v_mfma_f32_32x32x16_bf16 v[144:159], v[88:91], v[176:179], v[144:159]
    ds_read_b128 v[88:91], v17 offset:43008
    v_exp_f32 v189, v189
    v_add_f32 v14, v14, v188
    v_exp_f32 v190, v190
    v_add_f32 v14, v14, v189
    v_cvt_pk_bf16_f32 v186, v188, v189
    s_add_u32 s4, s74, 0
    buffer_load_dwordx4 v[32:35], v10, s[8:11], s4 offen offset:0 sc1
    buffer_load_dwordx4 v[36:39], v11, s[8:11], s4 offen offset:0 sc1
    s_waitcnt lgkmcnt(7)
    v_mfma_f32_32x32x16_bf16 v[160:175], v[92:95], v[176:179], v[160:175]
    ds_read_b128 v[92:95], v17 offset:44032
    v_exp_f32 v191, v191
    v_add_f32 v14, v14, v190
    v_exp_f32 v192, v192
    v_add_f32 v14, v14, v191
    v_cvt_pk_bf16_f32 v187, v190, v191
    s_nop 1
    s_waitcnt lgkmcnt(7)
    v_mfma_f32_32x32x16_bf16 v[112:127], v[96:99], v[184:187], v[112:127]
    ds_read_b128 v[96:99], v16 offset:45056
    v_exp_f32 v193, v193
    s_add_u32 s4, s74, 0
    buffer_load_dwordx4 v[40:43], v10, s[8:11], s4 offen offset:2048 sc1
    buffer_load_dwordx4 v[44:47], v11, s[8:11], s4 offen offset:2048 sc1
    v_add_f32 v14, v14, v192
    v_exp_f32 v194, v194
    v_add_f32 v14, v14, v193
    v_cvt_pk_bf16_f32 v192, v192, v193
    s_waitcnt lgkmcnt(7)
    v_mfma_f32_32x32x16_bf16 v[128:143], v[100:103], v[184:187], v[128:143]
    ds_read_b128 v[100:103], v16 offset:46080
    v_exp_f32 v195, v195
    v_add_f32 v14, v14, v194
    s_add_u32 s4, s74, 4096
    buffer_load_dwordx4 v[48:51], v10, s[8:11], s4 offen offset:0 sc1
    buffer_load_dwordx4 v[52:55], v11, s[8:11], s4 offen offset:0 sc1
    v_exp_f32 v196, v196
    v_add_f32 v14, v14, v195
    v_cvt_pk_bf16_f32 v193, v194, v195
    s_waitcnt lgkmcnt(7)
    v_mfma_f32_32x32x16_bf16 v[144:159], v[104:107], v[184:187], v[144:159]
    ds_read_b128 v[104:107], v17 offset:47104
    v_exp_f32 v197, v197
    v_add_f32 v14, v14, v196
    v_exp_f32 v198, v198
    s_add_u32 s4, s74, 4096
    buffer_load_dwordx4 v[56:59], v10, s[8:11], s4 offen offset:2048 sc1
    buffer_load_dwordx4 v[60:63], v11, s[8:11], s4 offen offset:2048 sc1
    v_add_f32 v14, v14, v197
    v_cvt_pk_bf16_f32 v194, v196, v197
    s_waitcnt lgkmcnt(7)
    v_mfma_f32_32x32x16_bf16 v[160:175], v[108:111], v[184:187], v[160:175]
    ds_read_b128 v[108:111], v17 offset:48128
    v_exp_f32 v199, v199
    v_add_f32 v14, v14, v198
    v_exp_f32 v200, v200
    v_add_f32 v14, v14, v199
    s_add_u32 s4, s74, 8192
    buffer_load_dwordx4 v[64:67], v10, s[8:11], s4 offen offset:0 sc1
    buffer_load_dwordx4 v[68:71], v11, s[8:11], s4 offen offset:0 sc1
    v_cvt_pk_bf16_f32 v195, v198, v199
    s_nop 1
    s_waitcnt lgkmcnt(7)
    v_mfma_f32_32x32x16_bf16 v[112:127], v[80:83], v[192:195], v[112:127]
    v_exp_f32 v201, v201
    v_add_f32 v14, v14, v200
    v_exp_f32 v202, v202
    v_add_f32 v14, v14, v201
    v_cvt_pk_bf16_f32 v200, v200, v201
    s_add_u32 s4, s74, 8192
    buffer_load_dwordx4 v[72:75], v10, s[8:11], s4 offen offset:2048 sc1
    buffer_load_dwordx4 v[76:79], v11, s[8:11], s4 offen offset:2048 sc1
    s_waitcnt lgkmcnt(6)
    v_mfma_f32_32x32x16_bf16 v[128:143], v[84:87], v[192:195], v[128:143]
    v_exp_f32 v203, v203
    v_add_f32 v14, v14, v202
    v_exp_f32 v204, v204
    v_add_f32 v14, v14, v203
    v_cvt_pk_bf16_f32 v201, v202, v203
    s_waitcnt lgkmcnt(5)
    v_mfma_f32_32x32x16_bf16 v[144:159], v[88:91], v[192:195], v[144:159]
    v_exp_f32 v205, v205
    s_add_u32 s4, s75, 12288
    buffer_load_dwordx4 v[208:211], v10, s[8:11], s4 offen offset:0 sc1
    buffer_load_dwordx4 v[212:215], v11, s[8:11], s4 offen offset:0 sc1
    v_add_f32 v14, v14, v204
    v_exp_f32 v206, v206
    v_add_f32 v14, v14, v205
    v_cvt_pk_bf16_f32 v202, v204, v205
    s_waitcnt lgkmcnt(4)
    v_mfma_f32_32x32x16_bf16 v[160:175], v[92:95], v[192:195], v[160:175]
    v_exp_f32 v207, v207
    v_add_f32 v14, v14, v206
    s_add_u32 s4, s75, 12288
    buffer_load_dwordx4 v[216:219], v10, s[8:11], s4 offen offset:2048 sc1
    buffer_load_dwordx4 v[220:223], v11, s[8:11], s4 offen offset:2048 sc1
    s_nop 0
    v_add_f32 v14, v14, v207
    v_cvt_pk_bf16_f32 v203, v206, v207
    s_nop 1
    v_mov_b32 v241, v14
    ds_write_b64 v5, v[240:241]
    v_xor_b32 v5, 0x800, v5
    s_waitcnt lgkmcnt(0)
    v_mfma_f32_32x32x16_bf16 v[144:159], v[104:107], v[200:203], v[144:159]
    s_waitcnt vmcnt(21)
    s_barrier
    ds_read_b64 v[242:243], v5
    v_mov_b32 v24, s54
    buffer_store_dword v24, v25, s[56:59], s25 offen sc1
    v_mfma_f32_32x32x16_bf16 v[160:175], v[108:111], v[200:203], v[160:175]
    s_waitcnt lgkmcnt(0)
    s_barrier
    v_min_f32 v246, v240, v242
    v_sub_f32 v244, v246, v240
    v_sub_f32 v245, v246, v242
    v_exp_f32 v244, v244
    v_exp_f32 v245, v245
    v_mfma_f32_32x32x16_bf16 v[112:127], v[96:99], v[200:203], v[112:127]
    v_mul_f32 v246, v14, v244
    v_fmac_f32 v246, v243, v245
    v_mov_b32 v247, v246
    s_nop 1
    v_permlane32_swap_b32 v246, v247
    v_mfma_f32_32x32x16_bf16 v[128:143], v[100:103], v[200:203], v[128:143]
    s_add_u32 s4, s76, 0
    buffer_load_dwordx4 v[224:227], v10, s[8:11], s4 offen offset:0 sc1
    buffer_load_dwordx4 v[228:231], v11, s[8:11], s4 offen offset:0 sc1
    s_add_u32 s4, s76, 0
    buffer_load_dwordx4 v[232:235], v10, s[8:11], s4 offen offset:2048 sc1
    buffer_load_dwordx4 v[236:239], v11, s[8:11], s4 offen offset:2048 sc1
    v_add_f32 v246, v246, v247
    v_rcp_f32 v246, v246
    s_nop 7
    ds_write_b128 v4, v[144:147] offset:0
    ds_write_b128 v4, v[148:151] offset:1024
    ds_write_b128 v4, v[152:155] offset:2048
    ds_write_b128 v4, v[156:159] offset:3072
    ds_write_b128 v4, v[160:163] offset:4096
    ds_write_b128 v4, v[164:167] offset:5120
    ds_write_b128 v4, v[168:171] offset:6144
    ds_write_b128 v4, v[172:175] offset:7168
    v_mul_f32 v244, v244, v246
    v_mul_f32 v245, v245, v246
    s_add_u32 s4, s74, 12288
    buffer_load_dwordx4 v[80:83], v10, s[8:11], s4 offen offset:0 sc1
    buffer_load_dwordx4 v[84:87], v11, s[8:11], s4 offen offset:0 sc1
    s_add_u32 s4, s74, 12288
    buffer_load_dwordx4 v[88:91], v10, s[8:11], s4 offen offset:2048 sc1
    buffer_load_dwordx4 v[92:95], v11, s[8:11], s4 offen offset:2048 sc1
    v_pk_mul_f32 v[112:113], v[112:113], v[244:245] op_sel:[0,0] op_sel_hi:[1,0]
    v_pk_mul_f32 v[114:115], v[114:115], v[244:245] op_sel:[0,0] op_sel_hi:[1,0]
    v_pk_mul_f32 v[116:117], v[116:117], v[244:245] op_sel:[0,0] op_sel_hi:[1,0]
    v_pk_mul_f32 v[118:119], v[118:119], v[244:245] op_sel:[0,0] op_sel_hi:[1,0]
    v_pk_mul_f32 v[120:121], v[120:121], v[244:245] op_sel:[0,0] op_sel_hi:[1,0]
    v_pk_mul_f32 v[122:123], v[122:123], v[244:245] op_sel:[0,0] op_sel_hi:[1,0]
    v_pk_mul_f32 v[124:125], v[124:125], v[244:245] op_sel:[0,0] op_sel_hi:[1,0]
    v_pk_mul_f32 v[126:127], v[126:127], v[244:245] op_sel:[0,0] op_sel_hi:[1,0]
    v_pk_mul_f32 v[128:129], v[128:129], v[244:245] op_sel:[0,0] op_sel_hi:[1,0]
    v_pk_mul_f32 v[130:131], v[130:131], v[244:245] op_sel:[0,0] op_sel_hi:[1,0]
    v_pk_mul_f32 v[132:133], v[132:133], v[244:245] op_sel:[0,0] op_sel_hi:[1,0]
    v_pk_mul_f32 v[134:135], v[134:135], v[244:245] op_sel:[0,0] op_sel_hi:[1,0]
    v_pk_mul_f32 v[136:137], v[136:137], v[244:245] op_sel:[0,0] op_sel_hi:[1,0]
    v_pk_mul_f32 v[138:139], v[138:139], v[244:245] op_sel:[0,0] op_sel_hi:[1,0]
    v_pk_mul_f32 v[140:141], v[140:141], v[244:245] op_sel:[0,0] op_sel_hi:[1,0]
    v_pk_mul_f32 v[142:143], v[142:143], v[244:245] op_sel:[0,0] op_sel_hi:[1,0]
    s_waitcnt lgkmcnt(0)
    s_barrier
    ds_read_b128 v[176:179], v6 offset:0
    ds_read_b128 v[180:183], v6 offset:1024
    ds_read_b128 v[184:187], v6 offset:2048
    ds_read_b128 v[188:191], v6 offset:3072
    ds_read_b128 v[192:195], v6 offset:4096
    ds_read_b128 v[196:199], v6 offset:5120
    ds_read_b128 v[200:203], v6 offset:6144
    ds_read_b128 v[204:207], v6 offset:7168
    s_waitcnt lgkmcnt(6)
    v_pk_fma_f32 v[112:113], v[176:177], v[244:245], v[112:113] op_sel:[0,1,0] op_sel_hi:[1,1,1]
    v_pk_fma_f32 v[114:115], v[178:179], v[244:245], v[114:115] op_sel:[0,1,0] op_sel_hi:[1,1,1]
    v_pk_fma_f32 v[116:117], v[180:181], v[244:245], v[116:117] op_sel:[0,1,0] op_sel_hi:[1,1,1]
    v_pk_fma_f32 v[118:119], v[182:183], v[244:245], v[118:119] op_sel:[0,1,0] op_sel_hi:[1,1,1]
    v_cvt_pk_bf16_f32 v176, v112, v113
    v_cvt_pk_bf16_f32 v177, v114, v115
    v_cvt_pk_bf16_f32 v178, v116, v117
    v_cvt_pk_bf16_f32 v179, v118, v119
    buffer_store_dwordx4 v[176:179], v12, s[12:15], s22 offen offset:0 sc1
    s_waitcnt lgkmcnt(4)
    v_pk_fma_f32 v[120:121], v[184:185], v[244:245], v[120:121] op_sel:[0,1,0] op_sel_hi:[1,1,1]
    v_pk_fma_f32 v[122:123], v[186:187], v[244:245], v[122:123] op_sel:[0,1,0] op_sel_hi:[1,1,1]
    v_pk_fma_f32 v[124:125], v[188:189], v[244:245], v[124:125] op_sel:[0,1,0] op_sel_hi:[1,1,1]
    v_pk_fma_f32 v[126:127], v[190:191], v[244:245], v[126:127] op_sel:[0,1,0] op_sel_hi:[1,1,1]
    v_cvt_pk_bf16_f32 v184, v120, v121
    v_cvt_pk_bf16_f32 v185, v122, v123
    v_cvt_pk_bf16_f32 v186, v124, v125
    v_cvt_pk_bf16_f32 v187, v126, v127
    buffer_store_dwordx4 v[184:187], v12, s[12:15], s22 offen offset:1024 sc1
    s_waitcnt lgkmcnt(2)
    v_pk_fma_f32 v[128:129], v[192:193], v[244:245], v[128:129] op_sel:[0,1,0] op_sel_hi:[1,1,1]
    v_pk_fma_f32 v[130:131], v[194:195], v[244:245], v[130:131] op_sel:[0,1,0] op_sel_hi:[1,1,1]
    v_pk_fma_f32 v[132:133], v[196:197], v[244:245], v[132:133] op_sel:[0,1,0] op_sel_hi:[1,1,1]
    v_pk_fma_f32 v[134:135], v[198:199], v[244:245], v[134:135] op_sel:[0,1,0] op_sel_hi:[1,1,1]
    v_cvt_pk_bf16_f32 v192, v128, v129
    v_cvt_pk_bf16_f32 v193, v130, v131
    v_cvt_pk_bf16_f32 v194, v132, v133
    v_cvt_pk_bf16_f32 v195, v134, v135
    buffer_store_dwordx4 v[192:195], v12, s[12:15], s22 offen offset:2048 sc1
    s_waitcnt lgkmcnt(0)
    v_pk_fma_f32 v[136:137], v[200:201], v[244:245], v[136:137] op_sel:[0,1,0] op_sel_hi:[1,1,1]
    v_pk_fma_f32 v[138:139], v[202:203], v[244:245], v[138:139] op_sel:[0,1,0] op_sel_hi:[1,1,1]
    v_pk_fma_f32 v[140:141], v[204:205], v[244:245], v[140:141] op_sel:[0,1,0] op_sel_hi:[1,1,1]
    v_pk_fma_f32 v[142:143], v[206:207], v[244:245], v[142:143] op_sel:[0,1,0] op_sel_hi:[1,1,1]
    v_cvt_pk_bf16_f32 v200, v136, v137
    v_cvt_pk_bf16_f32 v201, v138, v139
    v_cvt_pk_bf16_f32 v202, v140, v141
    v_cvt_pk_bf16_f32 v203, v142, v143
    buffer_store_dwordx4 v[200:203], v12, s[12:15], s22 offen offset:3072 sc1
    s_add_u32 m0, s81, 0
    s_add_u32 s4, s76, 4096
    buffer_load_dwordx4 v12, s[8:11], s4 offen offset:0 sc1 lds
    buffer_load_dwordx4 v12, s[8:11], s4 offen offset:1024 sc1 lds
    buffer_load_dwordx4 v12, s[8:11], s4 offen offset:2048 sc1 lds
    buffer_load_dwordx4 v12, s[8:11], s4 offen offset:3072 sc1 lds
    s_add_u32 m0, s81, 4096
    s_add_u32 s4, s76, 8192
    buffer_load_dwordx4 v12, s[8:11], s4 offen offset:0 sc1 lds
    buffer_load_dwordx4 v12, s[8:11], s4 offen offset:1024 sc1 lds
    buffer_load_dwordx4 v12, s[8:11], s4 offen offset:2048 sc1 lds
    buffer_load_dwordx4 v12, s[8:11], s4 offen offset:3072 sc1 lds
    s_setprio 0
    s_and_b32 s4, s2, 7
    s_lshl_b32 s18, s4, 5
    s_lshr_b32 s5, s2, 3
    s_add_u32 s18, s18, s5
    s_lshr_b32 s5, s18, 4
    s_bfe_u32 s4, s18, 0x10003
    s_lshl_b32 s4, s4, 4
    s_add_u32 s16, s5, s4
    s_and_b32 s17, s18, 7
    s_lshr_b32 s4, s16, 1
    s_sub_u32 s5, 15, s4
    s_cmp_lt_u32 s4, 8
    s_cselect_b32 s4, s4, s5
    s_cselect_b32 s5, 7, 6
    s_lshl_b32 s6, s20, 3
    s_add_u32 s4, s4, s6
    s_lshl_b32 s4, s4, 7
    s_add_u32 s41, s4, 0x10000
    v_lshlrev_b32 v4, 13, v0
    v_mov_b32 v6, 0x7f000000
    v_mov_b32 v5, s5
    v_cmp_gt_u32 vcc, 4, v0
    s_nop 1
    v_cndmask_b32 v4, v6, v4, vcc
    v_cndmask_b32 v5, 0, v5, vcc
    v_cmp_eq_u32 vcc, 0, v0
    s_nop 1
    v_cndmask_b32 v7, v6, 0, vcc
    buffer_load_dword v6, v4, s[56:59], s41 offen sc1
    s_lshl_b32 s19, s18, 11
    s_add_u32 s19, s19, 0x20000
    s_lshr_b32 s21, s18, 3
    s_lshl_b32 s21, s21, 14
    s_add_u32 s21, s21, 0x20000
    v_lshlrev_b32 v13, 11, v0
    v_mov_b32 v14, 0x7f000000
    v_cmp_gt_u32 vcc, 8, v0
    s_getreg_b32 s43, hwreg(HW_REG_XCC_ID, 0, 4)
    v_mov_b32 v16, s43
    v_cndmask_b32 v13, v14, v13, vcc
    v_cndmask_b32 v16, 0, v16, vcc
    buffer_load_dword v17, v13, s[56:59], s21 offen offset:384 sc1
    s_lshr_b32 s22, s20, 2
    s_bfe_u32 s23, s20, 0x10001
    s_and_b32 s24, s20, 1
    s_and_b32 s42, s20, 3
    s_lshl_b32 s4, s22, 18
    v_add_u32 v8, s4, v12
    s_xor_b32 s4, s4, 0x40000
    v_add_u32 v9, s4, v12
    s_lshl_b32 s5, s16, 19
    s_lshl_b32 s4, s70, 13
    s_add_u32 s66, s4, s5
    s_lshl_b32 s4, s71, 13
    s_add_u32 s67, s4, s5
    s_lshl_b32 s4, s72, 13
    s_add_u32 s68, s4, s5
    s_lshl_b32 s4, s73, 13
    s_add_u32 s69, s4, s5
    v_mov_b32 v1, 7
    s_waitcnt vmcnt(10)
    s_barrier
    buffer_store_dword v1, v25, s[56:59], s53 offen sc1
    s_mov_b32 s36, s64
    s_mov_b32 s37, s65
    s_mov_b32 s38, 0x200000
    s_mov_b32 s39, 0x00020000
    s_lshl_b32 s4, s16, 6
    s_lshl_b32 s5, s22, 5
    s_add_u32 s4, s4, s5
    s_lshl_b32 s27, s4, 10
    s_lshl_b32 s4, s17, 6
    s_lshl_b32 s5, s42, 4
    s_add_u32 s4, s4, s5
    s_lshl_b32 s5, s4, 1
    s_add_u32 s27, s27, s5
    s_lshl_b32 s40, s4, 2
    v_lshlrev_b32 v13, 10, v2
    v_lshl_add_u32 v13, v3, 4, v13
    v_lshlrev_b32 v14, 5, v3
    s_add_u32 s48, s94, 0x4800000
    s_addc_u32 s49, s95, 0
    s_mov_b32 s50, 0x160000
    s_mov_b32 s51, 0x00020000
    s_mul_i32 s4, s17, 3
    s_cmp_eq_u32 s22, 0
    s_cselect_b32 s5, 22, 0
    s_add_u32 s4, s4, s5
    s_lshl_b32 s6, s42, 14
    s_add_u32 s5, s4, 0
    s_lshr_b32 s7, s5, 1
    s_lshl_b32 s7, s7, 16
    s_and_b32 s5, s5, 1
    s_lshl_b32 s5, s5, 10
    s_add_u32 s7, s7, s5
    s_add_u32 s44, s7, s6
    s_add_u32 s5, s4, 1
    s_lshr_b32 s7, s5, 1
    s_lshl_b32 s7, s7, 16
    s_and_b32 s5, s5, 1
    s_lshl_b32 s5, s5, 10
    s_add_u32 s7, s7, s5
    s_add_u32 s45, s7, s6
    s_add_u32 s5, s4, 2
    s_lshr_b32 s7, s5, 1
    s_lshl_b32 s7, s7, 16
    s_and_b32 s5, s5, 1
    s_lshl_b32 s5, s5, 10
    s_add_u32 s7, s7, s5
    s_add_u32 s46, s7, s6
    s_mov_b32 s7, 0x40000
L_kva_ta1:
    s_waitcnt vmcnt(0)
    v_cmp_gt_u32 vcc, v5, v6
    s_sub_u32 s7, s7, 1
    s_nop 2
    s_cbranch_vccz L_kva_tb2
    s_cmp_eq_u32 s7, 0
    s_cbranch_scc1 L_kva_tb2
    s_sleep 1
    buffer_load_dword v6, v4, s[56:59], s41 offen sc1
    s_branch L_kva_ta1
L_kva_tb2:
    buffer_load_dwordx4 v[96:99], v8, s[12:15], s66 offen offset:0 sc1
    buffer_load_dwordx4 v[100:103], v9, s[12:15], s66 offen offset:0 sc1
    buffer_load_dwordx4 v[104:107], v8, s[12:15], s66 offen offset:1024 sc1
    buffer_load_dwordx4 v[108:111], v9, s[12:15], s66 offen offset:1024 sc1
    buffer_load_dwordx4 v[176:179], v8, s[12:15], s66 offen offset:2048 sc1
    buffer_load_dwordx4 v[180:183], v9, s[12:15], s66 offen offset:2048 sc1
    buffer_load_dwordx4 v[184:187], v8, s[12:15], s66 offen offset:3072 sc1
    buffer_load_dwordx4 v[188:191], v9, s[12:15], s66 offen offset:3072 sc1
    s_add_u32 s66, s66, 4096
    buffer_load_dwordx4 v[192:195], v8, s[12:15], s66 offen offset:0 sc1
    buffer_load_dwordx4 v[196:199], v9, s[12:15], s66 offen offset:0 sc1
    buffer_load_dwordx4 v[200:203], v8, s[12:15], s66 offen offset:1024 sc1
    buffer_load_dwordx4 v[204:207], v9, s[12:15], s66 offen offset:1024 sc1
    buffer_load_dwordx4 v[240:243], v8, s[12:15], s66 offen offset:2048 sc1
    buffer_load_dwordx4 v[244:247], v9, s[12:15], s66 offen offset:2048 sc1
    buffer_load_dwordx4 v[248:251], v8, s[12:15], s66 offen offset:3072 sc1
    buffer_load_dwordx4 v[252:255], v9, s[12:15], s66 offen offset:3072 sc1
    v_cmp_ne_u32 vcc, v16, v17
    s_nop 3
    s_cmp_eq_u64 vcc, 0
    s_cselect_b32 s43, 1, 0
    s_and_b32 s4, s22, s24
    s_lshl_b32 s4, s4, 8
    v_xor_b32 v1, s4, v12
    s_waitcnt vmcnt(14)
    v_mfma_f32_32x32x16_bf16 v[112:127], v[32:35], v[96:99], 0
    v_mfma_f32_32x32x16_bf16 v[128:143], v[36:39], v[96:99], 0
    v_mfma_f32_32x32x16_bf16 v[144:159], v[32:35], v[100:103], 0
    v_mfma_f32_32x32x16_bf16 v[160:175], v[36:39], v[100:103], 0
    buffer_load_dwordx4 v[96:99], v8, s[12:15], s67 offen offset:0 sc1
    buffer_load_dwordx4 v[100:103], v9, s[12:15], s67 offen offset:0 sc1
    s_waitcnt vmcnt(14)
    v_mfma_f32_32x32x16_bf16 v[112:127], v[40:43], v[104:107], v[112:127]
    v_mfma_f32_32x32x16_bf16 v[128:143], v[44:47], v[104:107], v[128:143]
    v_mfma_f32_32x32x16_bf16 v[144:159], v[40:43], v[108:111], v[144:159]
    v_mfma_f32_32x32x16_bf16 v[160:175], v[44:47], v[108:111], v[160:175]
    buffer_load_dwordx4 v[104:107], v8, s[12:15], s67 offen offset:1024 sc1
    buffer_load_dwordx4 v[108:111], v9, s[12:15], s67 offen offset:1024 sc1
    s_add_u32 s4, s76, 12288
    buffer_load_dwordx4 v[32:35], v10, s[8:11], s4 offen offset:0 sc1
    buffer_load_dwordx4 v[36:39], v11, s[8:11], s4 offen offset:0 sc1
    s_waitcnt vmcnt(16)
    v_mfma_f32_32x32x16_bf16 v[112:127], v[48:51], v[176:179], v[112:127]
    v_mfma_f32_32x32x16_bf16 v[128:143], v[52:55], v[176:179], v[128:143]
    v_mfma_f32_32x32x16_bf16 v[144:159], v[48:51], v[180:183], v[144:159]
    v_mfma_f32_32x32x16_bf16 v[160:175], v[52:55], v[180:183], v[160:175]
    buffer_load_dwordx4 v[176:179], v8, s[12:15], s67 offen offset:2048 sc1
    buffer_load_dwordx4 v[180:183], v9, s[12:15], s67 offen offset:2048 sc1
    s_waitcnt vmcnt(16)
    v_mfma_f32_32x32x16_bf16 v[112:127], v[56:59], v[184:187], v[112:127]
    v_mfma_f32_32x32x16_bf16 v[128:143], v[60:63], v[184:187], v[128:143]
    v_mfma_f32_32x32x16_bf16 v[144:159], v[56:59], v[188:191], v[144:159]
    v_mfma_f32_32x32x16_bf16 v[160:175], v[60:63], v[188:191], v[160:175]
    buffer_load_dwordx4 v[184:187], v8, s[12:15], s67 offen offset:3072 sc1
    buffer_load_dwordx4 v[188:191], v9, s[12:15], s67 offen offset:3072 sc1
    s_add_u32 s4, s76, 12288
    buffer_load_dwordx4 v[40:43], v10, s[8:11], s4 offen offset:2048 sc1
    buffer_load_dwordx4 v[44:47], v11, s[8:11], s4 offen offset:2048 sc1
    s_waitcnt vmcnt(18)
    v_mfma_f32_32x32x16_bf16 v[112:127], v[64:67], v[192:195], v[112:127]
    v_mfma_f32_32x32x16_bf16 v[128:143], v[68:71], v[192:195], v[128:143]
    v_mfma_f32_32x32x16_bf16 v[144:159], v[64:67], v[196:199], v[144:159]
    v_mfma_f32_32x32x16_bf16 v[160:175], v[68:71], v[196:199], v[160:175]
    s_add_u32 s67, s67, 4096
    buffer_load_dwordx4 v[192:195], v8, s[12:15], s67 offen offset:0 sc1
    buffer_load_dwordx4 v[196:199], v9, s[12:15], s67 offen offset:0 sc1
    s_waitcnt vmcnt(18)
    v_mfma_f32_32x32x16_bf16 v[112:127], v[72:75], v[200:203], v[112:127]
    v_mfma_f32_32x32x16_bf16 v[128:143], v[76:79], v[200:203], v[128:143]
    v_mfma_f32_32x32x16_bf16 v[144:159], v[72:75], v[204:207], v[144:159]
    v_mfma_f32_32x32x16_bf16 v[160:175], v[76:79], v[204:207], v[160:175]
    buffer_load_dwordx4 v[200:203], v8, s[12:15], s67 offen offset:1024 sc1
    buffer_load_dwordx4 v[204:207], v9, s[12:15], s67 offen offset:1024 sc1
    s_add_u32 s4, s77, 0
    buffer_load_dwordx4 v[48:51], v10, s[8:11], s4 offen offset:0 sc1
    buffer_load_dwordx4 v[52:55], v11, s[8:11], s4 offen offset:0 sc1
    s_waitcnt vmcnt(20)
    v_mfma_f32_32x32x16_bf16 v[112:127], v[80:83], v[240:243], v[112:127]
    v_mfma_f32_32x32x16_bf16 v[128:143], v[84:87], v[240:243], v[128:143]
    v_mfma_f32_32x32x16_bf16 v[144:159], v[80:83], v[244:247], v[144:159]
    v_mfma_f32_32x32x16_bf16 v[160:175], v[84:87], v[244:247], v[160:175]
    buffer_load_dwordx4 v[240:243], v8, s[12:15], s67 offen offset:2048 sc1
    buffer_load_dwordx4 v[244:247], v9, s[12:15], s67 offen offset:2048 sc1
    s_lshl_b32 s4, s20, 12
    s_add_u32 s4, s4, 65536
    v_add_u32 v4, s4, v10
    v_add_u32 v5, s4, v11
    ds_read_b128 v[16:19], v4 offset:32768
    ds_read_b128 v[20:23], v5 offset:32768
    s_waitcnt vmcnt(20)
    v_mfma_f32_32x32x16_bf16 v[112:127], v[88:91], v[248:251], v[112:127]
    v_mfma_f32_32x32x16_bf16 v[128:143], v[92:95], v[248:251], v[128:143]
    v_mfma_f32_32x32x16_bf16 v[144:159], v[88:91], v[252:255], v[144:159]
    v_mfma_f32_32x32x16_bf16 v[160:175], v[92:95], v[252:255], v[160:175]
    buffer_load_dwordx4 v[248:251], v8, s[12:15], s67 offen offset:3072 sc1
    buffer_load_dwordx4 v[252:255], v9, s[12:15], s67 offen offset:3072 sc1
    s_add_u32 s4, s77, 0
    buffer_load_dwordx4 v[56:59], v10, s[8:11], s4 offen offset:2048 sc1
    buffer_load_dwordx4 v[60:63], v11, s[8:11], s4 offen offset:2048 sc1
    ds_read_b128 v[24:27], v4 offset:34816
    ds_read_b128 v[28:31], v5 offset:34816
    s_waitcnt vmcnt(22) lgkmcnt(2)
    v_mfma_f32_32x32x16_bf16 v[112:127], v[16:19], v[96:99], v[112:127]
    v_mfma_f32_32x32x16_bf16 v[128:143], v[20:23], v[96:99], v[128:143]
    v_mfma_f32_32x32x16_bf16 v[144:159], v[16:19], v[100:103], v[144:159]
    v_mfma_f32_32x32x16_bf16 v[160:175], v[20:23], v[100:103], v[160:175]
    buffer_load_dwordx4 v[96:99], v8, s[12:15], s68 offen offset:0 sc1
    buffer_load_dwordx4 v[100:103], v9, s[12:15], s68 offen offset:0 sc1
    ds_read_b128 v[16:19], v4 offset:0
    ds_read_b128 v[20:23], v5 offset:0
    s_waitcnt vmcnt(22) lgkmcnt(2)
    v_mfma_f32_32x32x16_bf16 v[112:127], v[24:27], v[104:107], v[112:127]
    v_mfma_f32_32x32x16_bf16 v[128:143], v[28:31], v[104:107], v[128:143]
    v_mfma_f32_32x32x16_bf16 v[144:159], v[24:27], v[108:111], v[144:159]
    v_mfma_f32_32x32x16_bf16 v[160:175], v[28:31], v[108:111], v[160:175]
    buffer_load_dwordx4 v[104:107], v8, s[12:15], s68 offen offset:1024 sc1
    buffer_load_dwordx4 v[108:111], v9, s[12:15], s68 offen offset:1024 sc1
    s_add_u32 s4, s77, 4096
    buffer_load_dwordx4 v[64:67], v10, s[8:11], s4 offen offset:0 sc1
    buffer_load_dwordx4 v[68:71], v11, s[8:11], s4 offen offset:0 sc1
    ds_read_b128 v[24:27], v4 offset:2048
    ds_read_b128 v[28:31], v5 offset:2048
    s_waitcnt vmcnt(22) lgkmcnt(2)
    v_mfma_f32_32x32x16_bf16 v[112:127], v[16:19], v[176:179], v[112:127]
    v_mfma_f32_32x32x16_bf16 v[128:143], v[20:23], v[176:179], v[128:143]
    v_mfma_f32_32x32x16_bf16 v[144:159], v[16:19], v[180:183], v[144:159]
    v_mfma_f32_32x32x16_bf16 v[160:175], v[20:23], v[180:183], v[160:175]
    buffer_load_dwordx4 v[176:179], v8, s[12:15], s68 offen offset:2048 sc1
    buffer_load_dwordx4 v[180:183], v9, s[12:15], s68 offen offset:2048 sc1
    v_subrev_u32 v4, 65536, v4
    v_subrev_u32 v5, 65536, v5
    ds_read_b128 v[16:19], v4 offset:0
    ds_read_b128 v[20:23], v5 offset:0
    s_waitcnt vmcnt(22) lgkmcnt(2)
    v_mfma_f32_32x32x16_bf16 v[112:127], v[24:27], v[184:187], v[112:127]
    v_mfma_f32_32x32x16_bf16 v[128:143], v[28:31], v[184:187], v[128:143]
    v_mfma_f32_32x32x16_bf16 v[144:159], v[24:27], v[188:191], v[144:159]
    v_mfma_f32_32x32x16_bf16 v[160:175], v[28:31], v[188:191], v[160:175]
    buffer_load_dwordx4 v[184:187], v8, s[12:15], s68 offen offset:3072 sc1
    buffer_load_dwordx4 v[188:191], v9, s[12:15], s68 offen offset:3072 sc1
    s_add_u32 s4, s77, 4096
    buffer_load_dwordx4 v[72:75], v10, s[8:11], s4 offen offset:2048 sc1
    buffer_load_dwordx4 v[76:79], v11, s[8:11], s4 offen offset:2048 sc1
    ds_read_b128 v[24:27], v4 offset:2048
    ds_read_b128 v[28:31], v5 offset:2048
    s_waitcnt vmcnt(22) lgkmcnt(2)
    v_mfma_f32_32x32x16_bf16 v[112:127], v[16:19], v[192:195], v[112:127]
    v_mfma_f32_32x32x16_bf16 v[128:143], v[20:23], v[192:195], v[128:143]
    v_mfma_f32_32x32x16_bf16 v[144:159], v[16:19], v[196:199], v[144:159]
    v_mfma_f32_32x32x16_bf16 v[160:175], v[20:23], v[196:199], v[160:175]
    s_add_u32 s68, s68, 4096
    buffer_load_dwordx4 v[192:195], v8, s[12:15], s68 offen offset:0 sc1
    buffer_load_dwordx4 v[196:199], v9, s[12:15], s68 offen offset:0 sc1
    s_waitcnt vmcnt(22) lgkmcnt(0)
    v_mfma_f32_32x32x16_bf16 v[112:127], v[24:27], v[200:203], v[112:127]
    v_mfma_f32_32x32x16_bf16 v[128:143], v[28:31], v[200:203], v[128:143]
    v_mfma_f32_32x32x16_bf16 v[144:159], v[24:27], v[204:207], v[144:159]
    v_mfma_f32_32x32x16_bf16 v[160:175], v[28:31], v[204:207], v[160:175]
    buffer_load_dwordx4 v[200:203], v8, s[12:15], s68 offen offset:1024 sc1
    buffer_load_dwordx4 v[204:207], v9, s[12:15], s68 offen offset:1024 sc1
    s_add_u32 s4, s77, 8192
    buffer_load_dwordx4 v[80:83], v10, s[8:11], s4 offen offset:0 sc1
    buffer_load_dwordx4 v[84:87], v11, s[8:11], s4 offen offset:0 sc1
    s_waitcnt vmcnt(22)
    v_mfma_f32_32x32x16_bf16 v[112:127], v[208:211], v[240:243], v[112:127]
    v_mfma_f32_32x32x16_bf16 v[128:143], v[212:215], v[240:243], v[128:143]
    v_mfma_f32_32x32x16_bf16 v[144:159], v[208:211], v[244:247], v[144:159]
    v_mfma_f32_32x32x16_bf16 v[160:175], v[212:215], v[244:247], v[160:175]
    buffer_load_dwordx4 v[240:243], v8, s[12:15], s68 offen offset:2048 sc1
    buffer_load_dwordx4 v[244:247], v9, s[12:15], s68 offen offset:2048 sc1
    s_waitcnt vmcnt(22)
    v_mfma_f32_32x32x16_bf16 v[112:127], v[216:219], v[248:251], v[112:127]
    v_mfma_f32_32x32x16_bf16 v[128:143], v[220:223], v[248:251], v[128:143]
    v_mfma_f32_32x32x16_bf16 v[144:159], v[216:219], v[252:255], v[144:159]
    v_mfma_f32_32x32x16_bf16 v[160:175], v[220:223], v[252:255], v[160:175]
    buffer_load_dwordx4 v[248:251], v8, s[12:15], s68 offen offset:3072 sc1
    buffer_load_dwordx4 v[252:255], v9, s[12:15], s68 offen offset:3072 sc1
    s_add_u32 s4, s77, 8192
    buffer_load_dwordx4 v[88:91], v10, s[8:11], s4 offen offset:2048 sc1
    buffer_load_dwordx4 v[92:95], v11, s[8:11], s4 offen offset:2048 sc1
    s_waitcnt vmcnt(22)
    v_mfma_f32_32x32x16_bf16 v[112:127], v[224:227], v[96:99], v[112:127]
    v_mfma_f32_32x32x16_bf16 v[128:143], v[228:231], v[96:99], v[128:143]
    v_mfma_f32_32x32x16_bf16 v[144:159], v[224:227], v[100:103], v[144:159]
    v_mfma_f32_32x32x16_bf16 v[160:175], v[228:231], v[100:103], v[160:175]
    buffer_load_dwordx4 v[96:99], v8, s[12:15], s69 offen offset:0 sc1
    buffer_load_dwordx4 v[100:103], v9, s[12:15], s69 offen offset:0 sc1
    v_add_u32 v4, s81, v10
    v_add_u32 v5, s81, v11
    ds_read_b128 v[16:19], v4 offset:0
    ds_read_b128 v[20:23], v5 offset:0
    s_waitcnt vmcnt(22)
    v_mfma_f32_32x32x16_bf16 v[112:127], v[232:235], v[104:107], v[112:127]
    v_mfma_f32_32x32x16_bf16 v[128:143], v[236:239], v[104:107], v[128:143]
    v_mfma_f32_32x32x16_bf16 v[144:159], v[232:235], v[108:111], v[144:159]
    v_mfma_f32_32x32x16_bf16 v[160:175], v[236:239], v[108:111], v[160:175]
    buffer_load_dwordx4 v[104:107], v8, s[12:15], s69 offen offset:1024 sc1
    buffer_load_dwordx4 v[108:111], v9, s[12:15], s69 offen offset:1024 sc1
    s_add_u32 s4, s77, 12288
    buffer_load_dwordx4 v[224:227], v10, s[8:11], s4 offen offset:0 sc1
    buffer_load_dwordx4 v[228:231], v11, s[8:11], s4 offen offset:0 sc1
    ds_read_b128 v[24:27], v4 offset:2048
    ds_read_b128 v[28:31], v5 offset:2048
    s_waitcnt vmcnt(22) lgkmcnt(2)
    v_mfma_f32_32x32x16_bf16 v[112:127], v[16:19], v[176:179], v[112:127]
    v_mfma_f32_32x32x16_bf16 v[128:143], v[20:23], v[176:179], v[128:143]
    v_mfma_f32_32x32x16_bf16 v[144:159], v[16:19], v[180:183], v[144:159]
    v_mfma_f32_32x32x16_bf16 v[160:175], v[20:23], v[180:183], v[160:175]
    buffer_load_dwordx4 v[176:179], v8, s[12:15], s69 offen offset:2048 sc1
    buffer_load_dwordx4 v[180:183], v9, s[12:15], s69 offen offset:2048 sc1
    ds_read_b128 v[16:19], v4 offset:4096
    ds_read_b128 v[20:23], v5 offset:4096
    s_waitcnt vmcnt(22) lgkmcnt(2)
    v_mfma_f32_32x32x16_bf16 v[112:127], v[24:27], v[184:187], v[112:127]
    v_mfma_f32_32x32x16_bf16 v[128:143], v[28:31], v[184:187], v[128:143]
    v_mfma_f32_32x32x16_bf16 v[144:159], v[24:27], v[188:191], v[144:159]
    v_mfma_f32_32x32x16_bf16 v[160:175], v[28:31], v[188:191], v[160:175]
    buffer_load_dwordx4 v[184:187], v8, s[12:15], s69 offen offset:3072 sc1
    buffer_load_dwordx4 v[188:191], v9, s[12:15], s69 offen offset:3072 sc1
    s_add_u32 s4, s77, 12288
    buffer_load_dwordx4 v[232:235], v10, s[8:11], s4 offen offset:2048 sc1
    buffer_load_dwordx4 v[236:239], v11, s[8:11], s4 offen offset:2048 sc1
    ds_read_b128 v[24:27], v4 offset:6144
    ds_read_b128 v[28:31], v5 offset:6144
    s_waitcnt vmcnt(22) lgkmcnt(2)
    v_mfma_f32_32x32x16_bf16 v[112:127], v[16:19], v[192:195], v[112:127]
    v_mfma_f32_32x32x16_bf16 v[128:143], v[20:23], v[192:195], v[128:143]
    v_mfma_f32_32x32x16_bf16 v[144:159], v[16:19], v[196:199], v[144:159]
    v_mfma_f32_32x32x16_bf16 v[160:175], v[20:23], v[196:199], v[160:175]
    s_add_u32 s69, s69, 4096
    buffer_load_dwordx4 v[192:195], v8, s[12:15], s69 offen offset:0 sc1
    buffer_load_dwordx4 v[196:199], v9, s[12:15], s69 offen offset:0 sc1
    s_waitcnt vmcnt(22) lgkmcnt(0)
    v_mfma_f32_32x32x16_bf16 v[112:127], v[24:27], v[200:203], v[112:127]
    v_mfma_f32_32x32x16_bf16 v[128:143], v[28:31], v[200:203], v[128:143]
    v_mfma_f32_32x32x16_bf16 v[144:159], v[24:27], v[204:207], v[144:159]
    v_mfma_f32_32x32x16_bf16 v[160:175], v[28:31], v[204:207], v[160:175]
    buffer_load_dwordx4 v[200:203], v8, s[12:15], s69 offen offset:1024 sc1
    buffer_load_dwordx4 v[204:207], v9, s[12:15], s69 offen offset:1024 sc1
    s_waitcnt vmcnt(20)
    v_mfma_f32_32x32x16_bf16 v[112:127], v[32:35], v[240:243], v[112:127]
    v_mfma_f32_32x32x16_bf16 v[128:143], v[36:39], v[240:243], v[128:143]
    v_mfma_f32_32x32x16_bf16 v[144:159], v[32:35], v[244:247], v[144:159]
    v_mfma_f32_32x32x16_bf16 v[160:175], v[36:39], v[244:247], v[160:175]
    buffer_load_dwordx4 v[240:243], v8, s[12:15], s69 offen offset:2048 sc1
    buffer_load_dwordx4 v[244:247], v9, s[12:15], s69 offen offset:2048 sc1
    s_waitcnt vmcnt(20)
    v_mfma_f32_32x32x16_bf16 v[112:127], v[40:43], v[248:251], v[112:127]
    v_mfma_f32_32x32x16_bf16 v[128:143], v[44:47], v[248:251], v[128:143]
    v_mfma_f32_32x32x16_bf16 v[144:159], v[40:43], v[252:255], v[144:159]
    v_mfma_f32_32x32x16_bf16 v[160:175], v[44:47], v[252:255], v[160:175]
    buffer_load_dwordx4 v[248:251], v8, s[12:15], s69 offen offset:3072 sc1
    buffer_load_dwordx4 v[252:255], v9, s[12:15], s69 offen offset:3072 sc1
    s_waitcnt vmcnt(18)
    v_mfma_f32_32x32x16_bf16 v[112:127], v[48:51], v[96:99], v[112:127]
    v_mfma_f32_32x32x16_bf16 v[128:143], v[52:55], v[96:99], v[128:143]
    v_mfma_f32_32x32x16_bf16 v[144:159], v[48:51], v[100:103], v[144:159]
    v_mfma_f32_32x32x16_bf16 v[160:175], v[52:55], v[100:103], v[160:175]
    buffer_load_dwordx4 v[96:99], v13, s[36:39], s27 offen
    s_add_u32 s4, s40, 8192
    buffer_load_dwordx4 v[208:211], v14, s[56:59], s4 offen sc1
    buffer_load_dwordx4 v[212:215], v14, s[56:59], s4 offen offset:16 sc1
    v_lshlrev_b32 v4, 4, v2
    v_lshl_add_u32 v4, v3, 11, v4
    s_lshl_b32 s4, s42, 9
    s_add_u32 s4, s4, 6144
    buffer_load_dwordx4 v[216:219], v4, s[56:59], s4 offen sc1
    s_waitcnt vmcnt(20)
    v_mfma_f32_32x32x16_bf16 v[112:127], v[56:59], v[104:107], v[112:127]
    v_mfma_f32_32x32x16_bf16 v[128:143], v[60:63], v[104:107], v[128:143]
    v_mfma_f32_32x32x16_bf16 v[144:159], v[56:59], v[108:111], v[144:159]
    v_mfma_f32_32x32x16_bf16 v[160:175], v[60:63], v[108:111], v[160:175]
    s_add_u32 s4, s40, 4096
    buffer_load_dwordx4 v[100:103], v14, s[56:59], s4 offen sc1
    buffer_load_dwordx4 v[104:107], v14, s[56:59], s4 offen offset:16 sc1
    s_waitcnt vmcnt(18)
    v_mfma_f32_32x32x16_bf16 v[112:127], v[64:67], v[176:179], v[112:127]
    v_mfma_f32_32x32x16_bf16 v[128:143], v[68:71], v[176:179], v[128:143]
    v_mfma_f32_32x32x16_bf16 v[144:159], v[64:67], v[180:183], v[144:159]
    v_mfma_f32_32x32x16_bf16 v[160:175], v[68:71], v[180:183], v[160:175]
    s_waitcnt vmcnt(16)
    v_mfma_f32_32x32x16_bf16 v[112:127], v[72:75], v[184:187], v[112:127]
    v_mfma_f32_32x32x16_bf16 v[128:143], v[76:79], v[184:187], v[128:143]
    v_mfma_f32_32x32x16_bf16 v[144:159], v[72:75], v[188:191], v[144:159]
    v_mfma_f32_32x32x16_bf16 v[160:175], v[76:79], v[188:191], v[160:175]
    s_cmp_eq_u32 s22, 0
    s_cbranch_scc1 L_kva_ts3
    s_barrier
L_kva_ts3:
    s_waitcnt vmcnt(12)
    v_mfma_f32_32x32x16_bf16 v[112:127], v[80:83], v[192:195], v[112:127]
    v_mfma_f32_32x32x16_bf16 v[128:143], v[84:87], v[192:195], v[128:143]
    v_mfma_f32_32x32x16_bf16 v[144:159], v[80:83], v[196:199], v[144:159]
    v_mfma_f32_32x32x16_bf16 v[160:175], v[84:87], v[196:199], v[160:175]
    s_waitcnt vmcnt(10)
    v_mfma_f32_32x32x16_bf16 v[112:127], v[88:91], v[200:203], v[112:127]
    v_mfma_f32_32x32x16_bf16 v[128:143], v[92:95], v[200:203], v[128:143]
    v_mfma_f32_32x32x16_bf16 v[144:159], v[88:91], v[204:207], v[144:159]
    v_mfma_f32_32x32x16_bf16 v[160:175], v[92:95], v[204:207], v[160:175]
    s_waitcnt vmcnt(8)
    v_mfma_f32_32x32x16_bf16 v[112:127], v[224:227], v[240:243], v[112:127]
    v_mfma_f32_32x32x16_bf16 v[128:143], v[228:231], v[240:243], v[128:143]
    v_mfma_f32_32x32x16_bf16 v[144:159], v[224:227], v[244:247], v[144:159]
    v_mfma_f32_32x32x16_bf16 v[160:175], v[228:231], v[244:247], v[160:175]
    s_waitcnt vmcnt(6)
    v_mfma_f32_32x32x16_bf16 v[112:127], v[232:235], v[248:251], v[112:127]
    v_mfma_f32_32x32x16_bf16 v[128:143], v[236:239], v[248:251], v[128:143]
    v_mfma_f32_32x32x16_bf16 v[144:159], v[232:235], v[252:255], v[144:159]
    v_mfma_f32_32x32x16_bf16 v[160:175], v[236:239], v[252:255], v[160:175]
    s_lshl_b32 s4, s20, 12
    v_add_u32 v4, s4, v12
    v_add_u32 v5, 65536, v4
    v_add_u32 v6, s81, v12
    s_nop 6
    ds_write_b128 v4, v[120:123] offset:0
    ds_write_b128 v4, v[124:127] offset:1024
    ds_write_b128 v4, v[128:131] offset:2048
    ds_write_b128 v4, v[132:135] offset:3072
    ds_write_b128 v5, v[136:139] offset:0
    ds_write_b128 v5, v[140:143] offset:1024
    ds_write_b128 v5, v[144:147] offset:2048
    ds_write_b128 v5, v[148:151] offset:3072
    ds_write_b128 v5, v[152:155] offset:32768
    ds_write_b128 v5, v[156:159] offset:33792
    s_nop 7
    ds_write_b128 v5, v[160:163] offset:34816
    ds_write_b128 v5, v[164:167] offset:35840
    ds_write_b128 v6, v[168:171] offset:0
    ds_write_b128 v6, v[172:175] offset:1024
    v_xor_b32 v177, 4096, v4
    v_xor_b32 v178, 8192, v4
    v_xor_b32 v179, 12288, v5
    v_xor_b32 v180, 16384, v5
    v_xor_b32 v181, 20480, v5
    v_xor_b32 v182, 24576, v5
    s_xor_b32 s4, s42, 3
    s_lshl_b32 s4, s4, 13
    s_mul_i32 s5, s22, 98304
    s_add_u32 s5, s5, 32768
    s_add_u32 s4, s4, s5
    v_add_u32 v183, s4, v12
    s_waitcnt vmcnt(0)
    s_cmp_lg_u32 s22, 0
    s_cbranch_scc1 L_kva_ts4
    s_barrier
    s_add_u32 s4, s44, 0
    buffer_load_dwordx4 v[20:23], v1, s[48:51], s4 offen offset:0 sc1
    s_add_u32 s4, s45, 0
    buffer_load_dwordx4 v[24:27], v1, s[48:51], s4 offen offset:0 sc1
    s_add_u32 s4, s46, 0
    buffer_load_dwordx4 v[28:31], v1, s[48:51], s4 offen offset:0 sc1
    s_add_u32 s4, s44, 0
    buffer_load_dwordx4 v[32:35], v1, s[48:51], s4 offen offset:2048 sc1
    s_add_u32 s4, s45, 0
    buffer_load_dwordx4 v[36:39], v1, s[48:51], s4 offen offset:2048 sc1
    s_add_u32 s4, s46, 0
    buffer_load_dwordx4 v[40:43], v1, s[48:51], s4 offen offset:2048 sc1
    s_add_u32 s4, s44, 4096
    buffer_load_dwordx4 v[44:47], v1, s[48:51], s4 offen offset:0 sc1
    s_add_u32 s4, s45, 4096
    buffer_load_dwordx4 v[48:51], v1, s[48:51], s4 offen offset:0 sc1
    s_add_u32 s4, s46, 4096
    buffer_load_dwordx4 v[52:55], v1, s[48:51], s4 offen offset:0 sc1
    s_add_u32 s4, s44, 4096
    buffer_load_dwordx4 v[56:59], v1, s[48:51], s4 offen offset:2048 sc1
    s_add_u32 s4, s45, 4096
    buffer_load_dwordx4 v[60:63], v1, s[48:51], s4 offen offset:2048 sc1
    s_add_u32 s4, s46, 4096
    buffer_load_dwordx4 v[64:67], v1, s[48:51], s4 offen offset:2048 sc1
    s_add_u32 s4, s44, 8192
    buffer_load_dwordx4 v[68:71], v1, s[48:51], s4 offen offset:0 sc1
    s_add_u32 s4, s45, 8192
    buffer_load_dwordx4 v[72:75], v1, s[48:51], s4 offen offset:0 sc1
    s_add_u32 s4, s46, 8192
    buffer_load_dwordx4 v[76:79], v1, s[48:51], s4 offen offset:0 sc1
    s_add_u32 s4, s44, 8192
    buffer_load_dwordx4 v[80:83], v1, s[48:51], s4 offen offset:2048 sc1
    s_add_u32 s4, s45, 8192
    buffer_load_dwordx4 v[84:87], v1, s[48:51], s4 offen offset:2048 sc1
    s_add_u32 s4, s46, 8192
    buffer_load_dwordx4 v[88:91], v1, s[48:51], s4 offen offset:2048 sc1
    s_add_u32 m0, s81, 2048
    s_add_u32 s4, s44, 12288
    buffer_load_dwordx4 v1, s[48:51], s4 offen offset:0 sc1 lds
    s_add_u32 m0, s81, 3072
    s_add_u32 s4, s45, 12288
    buffer_load_dwordx4 v1, s[48:51], s4 offen offset:0 sc1 lds
    s_add_u32 m0, s81, 4096
    s_add_u32 s4, s46, 12288
    buffer_load_dwordx4 v1, s[48:51], s4 offen offset:0 sc1 lds
    s_add_u32 m0, s81, 3072
    s_add_u32 s4, s44, 12288
    buffer_load_dwordx4 v1, s[48:51], s4 offen offset:2048 sc1 lds
    s_add_u32 m0, s81, 4096
    s_add_u32 s4, s45, 12288
    buffer_load_dwordx4 v1, s[48:51], s4 offen offset:2048 sc1 lds
    s_add_u32 m0, s81, 5120
    s_add_u32 s4, s46, 12288
    buffer_load_dwordx4 v1, s[48:51], s4 offen offset:2048 sc1 lds
L_kva_ts4:
    v_lshlrev_b32 v224, 16, v96
    v_and_b32 v225, 0xffff0000, v96
    v_lshlrev_b32 v226, 16, v97
    v_and_b32 v227, 0xffff0000, v97
    v_lshlrev_b32 v228, 16, v98
    v_and_b32 v229, 0xffff0000, v98
    v_lshlrev_b32 v230, 16, v99
    v_and_b32 v231, 0xffff0000, v99
    v_add_f32 v208, 1.0, v208
    v_add_f32 v209, 1.0, v209
    v_add_f32 v210, 1.0, v210
    v_add_f32 v211, 1.0, v211
    v_add_f32 v212, 1.0, v212
    v_add_f32 v213, 1.0, v213
    v_add_f32 v214, 1.0, v214
    v_add_f32 v215, 1.0, v215
    v_cvt_pk_bf16_f32 v208, v208, v209
    v_and_b32 v209, 0xffff0000, v208
    v_lshlrev_b32 v208, 16, v208
    v_cvt_pk_bf16_f32 v210, v210, v211
    v_and_b32 v211, 0xffff0000, v210
    v_lshlrev_b32 v210, 16, v210
    v_cvt_pk_bf16_f32 v212, v212, v213
    v_and_b32 v213, 0xffff0000, v212
    v_lshlrev_b32 v212, 16, v212
    v_cvt_pk_bf16_f32 v214, v214, v215
    v_and_b32 v215, 0xffff0000, v214
    v_lshlrev_b32 v214, 16, v214
    v_cvt_f32_u32 v220, v3
    v_add_f32 v216, v216, v220
    v_add_f32 v217, v217, v220
    v_add_f32 v218, v218, v220
    v_add_f32 v219, v219, v220
    v_cvt_pk_bf16_f32 v216, v216, v217
    v_cvt_pk_bf16_f32 v217, v218, v219
    s_mul_i32 s4, s20, 768
    s_add_u32 s4, s4, 43008
    v_lshlrev_b32 v218, 3, v0
    v_add_u32 v218, s4, v218
    v_lshlrev_b32 v219, 2, v0
    v_add_u32 v219, s4, v219
    v_mov_b32 v220, 0
    v_lshrrev_b32 v221, 2, v0
    v_xor_b32 v221, v221, v0
    v_and_b32 v221, 4, v221
    v_and_b32 v222, 2, v0
    v_or_b32 v221, v221, v222
    v_cmp_eq_u32 vcc, 0, v221
    v_and_b32 v222, 1, v0
    v_xor_b32 v222, 1, v222
    v_lshlrev_b32 v222, 8, v222
    v_lshl_add_u32 v222, v3, 4, v222
    v_mov_b32 v221, 512
    v_cndmask_b32 v221, v221, v222, vcc
    v_add_u32 v221, s4, v221
    s_lshl_b32 s4, s16, 1
    s_add_u32 s4, s4, s22
    s_lshl_b32 s4, s4, 5
    s_lshl_b32 s5, s17, 2
    s_add_u32 s4, s4, s5
    s_add_u32 s4, s4, s42
    s_lshl_b32 s4, s4, 10
    s_add_u32 s6, s4, 0x4800000
    s_waitcnt lgkmcnt(0)
    s_barrier
    ds_read_b128 v[120:123], v177 offset:0
    ds_read_b128 v[124:127], v177 offset:1024
    ds_read_b128 v[128:131], v178 offset:2048
    ds_read_b128 v[132:135], v178 offset:3072
    ds_read_b128 v[136:139], v179 offset:0
    ds_read_b128 v[140:143], v179 offset:1024
    ds_read_b128 v[144:147], v180 offset:2048
    ds_read_b128 v[148:151], v180 offset:3072
    ds_read_b128 v[152:155], v181 offset:32768
    ds_read_b128 v[156:159], v181 offset:33792
    ds_read_b128 v[160:163], v182 offset:34816
    ds_read_b128 v[164:167], v182 offset:35840
    ds_read_b128 v[168:171], v183 offset:0
    ds_read_b128 v[172:175], v183 offset:1024
    s_waitcnt lgkmcnt(12)
    v_pk_add_f32 v[112:113], v[112:113], v[120:121]
    v_pk_add_f32 v[114:115], v[114:115], v[122:123]
    v_pk_add_f32 v[116:117], v[116:117], v[124:125]
    v_pk_add_f32 v[118:119], v[118:119], v[126:127]
    s_waitcnt lgkmcnt(10)
    v_pk_add_f32 v[112:113], v[112:113], v[128:129]
    v_pk_add_f32 v[114:115], v[114:115], v[130:131]
    v_pk_add_f32 v[116:117], v[116:117], v[132:133]
    v_pk_add_f32 v[118:119], v[118:119], v[134:135]
    s_waitcnt lgkmcnt(8)
    v_pk_add_f32 v[112:113], v[112:113], v[136:137]
    v_pk_add_f32 v[114:115], v[114:115], v[138:139]
    v_pk_add_f32 v[116:117], v[116:117], v[140:141]
    v_pk_add_f32 v[118:119], v[118:119], v[142:143]
    s_waitcnt lgkmcnt(6)
    v_pk_add_f32 v[112:113], v[112:113], v[144:145]
    v_pk_add_f32 v[114:115], v[114:115], v[146:147]
    v_pk_add_f32 v[116:117], v[116:117], v[148:149]
    v_pk_add_f32 v[118:119], v[118:119], v[150:151]
    s_waitcnt lgkmcnt(4)
    v_pk_add_f32 v[112:113], v[112:113], v[152:153]
    v_pk_add_f32 v[114:115], v[114:115], v[154:155]
    v_pk_add_f32 v[116:117], v[116:117], v[156:157]
    v_pk_add_f32 v[118:119], v[118:119], v[158:159]
    s_waitcnt lgkmcnt(2)
    v_pk_add_f32 v[112:113], v[112:113], v[160:161]
    v_pk_add_f32 v[114:115], v[114:115], v[162:163]
    v_pk_add_f32 v[116:117], v[116:117], v[164:165]
    v_pk_add_f32 v[118:119], v[118:119], v[166:167]
    s_waitcnt lgkmcnt(0)
    v_pk_add_f32 v[112:113], v[112:113], v[168:169]
    v_pk_add_f32 v[114:115], v[114:115], v[170:171]
    v_pk_add_f32 v[116:117], v[116:117], v[172:173]
    v_pk_add_f32 v[118:119], v[118:119], v[174:175]
    v_pk_fma_f32 v[120:121], v[100:101], v[112:113], v[224:225]
    v_pk_fma_f32 v[122:123], v[102:103], v[114:115], v[226:227]
    v_pk_fma_f32 v[124:125], v[104:105], v[116:117], v[228:229]
    v_pk_fma_f32 v[126:127], v[106:107], v[118:119], v[230:231]
    v_pk_mul_f32 v[128:129], v[120:121], v[208:209]
    v_pk_mul_f32 v[130:131], v[122:123], v[210:211]
    v_pk_mul_f32 v[132:133], v[124:125], v[212:213]
    v_pk_mul_f32 v[134:135], v[126:127], v[214:215]
    v_cvt_pk_bf16_f32 v128, v128, v129
    v_cvt_pk_bf16_f32 v129, v130, v131
    v_cvt_pk_bf16_f32 v130, v132, v133
    v_cvt_pk_bf16_f32 v131, v134, v135
    v_min_u32 v128, -2, v128
    v_min_u32 v129, -2, v129
    v_min_u32 v130, -2, v130
    v_min_u32 v131, -2, v131
    s_cmp_eq_u32 s43, 0
    s_cbranch_scc1 L_kva_tf5
    buffer_store_dwordx4 v[128:131], v12, s[8:11], s6 offen
L_kva_tg6:
    ds_write_b64 v218, v[216:217]
    ds_write_b32 v219, v220 offset:512
    ds_read_b128 v[224:227], v221 offset:0
    ds_read_b128 v[228:231], v221 offset:32
    ds_read_b128 v[232:235], v221 offset:64
    ds_read_b128 v[236:239], v221 offset:96
    ds_read_b128 v[240:243], v221 offset:128
    ds_read_b128 v[244:247], v221 offset:160
    ds_read_b128 v[248:251], v221 offset:192
    ds_read_b128 v[252:255], v221 offset:224
    v_cvt_pk_bf16_f32 v16, v120, v121
    v_cvt_pk_bf16_f32 v17, v122, v123
    v_cvt_pk_bf16_f32 v18, v124, v125
    v_cvt_pk_bf16_f32 v19, v126, v127
    s_mov_b32 s5, 0x3f803f80
    v_dot2_f32_bf16 v132, v16, s5, 0
    v_dot2_f32_bf16 v133, v16, v16, 0
    v_dot2_f32_bf16 v132, v17, s5, v132
    v_dot2_f32_bf16 v133, v17, v17, v133
    v_dot2_f32_bf16 v132, v18, s5, v132
    v_dot2_f32_bf16 v133, v18, v18, v133
    v_dot2_f32_bf16 v132, v19, s5, v132
    v_dot2_f32_bf16 v133, v19, v19, v133
    s_lshl_b32 s4, s22, 11
    s_lshl_b32 s5, s42, 4
    s_add_u32 s4, s4, s5
    s_add_u32 s4, s4, 36864
    v_lshlrev_b32 v4, 6, v2
    v_lshl_add_u32 v4, v3, 3, v4
    v_add_u32 v4, s4, v4
    ds_write_b64 v4, v[132:133]
    v_lshlrev_b32 v5, 3, v2
    v_lshl_add_u32 v5, v3, 13, v5
    s_lshl_b32 s4, s23, 8
    s_add_u32 s4, s4, 512
    v_add_u32 v158, s4, v5
    s_add_u32 s41, s21, 4096
    s_waitcnt lgkmcnt(0)
    s_barrier
    s_cmp_lg_u32 s20, 4
    s_cbranch_scc1 L_kva_ts7
    v_lshlrev_b32 v4, 6, v0
    v_add_u32 v4, 36864, v4
    ds_read_b128 v[136:139], v4 offset:0
    ds_read_b128 v[140:143], v4 offset:16
    ds_read_b128 v[144:147], v4 offset:32
    ds_read_b128 v[148:151], v4 offset:48
    v_lshlrev_b32 v4, 3, v0
    s_waitcnt lgkmcnt(0)
    v_pk_add_f32 v[136:137], v[136:137], v[138:139]
    v_pk_add_f32 v[136:137], v[136:137], v[140:141]
    v_pk_add_f32 v[136:137], v[136:137], v[142:143]
    v_pk_add_f32 v[136:137], v[136:137], v[144:145]
    v_pk_add_f32 v[136:137], v[136:137], v[146:147]
    v_pk_add_f32 v[136:137], v[136:137], v[148:149]
    v_pk_add_f32 v[136:137], v[136:137], v[150:151]
    v_or_b32 v136, 1, v136
    v_or_b32 v137, 1, v137
    s_cmp_eq_u32 s43, 0
    s_cbranch_scc1 L_kva_tf8
    buffer_store_dwordx2 v[136:137], v4, s[56:59], s19 offen offset:512
L_kva_tg9:
L_kva_ts7:
    s_cmp_eq_u32 s22, 0
    s_cbranch_scc1 L_kva_ts10
    s_add_u32 s4, s44, 0
    buffer_load_dwordx4 v[20:23], v1, s[48:51], s4 offen offset:0 sc1
    s_add_u32 s4, s45, 0
    buffer_load_dwordx4 v[24:27], v1, s[48:51], s4 offen offset:0 sc1
    s_add_u32 s4, s46, 0
    buffer_load_dwordx4 v[28:31], v1, s[48:51], s4 offen offset:0 sc1
    s_add_u32 s4, s44, 0
    buffer_load_dwordx4 v[32:35], v1, s[48:51], s4 offen offset:2048 sc1
    s_add_u32 s4, s45, 0
    buffer_load_dwordx4 v[36:39], v1, s[48:51], s4 offen offset:2048 sc1
    s_add_u32 s4, s46, 0
    buffer_load_dwordx4 v[40:43], v1, s[48:51], s4 offen offset:2048 sc1
    s_add_u32 s4, s44, 4096
    buffer_load_dwordx4 v[44:47], v1, s[48:51], s4 offen offset:0 sc1
    s_add_u32 s4, s45, 4096
    buffer_load_dwordx4 v[48:51], v1, s[48:51], s4 offen offset:0 sc1
    s_add_u32 s4, s46, 4096
    buffer_load_dwordx4 v[52:55], v1, s[48:51], s4 offen offset:0 sc1
    s_add_u32 s4, s44, 4096
    buffer_load_dwordx4 v[56:59], v1, s[48:51], s4 offen offset:2048 sc1
    s_add_u32 s4, s45, 4096
    buffer_load_dwordx4 v[60:63], v1, s[48:51], s4 offen offset:2048 sc1
    s_add_u32 s4, s46, 4096
    buffer_load_dwordx4 v[64:67], v1, s[48:51], s4 offen offset:2048 sc1
    s_add_u32 s4, s44, 8192
    buffer_load_dwordx4 v[68:71], v1, s[48:51], s4 offen offset:0 sc1
    s_add_u32 s4, s45, 8192
    buffer_load_dwordx4 v[72:75], v1, s[48:51], s4 offen offset:0 sc1
    s_add_u32 s4, s46, 8192
    buffer_load_dwordx4 v[76:79], v1, s[48:51], s4 offen offset:0 sc1
    s_add_u32 s4, s44, 8192
    buffer_load_dwordx4 v[80:83], v1, s[48:51], s4 offen offset:2048 sc1
    s_add_u32 s4, s45, 8192
    buffer_load_dwordx4 v[84:87], v1, s[48:51], s4 offen offset:2048 sc1
    s_add_u32 s4, s46, 8192
    buffer_load_dwordx4 v[88:91], v1, s[48:51], s4 offen offset:2048 sc1
    s_add_u32 s4, s44, 12288
    buffer_load_dwordx4 v[184:187], v1, s[48:51], s4 offen offset:0 sc1
    s_add_u32 s4, s45, 12288
    buffer_load_dwordx4 v[188:191], v1, s[48:51], s4 offen offset:0 sc1
    s_add_u32 s4, s46, 12288
    buffer_load_dwordx4 v[192:195], v1, s[48:51], s4 offen offset:0 sc1
    s_add_u32 s4, s44, 12288
    buffer_load_dwordx4 v[196:199], v1, s[48:51], s4 offen offset:2048 sc1
    s_add_u32 s4, s45, 12288
    buffer_load_dwordx4 v[200:203], v1, s[48:51], s4 offen offset:2048 sc1
    s_add_u32 s4, s46, 12288
    buffer_load_dwordx4 v[204:207], v1, s[48:51], s4 offen offset:2048 sc1
L_kva_ts10:
    v_and_b32 v4, 0x33, v0
    v_bfe_u32 v6, v0, 2, 1
    v_lshl_or_b32 v4, v6, 3, v4
    v_bfe_u32 v6, v0, 3, 1
    v_lshl_or_b32 v4, v6, 2, v4
    s_lshl_b32 s4, s24, 4
    v_xor_b32 v4, s4, v4
    v_lshlrev_b32 v4, 4, v4
    s_cmp_eq_u32 s22, 0
    s_cselect_b64 vcc, -1, 0
    s_nop 1
    v_cndmask_b32 v10, v12, v4, vcc
    v_add_u32 v11, 4096, v10
    s_lshl_b32 s4, s16, 1
    s_add_u32 s4, s4, s23
    s_lshl_b32 s4, s4, 15
    s_lshl_b32 s5, s42, 13
    s_add_u32 s4, s4, s5
    s_add_u32 s28, s4, 0x4800000
    s_xor_b32 s29, s28, 0x8000
    s_lshl_b32 s4, s22, 17
    v_add_u32 v8, s4, v12
    s_xor_b32 s4, s4, 0x20000
    v_add_u32 v9, s4, v12
    s_lshl_b32 s4, s16, 18
    s_lshl_b32 s5, s20, 13
    s_add_u32 s4, s4, s5
    s_add_u32 s30, s4, 0x3800000
    s_lshl_b32 s4, s17, 7
    s_lshl_b32 s5, s20, 3
    s_add_u32 s4, s4, s5
    s_mul_i32 s4, s4, 3072
    s_add_u32 s31, s4, 0x5000000
    s_add_u32 s70, s30, 65536
    s_add_u32 s74, s31, 196608
    s_add_u32 s71, s30, 69632
    s_add_u32 s75, s31, 208896
    s_add_u32 s72, s30, 0
    s_add_u32 s76, s31, 0
    s_add_u32 s73, s30, 4096
    s_add_u32 s77, s31, 12288
    s_cmp_lg_u32 s22, 0
    s_cbranch_scc1 L_kva_tz18
    s_setprio 1
    buffer_load_dwordx4 v[92:95], v10, s[8:11], s28 offen offset:0 sc1
    buffer_load_dwordx4 v[96:99], v10, s[8:11], s29 offen offset:0 sc1
    buffer_load_dwordx4 v[100:103], v10, s[8:11], s28 offen offset:1024 sc1
    buffer_load_dwordx4 v[104:107], v10, s[8:11], s29 offen offset:1024 sc1
    buffer_load_dwordx4 v[108:111], v10, s[8:11], s28 offen offset:2048 sc1
    buffer_load_dwordx4 v[112:115], v10, s[8:11], s29 offen offset:2048 sc1
    buffer_load_dwordx4 v[116:119], v10, s[8:11], s28 offen offset:3072 sc1
    buffer_load_dwordx4 v[120:123], v10, s[8:11], s29 offen offset:3072 sc1
    buffer_load_dwordx4 v[124:127], v11, s[8:11], s28 offen offset:0 sc1
    buffer_load_dwordx4 v[128:131], v11, s[8:11], s29 offen offset:0 sc1
    buffer_load_dwordx4 v[132:135], v11, s[8:11], s28 offen offset:1024 sc1
    buffer_load_dwordx4 v[136:139], v11, s[8:11], s29 offen offset:1024 sc1
    buffer_load_dwordx4 v[140:143], v11, s[8:11], s28 offen offset:2048 sc1
    buffer_load_dwordx4 v[144:147], v11, s[8:11], s29 offen offset:2048 sc1
    buffer_load_dwordx4 v[148:151], v11, s[8:11], s28 offen offset:3072 sc1
    buffer_load_dwordx4 v[152:155], v11, s[8:11], s29 offen offset:3072 sc1
    v_add_u32 v4, s81, v12
    s_waitcnt vmcnt(16)
    ds_read_b128 v[184:187], v4 offset:2048
    ds_read_b128 v[188:191], v4 offset:3072
    ds_read_b128 v[192:195], v4 offset:4096
    ds_read_b128 v[196:199], v4 offset:5120
    ds_read_b128 v[200:203], v4 offset:6144
    ds_read_b128 v[204:207], v4 offset:7168
    v_mfma_f32_16x16x32_bf16 v[160:163], v[224:227], v[20:23], 0
    v_mfma_f32_16x16x32_bf16 v[164:167], v[224:227], v[24:27], 0
    v_mfma_f32_16x16x32_bf16 v[168:171], v[224:227], v[28:31], 0
    v_mfma_f32_16x16x32_bf16 v[160:163], v[228:231], v[32:35], v[160:163]
    v_mfma_f32_16x16x32_bf16 v[164:167], v[228:231], v[36:39], v[164:167]
    v_mfma_f32_16x16x32_bf16 v[168:171], v[228:231], v[40:43], v[168:171]
    v_mfma_f32_16x16x32_bf16 v[160:163], v[232:235], v[44:47], v[160:163]
    v_mfma_f32_16x16x32_bf16 v[164:167], v[232:235], v[48:51], v[164:167]
    v_mfma_f32_16x16x32_bf16 v[168:171], v[232:235], v[52:55], v[168:171]
    v_mfma_f32_16x16x32_bf16 v[160:163], v[236:239], v[56:59], v[160:163]
    v_mfma_f32_16x16x32_bf16 v[164:167], v[236:239], v[60:63], v[164:167]
    v_mfma_f32_16x16x32_bf16 v[168:171], v[236:239], v[64:67], v[168:171]
    v_mfma_f32_16x16x32_bf16 v[160:163], v[240:243], v[68:71], v[160:163]
    v_mfma_f32_16x16x32_bf16 v[164:167], v[240:243], v[72:75], v[164:167]
    v_mfma_f32_16x16x32_bf16 v[168:171], v[240:243], v[76:79], v[168:171]
    v_mfma_f32_16x16x32_bf16 v[160:163], v[244:247], v[80:83], v[160:163]
    v_mfma_f32_16x16x32_bf16 v[164:167], v[244:247], v[84:87], v[164:167]
    v_mfma_f32_16x16x32_bf16 v[168:171], v[244:247], v[88:91], v[168:171]
    s_waitcnt lgkmcnt(0)
    v_mfma_f32_16x16x32_bf16 v[160:163], v[248:251], v[184:187], v[160:163]
    v_mfma_f32_16x16x32_bf16 v[164:167], v[248:251], v[188:191], v[164:167]
    v_mfma_f32_16x16x32_bf16 v[168:171], v[248:251], v[192:195], v[168:171]
    v_mfma_f32_16x16x32_bf16 v[160:163], v[252:255], v[196:199], v[160:163]
    v_mfma_f32_16x16x32_bf16 v[164:167], v[252:255], v[200:203], v[164:167]
    v_mfma_f32_16x16x32_bf16 v[168:171], v[252:255], v[204:207], v[168:171]
    v_lshlrev_b32 v5, 1, v1
    v_and_b32 v5, 0x3e0, v5
    s_lshl_b32 s4, s42, 3
    s_add_u32 s4, s4, 147456
    v_add_u32 v5, s4, v5
    v_lshlrev_b32 v159, 5, v2
    v_add_u32 v159, 147456, v159
    s_nop 7
    ds_write_b64 v5, v[160:161] offset:0
    ds_write_b64 v5, v[164:165] offset:1024
    ds_write_b64 v5, v[168:169] offset:8192
    s_waitcnt vmcnt(14)
    v_max3_u32 v6, v92, v93, v94
    v_max3_u32 v6, v6, v95, v96
    v_max3_u32 v6, v6, v97, v98
    v_max_u32 v6, v6, v99
    v_cmp_eq_u32 vcc, -1, v6
    s_nop 3
    s_cbranch_vccnz L_kva_tv20
L_kva_tw21:
    v_mfma_f32_32x32x16_bf16 v[160:175], v[92:95], v[20:23], 0
    v_mfma_f32_32x32x16_bf16 v[176:191], v[92:95], v[24:27], 0
    v_mfma_f32_32x32x16_bf16 v[192:207], v[92:95], v[28:31], 0
    v_mfma_f32_32x32x16_bf16 v[208:223], v[96:99], v[20:23], 0
    v_mfma_f32_32x32x16_bf16 v[224:239], v[96:99], v[24:27], 0
    v_mfma_f32_32x32x16_bf16 v[240:255], v[96:99], v[28:31], 0
    ds_read_b128 v[20:23], v4 offset:2048
    ds_read_b128 v[24:27], v4 offset:3072
    ds_read_b128 v[28:31], v4 offset:4096
    s_waitcnt vmcnt(12)
    v_max3_u32 v6, v100, v101, v102
    v_max3_u32 v6, v6, v103, v104
    v_max3_u32 v6, v6, v105, v106
    v_max_u32 v6, v6, v107
    v_cmp_eq_u32 vcc, -1, v6
    s_nop 3
    s_cbranch_vccnz L_kva_tv23
L_kva_tw24:
    v_mfma_f32_32x32x16_bf16 v[160:175], v[100:103], v[32:35], v[160:175]
    v_mfma_f32_32x32x16_bf16 v[176:191], v[100:103], v[36:39], v[176:191]
    v_mfma_f32_32x32x16_bf16 v[192:207], v[100:103], v[40:43], v[192:207]
    v_mfma_f32_32x32x16_bf16 v[208:223], v[104:107], v[32:35], v[208:223]
    v_mfma_f32_32x32x16_bf16 v[224:239], v[104:107], v[36:39], v[224:239]
    v_mfma_f32_32x32x16_bf16 v[240:255], v[104:107], v[40:43], v[240:255]
    ds_read_b128 v[32:35], v4 offset:5120
    ds_read_b128 v[36:39], v4 offset:6144
    ds_read_b128 v[40:43], v4 offset:7168
    s_waitcnt vmcnt(10)
    v_max3_u32 v6, v108, v109, v110
    v_max3_u32 v6, v6, v111, v112
    v_max3_u32 v6, v6, v113, v114
    v_max_u32 v6, v6, v115
    v_cmp_eq_u32 vcc, -1, v6
    s_nop 3
    s_cbranch_vccnz L_kva_tv26
L_kva_tw27:
    v_mfma_f32_32x32x16_bf16 v[160:175], v[108:111], v[44:47], v[160:175]
    v_mfma_f32_32x32x16_bf16 v[176:191], v[108:111], v[48:51], v[176:191]
    v_mfma_f32_32x32x16_bf16 v[192:207], v[108:111], v[52:55], v[192:207]
    v_mfma_f32_32x32x16_bf16 v[208:223], v[112:115], v[44:47], v[208:223]
    v_mfma_f32_32x32x16_bf16 v[224:239], v[112:115], v[48:51], v[224:239]
    v_mfma_f32_32x32x16_bf16 v[240:255], v[112:115], v[52:55], v[240:255]
    s_waitcnt vmcnt(8)
    v_max3_u32 v6, v116, v117, v118
    v_max3_u32 v6, v6, v119, v120
    v_max3_u32 v6, v6, v121, v122
    v_max_u32 v6, v6, v123
    v_cmp_eq_u32 vcc, -1, v6
    s_nop 3
    s_cbranch_vccnz L_kva_tv29
L_kva_tw30:
    v_mfma_f32_32x32x16_bf16 v[160:175], v[116:119], v[56:59], v[160:175]
    v_mfma_f32_32x32x16_bf16 v[176:191], v[116:119], v[60:63], v[176:191]
    v_mfma_f32_32x32x16_bf16 v[192:207], v[116:119], v[64:67], v[192:207]
    v_mfma_f32_32x32x16_bf16 v[208:223], v[120:123], v[56:59], v[208:223]
    v_mfma_f32_32x32x16_bf16 v[224:239], v[120:123], v[60:63], v[224:239]
    v_mfma_f32_32x32x16_bf16 v[240:255], v[120:123], v[64:67], v[240:255]
    s_waitcnt vmcnt(6)
    v_max3_u32 v6, v124, v125, v126
    v_max3_u32 v6, v6, v127, v128
    v_max3_u32 v6, v6, v129, v130
    v_max_u32 v6, v6, v131
    v_cmp_eq_u32 vcc, -1, v6
    s_nop 3
    s_cbranch_vccnz L_kva_tv32
L_kva_tw33:
    v_mfma_f32_32x32x16_bf16 v[160:175], v[124:127], v[68:71], v[160:175]
    v_mfma_f32_32x32x16_bf16 v[176:191], v[124:127], v[72:75], v[176:191]
    v_mfma_f32_32x32x16_bf16 v[192:207], v[124:127], v[76:79], v[192:207]
    v_mfma_f32_32x32x16_bf16 v[208:223], v[128:131], v[68:71], v[208:223]
    v_mfma_f32_32x32x16_bf16 v[224:239], v[128:131], v[72:75], v[224:239]
    v_mfma_f32_32x32x16_bf16 v[240:255], v[128:131], v[76:79], v[240:255]
    buffer_load_dwordx2 v[108:109], v158, s[56:59], s21 offen offset:0 sc1
    buffer_load_dwordx2 v[110:111], v158, s[56:59], s21 offen offset:2048 sc1
    buffer_load_dwordx2 v[112:113], v158, s[56:59], s41 offen offset:0 sc1
    buffer_load_dwordx2 v[114:115], v158, s[56:59], s41 offen offset:2048 sc1
    s_waitcnt vmcnt(8)
    v_max3_u32 v6, v132, v133, v134
    v_max3_u32 v6, v6, v135, v136
    v_max3_u32 v6, v6, v137, v138
    v_max_u32 v6, v6, v139
    v_cmp_eq_u32 vcc, -1, v6
    s_nop 3
    s_cbranch_vccnz L_kva_tv35
L_kva_tw36:
    v_mfma_f32_32x32x16_bf16 v[160:175], v[132:135], v[80:83], v[160:175]
    v_mfma_f32_32x32x16_bf16 v[176:191], v[132:135], v[84:87], v[176:191]
    v_mfma_f32_32x32x16_bf16 v[192:207], v[132:135], v[88:91], v[192:207]
    v_mfma_f32_32x32x16_bf16 v[208:223], v[136:139], v[80:83], v[208:223]
    v_mfma_f32_32x32x16_bf16 v[224:239], v[136:139], v[84:87], v[224:239]
    v_mfma_f32_32x32x16_bf16 v[240:255], v[136:139], v[88:91], v[240:255]
    s_waitcnt vmcnt(6) lgkmcnt(3)
    v_max3_u32 v6, v140, v141, v142
    v_max3_u32 v6, v6, v143, v144
    v_max3_u32 v6, v6, v145, v146
    v_max_u32 v6, v6, v147
    v_cmp_eq_u32 vcc, -1, v6
    s_nop 3
    s_cbranch_vccnz L_kva_tv38
L_kva_tw39:
    v_mfma_f32_32x32x16_bf16 v[160:175], v[140:143], v[20:23], v[160:175]
    v_mfma_f32_32x32x16_bf16 v[176:191], v[140:143], v[24:27], v[176:191]
    v_mfma_f32_32x32x16_bf16 v[192:207], v[140:143], v[28:31], v[192:207]
    v_mfma_f32_32x32x16_bf16 v[208:223], v[144:147], v[20:23], v[208:223]
    v_mfma_f32_32x32x16_bf16 v[224:239], v[144:147], v[24:27], v[224:239]
    v_mfma_f32_32x32x16_bf16 v[240:255], v[144:147], v[28:31], v[240:255]
    s_waitcnt vmcnt(4) lgkmcnt(0)
    v_max3_u32 v6, v148, v149, v150
    v_max3_u32 v6, v6, v151, v152
    v_max3_u32 v6, v6, v153, v154
    v_max_u32 v6, v6, v155
    v_cmp_eq_u32 vcc, -1, v6
    s_nop 3
    s_cbranch_vccnz L_kva_tv41
L_kva_tw42:
    v_mfma_f32_32x32x16_bf16 v[160:175], v[148:151], v[32:35], v[160:175]
    v_mfma_f32_32x32x16_bf16 v[176:191], v[148:151], v[36:39], v[176:191]
    v_mfma_f32_32x32x16_bf16 v[192:207], v[148:151], v[40:43], v[192:207]
    v_mfma_f32_32x32x16_bf16 v[208:223], v[152:155], v[32:35], v[208:223]
    v_mfma_f32_32x32x16_bf16 v[224:239], v[152:155], v[36:39], v[224:239]
    v_mfma_f32_32x32x16_bf16 v[240:255], v[152:155], v[40:43], v[240:255]
    s_mov_b32 s7, 0x40000
L_kva_ta44:
    s_waitcnt vmcnt(0)
    v_min3_u32 v4, v108, v109, v110
    v_min3_u32 v6, v111, v112, v113
    v_min3_u32 v4, v4, v114, v115
    v_min_u32 v4, v4, v6
    v_cmp_eq_u32 vcc, 0, v4
    s_sub_u32 s7, s7, 1
    s_nop 2
    s_cbranch_vccz L_kva_tb45
    s_cmp_eq_u32 s7, 0
    s_cbranch_scc1 L_kva_tb45
    s_sleep 1
    buffer_load_dwordx2 v[108:109], v158, s[56:59], s21 offen offset:0 sc1
    buffer_load_dwordx2 v[110:111], v158, s[56:59], s21 offen offset:2048 sc1
    buffer_load_dwordx2 v[112:113], v158, s[56:59], s41 offen offset:0 sc1
    buffer_load_dwordx2 v[114:115], v158, s[56:59], s41 offen offset:2048 sc1
    s_branch L_kva_ta44
L_kva_tb45:
    buffer_load_dwordx4 v[20:23], v8, s[8:11], s70 offen offset:0 sc1
    buffer_load_dwordx4 v[24:27], v9, s[8:11], s70 offen offset:0 sc1
    buffer_load_dwordx4 v[28:31], v8, s[8:11], s70 offen offset:1024 sc1
    buffer_load_dwordx4 v[32:35], v9, s[8:11], s70 offen offset:1024 sc1
    buffer_load_dwordx4 v[36:39], v8, s[8:11], s70 offen offset:2048 sc1
    buffer_load_dwordx4 v[40:43], v9, s[8:11], s70 offen offset:2048 sc1
    buffer_load_dwordx4 v[44:47], v8, s[8:11], s70 offen offset:3072 sc1
    buffer_load_dwordx4 v[48:51], v9, s[8:11], s70 offen offset:3072 sc1
    buffer_load_dwordx4 v[52:55], v8, s[8:11], s71 offen offset:0 sc1
    buffer_load_dwordx4 v[56:59], v9, s[8:11], s71 offen offset:0 sc1
    buffer_load_dwordx4 v[60:63], v8, s[8:11], s71 offen offset:1024 sc1
    buffer_load_dwordx4 v[64:67], v9, s[8:11], s71 offen offset:1024 sc1
    buffer_load_dwordx4 v[68:71], v8, s[8:11], s71 offen offset:2048 sc1
    buffer_load_dwordx4 v[72:75], v9, s[8:11], s71 offen offset:2048 sc1
    buffer_load_dwordx4 v[76:79], v8, s[8:11], s71 offen offset:3072 sc1
    buffer_load_dwordx4 v[80:83], v9, s[8:11], s71 offen offset:3072 sc1
    buffer_load_dwordx4 v[84:87], v8, s[8:11], s72 offen offset:0 sc1
    buffer_load_dwordx4 v[88:91], v9, s[8:11], s72 offen offset:0 sc1
    buffer_load_dwordx4 v[92:95], v8, s[8:11], s72 offen offset:1024 sc1
    buffer_load_dwordx4 v[96:99], v9, s[8:11], s72 offen offset:1024 sc1
    buffer_load_dwordx4 v[100:103], v8, s[8:11], s72 offen offset:2048 sc1
    buffer_load_dwordx4 v[104:107], v9, s[8:11], s72 offen offset:2048 sc1
    s_xor_b32 s4, s20, 1
    s_mul_i32 s4, s4, 18432
    v_add_u32 v4, s4, v12
    s_xor_b32 s4, s20, 2
    s_mul_i32 s4, s4, 18432
    v_add_u32 v5, s4, v12
    s_xor_b32 s4, s20, 3
    s_mul_i32 s4, s4, 18432
    v_add_u32 v6, s4, v12
    ds_write_b128 v4, v[168:171] offset:0
    ds_write_b128 v4, v[172:175] offset:1024
    ds_write_b128 v4, v[184:187] offset:2048
    ds_write_b128 v4, v[188:191] offset:3072
    ds_write_b128 v4, v[200:203] offset:4096
    ds_write_b128 v4, v[204:207] offset:5120
    ds_write_b128 v5, v[208:211] offset:6144
    ds_write_b128 v5, v[212:215] offset:7168
    ds_write_b128 v5, v[224:227] offset:8192
    ds_write_b128 v5, v[228:231] offset:9216
    ds_write_b128 v5, v[240:243] offset:10240
    ds_write_b128 v5, v[244:247] offset:11264
    ds_write_b128 v6, v[216:219] offset:12288
    ds_write_b128 v6, v[220:223] offset:13312
    ds_write_b128 v6, v[232:235] offset:14336
    ds_write_b128 v6, v[236:239] offset:15360
    ds_write_b128 v6, v[248:251] offset:16384
    ds_write_b128 v6, v[252:255] offset:17408
    s_mul_i32 s4, s20, 18432
    v_add_u32 v4, s4, v12
    s_mov_b32 s4, 0xc0135761
    v_mov_b32 v11, s4
    v_pk_add_f32 v[108:109], v[108:109], v[110:111]
    v_pk_add_f32 v[108:109], v[108:109], v[112:113]
    v_pk_add_f32 v[108:109], v[108:109], v[114:115]
    v_mov_b32 v110, v108
    v_mov_b32 v111, v109
    s_nop 1
    v_permlane32_swap_b32 v108, v110
    v_permlane32_swap_b32 v109, v111
    s_nop 1
    v_pk_add_f32 v[108:109], v[108:109], v[110:111]
    v_mul_f32 v108, 0x3b000000, v108
    v_mul_f32 v109, 0x3b000000, v109
    v_fma_f32 v109, -v108, v108, v109
    v_max_f32 v109, 0, v109
    v_add_f32 v109, 0x3727c5ac, v109
    v_rsq_f32 v109, v109
    s_nop 0
    v_mul_f32 v108, -v108, v109
    s_lshl_b32 s4, s20, 8
    s_add_u32 s4, s4, 156672
    v_lshl_add_u32 v5, v2, 2, s4
    s_lshl_b32 s5, s24, 6
    s_add_u32 s4, s4, s5
    v_lshl_add_u32 v6, v3, 5, s4
    ds_write2_b32 v5, v109, v108 offset0:0 offset1:32
    ds_read_b128 v[140:143], v6 offset:0
    ds_read_b128 v[144:147], v6 offset:16
    ds_read_b128 v[148:151], v6 offset:128
    ds_read_b128 v[152:155], v6 offset:144
    s_waitcnt lgkmcnt(0)
    s_barrier
    ds_read_b128 v[116:119], v159 offset:0
    ds_read_b128 v[120:123], v159 offset:16
    ds_read_b128 v[124:127], v159 offset:1024
    ds_read_b128 v[128:131], v159 offset:1040
    ds_read_b128 v[132:135], v159 offset:8192
    ds_read_b128 v[136:139], v159 offset:8208
    ds_read_b128 v[168:171], v4 offset:0
    ds_read_b128 v[172:175], v4 offset:1024
    ds_read_b128 v[184:187], v4 offset:2048
    ds_read_b128 v[188:191], v4 offset:3072
    ds_read_b128 v[200:203], v4 offset:4096
    ds_read_b128 v[204:207], v4 offset:5120
    ds_read_b128 v[208:211], v4 offset:6144
    ds_read_b128 v[212:215], v4 offset:7168
    ds_read_b128 v[224:227], v4 offset:8192
    ds_read_b128 v[228:231], v4 offset:9216
    ds_read_b128 v[240:243], v4 offset:10240
    ds_read_b128 v[244:247], v4 offset:11264
    ds_read_b128 v[216:219], v4 offset:12288
    ds_read_b128 v[220:223], v4 offset:13312
    ds_read_b128 v[232:235], v4 offset:14336
    ds_read_b128 v[236:239], v4 offset:15360
    ds_read_b128 v[248:251], v4 offset:16384
    ds_read_b128 v[252:255], v4 offset:17408
    s_waitcnt lgkmcnt(15)
    v_pk_add_f32 v[160:161], v[160:161], v[168:169]
    v_pk_add_f32 v[162:163], v[162:163], v[170:171]
    v_pk_add_f32 v[164:165], v[164:165], v[172:173]
    v_pk_add_f32 v[166:167], v[166:167], v[174:175]
    v_pk_add_f32 v[116:117], v[116:117], v[120:121]
    v_pk_add_f32 v[118:119], v[118:119], v[122:123]
    v_pk_add_f32 v[116:117], v[116:117], v[118:119]
    s_waitcnt lgkmcnt(14)
    v_pk_add_f32 v[176:177], v[176:177], v[184:185]
    v_pk_add_f32 v[178:179], v[178:179], v[186:187]
    v_pk_add_f32 v[180:181], v[180:181], v[188:189]
    v_pk_add_f32 v[182:183], v[182:183], v[190:191]
    v_pk_add_f32 v[124:125], v[124:125], v[128:129]
    v_pk_add_f32 v[126:127], v[126:127], v[130:131]
    v_pk_add_f32 v[124:125], v[124:125], v[126:127]
    s_waitcnt lgkmcnt(12)
    v_pk_add_f32 v[192:193], v[192:193], v[200:201]
    v_pk_add_f32 v[194:195], v[194:195], v[202:203]
    v_pk_add_f32 v[196:197], v[196:197], v[204:205]
    v_pk_add_f32 v[198:199], v[198:199], v[206:207]
    v_pk_add_f32 v[132:133], v[132:133], v[136:137]
    v_pk_add_f32 v[134:135], v[134:135], v[138:139]
    v_pk_add_f32 v[132:133], v[132:133], v[134:135]
    s_waitcnt lgkmcnt(10)
    v_pk_add_f32 v[160:161], v[160:161], v[208:209]
    v_pk_add_f32 v[162:163], v[162:163], v[210:211]
    v_pk_add_f32 v[164:165], v[164:165], v[212:213]
    v_pk_add_f32 v[166:167], v[166:167], v[214:215]
    s_waitcnt lgkmcnt(8)
    v_pk_add_f32 v[176:177], v[176:177], v[224:225]
    v_pk_add_f32 v[178:179], v[178:179], v[226:227]
    v_pk_add_f32 v[180:181], v[180:181], v[228:229]
    v_pk_add_f32 v[182:183], v[182:183], v[230:231]
    s_waitcnt lgkmcnt(6)
    v_pk_add_f32 v[192:193], v[192:193], v[240:241]
    v_pk_add_f32 v[194:195], v[194:195], v[242:243]
    v_pk_add_f32 v[196:197], v[196:197], v[244:245]
    v_pk_add_f32 v[198:199], v[198:199], v[246:247]
    s_waitcnt lgkmcnt(4)
    v_pk_add_f32 v[160:161], v[160:161], v[216:217]
    v_pk_add_f32 v[162:163], v[162:163], v[218:219]
    v_pk_add_f32 v[164:165], v[164:165], v[220:221]
    v_pk_add_f32 v[166:167], v[166:167], v[222:223]
    v_pk_fma_f32 v[160:161], v[160:161], v[140:141], v[116:117] op_sel:[0,0,1] op_sel_hi:[1,1,1]
    v_pk_fma_f32 v[162:163], v[162:163], v[142:143], v[116:117] op_sel:[0,0,1] op_sel_hi:[1,1,1]
    v_pk_fma_f32 v[164:165], v[164:165], v[144:145], v[116:117] op_sel:[0,0,1] op_sel_hi:[1,1,1]
    v_pk_fma_f32 v[166:167], v[166:167], v[146:147], v[116:117] op_sel:[0,0,1] op_sel_hi:[1,1,1]
    v_pk_fma_f32 v[160:161], v[148:149], v[116:117], v[160:161] op_sel:[0,0,0] op_sel_hi:[1,0,1]
    v_pk_fma_f32 v[162:163], v[150:151], v[116:117], v[162:163] op_sel:[0,0,0] op_sel_hi:[1,0,1]
    v_pk_fma_f32 v[164:165], v[152:153], v[116:117], v[164:165] op_sel:[0,0,0] op_sel_hi:[1,0,1]
    v_pk_fma_f32 v[166:167], v[154:155], v[116:117], v[166:167] op_sel:[0,0,0] op_sel_hi:[1,0,1]
    s_waitcnt lgkmcnt(2)
    v_pk_add_f32 v[176:177], v[176:177], v[232:233]
    v_pk_add_f32 v[178:179], v[178:179], v[234:235]
    v_pk_add_f32 v[180:181], v[180:181], v[236:237]
    v_pk_add_f32 v[182:183], v[182:183], v[238:239]
    v_pk_fma_f32 v[176:177], v[176:177], v[140:141], v[124:125] op_sel:[0,0,1] op_sel_hi:[1,1,1]
    v_pk_fma_f32 v[178:179], v[178:179], v[142:143], v[124:125] op_sel:[0,0,1] op_sel_hi:[1,1,1]
    v_pk_fma_f32 v[180:181], v[180:181], v[144:145], v[124:125] op_sel:[0,0,1] op_sel_hi:[1,1,1]
    v_pk_fma_f32 v[182:183], v[182:183], v[146:147], v[124:125] op_sel:[0,0,1] op_sel_hi:[1,1,1]
    v_pk_fma_f32 v[176:177], v[148:149], v[124:125], v[176:177] op_sel:[0,0,0] op_sel_hi:[1,0,1]
    v_pk_fma_f32 v[178:179], v[150:151], v[124:125], v[178:179] op_sel:[0,0,0] op_sel_hi:[1,0,1]
    v_pk_fma_f32 v[180:181], v[152:153], v[124:125], v[180:181] op_sel:[0,0,0] op_sel_hi:[1,0,1]
    v_pk_fma_f32 v[182:183], v[154:155], v[124:125], v[182:183] op_sel:[0,0,0] op_sel_hi:[1,0,1]
    s_waitcnt lgkmcnt(0)
    v_pk_add_f32 v[192:193], v[192:193], v[248:249]
    v_pk_add_f32 v[194:195], v[194:195], v[250:251]
    v_pk_add_f32 v[196:197], v[196:197], v[252:253]
    v_pk_add_f32 v[198:199], v[198:199], v[254:255]
    v_pk_fma_f32 v[192:193], v[192:193], v[140:141], v[132:133] op_sel:[0,0,1] op_sel_hi:[1,1,1]
    v_pk_fma_f32 v[194:195], v[194:195], v[142:143], v[132:133] op_sel:[0,0,1] op_sel_hi:[1,1,1]
    v_pk_fma_f32 v[196:197], v[196:197], v[144:145], v[132:133] op_sel:[0,0,1] op_sel_hi:[1,1,1]
    v_pk_fma_f32 v[198:199], v[198:199], v[146:147], v[132:133] op_sel:[0,0,1] op_sel_hi:[1,1,1]
    v_pk_fma_f32 v[192:193], v[148:149], v[132:133], v[192:193] op_sel:[0,0,0] op_sel_hi:[1,0,1]
    v_pk_fma_f32 v[194:195], v[150:151], v[132:133], v[194:195] op_sel:[0,0,0] op_sel_hi:[1,0,1]
    v_pk_fma_f32 v[196:197], v[152:153], v[132:133], v[196:197] op_sel:[0,0,0] op_sel_hi:[1,0,1]
    v_pk_fma_f32 v[198:199], v[154:155], v[132:133], v[198:199] op_sel:[0,0,0] op_sel_hi:[1,0,1]
    s_mov_b32 s6, 0xbdd2d3e8
    s_mov_b32 s7, 1.0
    v_pk_mul_f32 v[168:169], v[160:161], v[160:161]
    v_pk_mul_f32 v[170:171], v[162:163], v[162:163]
    v_pk_mul_f32 v[172:173], v[164:165], v[164:165]
    v_pk_mul_f32 v[174:175], v[166:167], v[166:167]
    v_pk_fma_f32 v[168:169], v[168:169], s[6:7], v[10:11] op_sel:[0,0,1] op_sel_hi:[1,0,1]
    v_pk_fma_f32 v[170:171], v[170:171], s[6:7], v[10:11] op_sel:[0,0,1] op_sel_hi:[1,0,1]
    v_pk_fma_f32 v[172:173], v[172:173], s[6:7], v[10:11] op_sel:[0,0,1] op_sel_hi:[1,0,1]
    v_pk_fma_f32 v[174:175], v[174:175], s[6:7], v[10:11] op_sel:[0,0,1] op_sel_hi:[1,0,1]
    v_pk_mul_f32 v[168:169], v[168:169], v[160:161]
    v_pk_mul_f32 v[170:171], v[170:171], v[162:163]
    v_pk_mul_f32 v[172:173], v[172:173], v[164:165]
    v_pk_mul_f32 v[174:175], v[174:175], v[166:167]
    v_exp_f32 v168, v168
    v_exp_f32 v169, v169
    v_exp_f32 v170, v170
    v_exp_f32 v171, v171
    v_exp_f32 v172, v172
    v_exp_f32 v173, v173
    v_exp_f32 v174, v174
    v_exp_f32 v175, v175
    v_pk_add_f32 v[168:169], v[168:169], s[6:7] op_sel:[0,1] op_sel_hi:[1,1]
    v_pk_add_f32 v[170:171], v[170:171], s[6:7] op_sel:[0,1] op_sel_hi:[1,1]
    v_pk_add_f32 v[172:173], v[172:173], s[6:7] op_sel:[0,1] op_sel_hi:[1,1]
    v_pk_add_f32 v[174:175], v[174:175], s[6:7] op_sel:[0,1] op_sel_hi:[1,1]
    v_rcp_f32 v168, v168
    v_rcp_f32 v169, v169
    v_rcp_f32 v170, v170
    v_rcp_f32 v171, v171
    v_rcp_f32 v172, v172
    v_rcp_f32 v173, v173
    v_rcp_f32 v174, v174
    v_rcp_f32 v175, v175
    s_nop 0
    v_pk_mul_f32 v[160:161], v[168:169], v[160:161]
    v_pk_mul_f32 v[162:163], v[170:171], v[162:163]
    v_pk_mul_f32 v[164:165], v[172:173], v[164:165]
    v_pk_mul_f32 v[166:167], v[174:175], v[166:167]
    v_pk_mul_f32 v[184:185], v[176:177], v[176:177]
    v_pk_mul_f32 v[186:187], v[178:179], v[178:179]
    v_pk_mul_f32 v[188:189], v[180:181], v[180:181]
    v_pk_mul_f32 v[190:191], v[182:183], v[182:183]
    v_pk_fma_f32 v[184:185], v[184:185], s[6:7], v[10:11] op_sel:[0,0,1] op_sel_hi:[1,0,1]
    v_pk_fma_f32 v[186:187], v[186:187], s[6:7], v[10:11] op_sel:[0,0,1] op_sel_hi:[1,0,1]
    v_pk_fma_f32 v[188:189], v[188:189], s[6:7], v[10:11] op_sel:[0,0,1] op_sel_hi:[1,0,1]
    v_pk_fma_f32 v[190:191], v[190:191], s[6:7], v[10:11] op_sel:[0,0,1] op_sel_hi:[1,0,1]
    v_pk_mul_f32 v[184:185], v[184:185], v[176:177]
    v_pk_mul_f32 v[186:187], v[186:187], v[178:179]
    v_pk_mul_f32 v[188:189], v[188:189], v[180:181]
    v_pk_mul_f32 v[190:191], v[190:191], v[182:183]
    v_exp_f32 v184, v184
    v_exp_f32 v185, v185
    v_exp_f32 v186, v186
    v_exp_f32 v187, v187
    v_exp_f32 v188, v188
    v_exp_f32 v189, v189
    v_exp_f32 v190, v190
    v_exp_f32 v191, v191
    v_pk_add_f32 v[184:185], v[184:185], s[6:7] op_sel:[0,1] op_sel_hi:[1,1]
    v_pk_add_f32 v[186:187], v[186:187], s[6:7] op_sel:[0,1] op_sel_hi:[1,1]
    v_pk_add_f32 v[188:189], v[188:189], s[6:7] op_sel:[0,1] op_sel_hi:[1,1]
    v_pk_add_f32 v[190:191], v[190:191], s[6:7] op_sel:[0,1] op_sel_hi:[1,1]
    v_rcp_f32 v184, v184
    v_rcp_f32 v185, v185
    v_rcp_f32 v186, v186
    v_rcp_f32 v187, v187
    v_rcp_f32 v188, v188
    v_rcp_f32 v189, v189
    v_rcp_f32 v190, v190
    v_rcp_f32 v191, v191
    s_nop 0
    v_pk_mul_f32 v[176:177], v[184:185], v[176:177]
    v_pk_mul_f32 v[178:179], v[186:187], v[178:179]
    v_pk_mul_f32 v[180:181], v[188:189], v[180:181]
    v_pk_mul_f32 v[182:183], v[190:191], v[182:183]
    v_pk_mul_f32 v[200:201], v[192:193], v[192:193]
    v_pk_mul_f32 v[202:203], v[194:195], v[194:195]
    v_pk_mul_f32 v[204:205], v[196:197], v[196:197]
    v_pk_mul_f32 v[206:207], v[198:199], v[198:199]
    v_pk_fma_f32 v[200:201], v[200:201], s[6:7], v[10:11] op_sel:[0,0,1] op_sel_hi:[1,0,1]
    v_pk_fma_f32 v[202:203], v[202:203], s[6:7], v[10:11] op_sel:[0,0,1] op_sel_hi:[1,0,1]
    v_pk_fma_f32 v[204:205], v[204:205], s[6:7], v[10:11] op_sel:[0,0,1] op_sel_hi:[1,0,1]
    v_pk_fma_f32 v[206:207], v[206:207], s[6:7], v[10:11] op_sel:[0,0,1] op_sel_hi:[1,0,1]
    v_pk_mul_f32 v[200:201], v[200:201], v[192:193]
    v_pk_mul_f32 v[202:203], v[202:203], v[194:195]
    v_pk_mul_f32 v[204:205], v[204:205], v[196:197]
    v_pk_mul_f32 v[206:207], v[206:207], v[198:199]
    v_exp_f32 v200, v200
    v_exp_f32 v201, v201
    v_exp_f32 v202, v202
    v_exp_f32 v203, v203
    v_exp_f32 v204, v204
    v_exp_f32 v205, v205
    v_exp_f32 v206, v206
    v_exp_f32 v207, v207
    v_pk_add_f32 v[200:201], v[200:201], s[6:7] op_sel:[0,1] op_sel_hi:[1,1]
    v_pk_add_f32 v[202:203], v[202:203], s[6:7] op_sel:[0,1] op_sel_hi:[1,1]
    v_pk_add_f32 v[204:205], v[204:205], s[6:7] op_sel:[0,1] op_sel_hi:[1,1]
    v_pk_add_f32 v[206:207], v[206:207], s[6:7] op_sel:[0,1] op_sel_hi:[1,1]
    v_rcp_f32 v200, v200
    v_rcp_f32 v201, v201
    v_rcp_f32 v202, v202
    v_rcp_f32 v203, v203
    v_rcp_f32 v204, v204
    v_rcp_f32 v205, v205
    v_rcp_f32 v206, v206
    v_rcp_f32 v207, v207
    s_nop 0
    v_pk_mul_f32 v[192:193], v[200:201], v[192:193]
    v_pk_mul_f32 v[194:195], v[202:203], v[194:195]
    v_pk_mul_f32 v[196:197], v[204:205], v[196:197]
    v_pk_mul_f32 v[198:199], v[206:207], v[198:199]
    v_pk_add_f32 v[208:209], v[160:161], v[176:177]
    v_pk_add_f32 v[210:211], v[162:163], v[178:179]
    v_pk_add_f32 v[212:213], v[164:165], v[180:181]
    v_pk_add_f32 v[214:215], v[166:167], v[182:183]
    v_pk_mul_f32 v[216:217], v[160:161], v[160:161]
    v_pk_mul_f32 v[218:219], v[162:163], v[162:163]
    v_pk_mul_f32 v[220:221], v[164:165], v[164:165]
    v_pk_mul_f32 v[222:223], v[166:167], v[166:167]
    v_pk_add_f32 v[208:209], v[208:209], v[192:193]
    v_pk_add_f32 v[210:211], v[210:211], v[194:195]
    v_pk_add_f32 v[212:213], v[212:213], v[196:197]
    v_pk_add_f32 v[214:215], v[214:215], v[198:199]
    v_pk_fma_f32 v[216:217], v[176:177], v[176:177], v[216:217]
    v_pk_fma_f32 v[218:219], v[178:179], v[178:179], v[218:219]
    v_pk_fma_f32 v[220:221], v[180:181], v[180:181], v[220:221]
    v_pk_fma_f32 v[222:223], v[182:183], v[182:183], v[222:223]
    v_pk_fma_f32 v[216:217], v[192:193], v[192:193], v[216:217]
    v_pk_fma_f32 v[218:219], v[194:195], v[194:195], v[218:219]
    v_pk_fma_f32 v[220:221], v[196:197], v[196:197], v[220:221]
    v_pk_fma_f32 v[222:223], v[198:199], v[198:199], v[222:223]
    s_nop 1
    v_permlane16_swap_b32 v208, v216
    v_permlane16_swap_b32 v209, v217
    v_permlane16_swap_b32 v210, v218
    v_permlane16_swap_b32 v211, v219
    v_permlane16_swap_b32 v212, v220
    v_permlane16_swap_b32 v213, v221
    v_permlane16_swap_b32 v214, v222
    v_permlane16_swap_b32 v215, v223
    s_nop 1
    v_pk_add_f32 v[208:209], v[208:209], v[216:217]
    v_pk_add_f32 v[210:211], v[210:211], v[218:219]
    v_pk_add_f32 v[212:213], v[212:213], v[220:221]
    v_pk_add_f32 v[214:215], v[214:215], v[222:223]
    s_nop 0
    v_add_f32_dpp v208, v208, v208 row_ror:8
    v_add_f32_dpp v209, v209, v209 row_ror:8
    v_add_f32_dpp v210, v210, v210 row_ror:8
    v_add_f32_dpp v211, v211, v211 row_ror:8
    v_add_f32_dpp v212, v212, v212 row_ror:8
    v_add_f32_dpp v213, v213, v213 row_ror:8
    v_add_f32_dpp v214, v214, v214 row_ror:8
    v_add_f32_dpp v215, v215, v215 row_ror:8
    s_nop 0
    v_add_f32_dpp v208, v208, v208 row_ror:4
    v_add_f32_dpp v209, v209, v209 row_ror:4
    v_add_f32_dpp v210, v210, v210 row_ror:4
    v_add_f32_dpp v211, v211, v211 row_ror:4
    v_add_f32_dpp v212, v212, v212 row_ror:4
    v_add_f32_dpp v213, v213, v213 row_ror:4
    v_add_f32_dpp v214, v214, v214 row_ror:4
    v_add_f32_dpp v215, v215, v215 row_ror:4
    s_nop 0
    v_add_f32_dpp v208, v208, v208 row_ror:2
    v_add_f32_dpp v209, v209, v209 row_ror:2
    v_add_f32_dpp v210, v210, v210 row_ror:2
    v_add_f32_dpp v211, v211, v211 row_ror:2
    v_add_f32_dpp v212, v212, v212 row_ror:2
    v_add_f32_dpp v213, v213, v213 row_ror:2
    v_add_f32_dpp v214, v214, v214 row_ror:2
    v_add_f32_dpp v215, v215, v215 row_ror:2
    s_nop 0
    v_add_f32_dpp v208, v208, v208 row_ror:1
    v_add_f32_dpp v209, v209, v209 row_ror:1
    v_add_f32_dpp v210, v210, v210 row_ror:1
    v_add_f32_dpp v211, v211, v211 row_ror:1
    v_add_f32_dpp v212, v212, v212 row_ror:1
    v_add_f32_dpp v213, v213, v213 row_ror:1
    v_add_f32_dpp v214, v214, v214 row_ror:1
    v_add_f32_dpp v215, v215, v215 row_ror:1
    v_or_b32 v208, 1, v208
    v_or_b32 v209, 1, v209
    v_or_b32 v210, 1, v210
    v_or_b32 v211, 1, v211
    v_or_b32 v212, 1, v212
    v_or_b32 v213, 1, v213
    v_or_b32 v214, 1, v214
    v_or_b32 v215, 1, v215
    v_and_b32 v4, 15, v0
    v_lshlrev_b32 v5, 1, v0
    v_mov_b32 v6, 0x7f000000
    v_cmp_eq_u32 vcc, 0, v4
    s_lshl_b32 s4, s20, 7
    s_add_u32 s5, s4, s19
    v_cndmask_b32 v4, v6, v5, vcc
    s_cmp_eq_u32 s43, 0
    s_cbranch_scc1 L_kva_tf46
    buffer_store_dwordx4 v[208:211], v4, s[56:59], s5 offen offset:1024
    buffer_store_dwordx4 v[212:215], v4, s[56:59], s5 offen offset:1040
L_kva_tg47:
    v_lshrrev_b32 v4, 3, v0
    v_lshlrev_b32 v4, 11, v4
    v_and_b32 v5, 7, v0
    v_lshl_add_u32 v4, v5, 4, v4
    s_add_u32 s6, s4, s21
    buffer_load_dwordx4 v[224:227], v4, s[56:59], s6 offen offset:1024 sc1
    v_bfe_u32 v5, v0, 2, 1
    v_lshlrev_b32 v5, 6, v5
    v_and_b32 v6, 1, v0
    v_lshl_add_u32 v5, v6, 4, v5
    v_bfe_u32 v6, v0, 1, 1
    v_lshl_add_u32 v5, v6, 7, v5
    s_lshl_b32 s4, s20, 8
    s_add_u32 s4, s4, 159744
    v_add_u32 v5, s4, v5
    v_lshlrev_b32 v11, 6, v3
    v_add_u32 v11, s4, v11
    s_mov_b32 s7, 0x40000
L_kva_ta48:
    s_waitcnt vmcnt(0)
    v_min3_u32 v6, v224, v225, v226
    v_min_u32 v6, v6, v227
    v_cmp_eq_u32 vcc, 0, v6
    s_sub_u32 s7, s7, 1
    s_nop 2
    s_cbranch_vccz L_kva_tb49
    s_cmp_eq_u32 s7, 0
    s_cbranch_scc1 L_kva_tb49
    s_sleep 1
    buffer_load_dwordx4 v[224:227], v4, s[56:59], s6 offen offset:1024 sc1
    s_branch L_kva_ta48
L_kva_tb49:
    v_add_f32_dpp v224, v224, v224 row_ror:8
    v_add_f32_dpp v225, v225, v225 row_ror:8
    v_add_f32_dpp v226, v226, v226 row_ror:8
    v_add_f32_dpp v227, v227, v227 row_ror:8
    v_mov_b32 v228, v224
    v_mov_b32 v229, v225
    v_mov_b32 v230, v226
    v_mov_b32 v231, v227
    s_nop 1
    v_permlane16_swap_b32 v224, v228
    v_permlane16_swap_b32 v225, v229
    v_permlane16_swap_b32 v226, v230
    v_permlane16_swap_b32 v227, v231
    s_nop 1
    v_add_f32 v224, v224, v228
    v_add_f32 v225, v225, v229
    v_add_f32 v226, v226, v230
    v_add_f32 v227, v227, v231
    v_mov_b32 v228, v224
    v_mov_b32 v229, v225
    v_mov_b32 v230, v226
    v_mov_b32 v231, v227
    s_nop 1
    v_permlane32_swap_b32 v224, v228
    v_permlane32_swap_b32 v225, v229
    v_permlane32_swap_b32 v226, v230
    v_permlane32_swap_b32 v227, v231
    s_nop 1
    v_add_f32 v224, v224, v228
    v_add_f32 v225, v225, v229
    v_add_f32 v226, v226, v230
    v_add_f32 v227, v227, v231
    s_nop 1
    v_mov_b32_dpp v228, v224 quad_perm:[2,3,0,1]
    v_mov_b32_dpp v229, v225 quad_perm:[2,3,0,1]
    v_mov_b32_dpp v230, v226 quad_perm:[2,3,0,1]
    v_mov_b32_dpp v231, v227 quad_perm:[2,3,0,1]
    v_mul_f32 v224, 0x3abe82fa, v224
    v_mul_f32 v228, 0x3abe82fa, v228
    v_mul_f32 v225, 0x3abe82fa, v225
    v_mul_f32 v229, 0x3abe82fa, v229
    v_mul_f32 v226, 0x3abe82fa, v226
    v_mul_f32 v230, 0x3abe82fa, v230
    v_mul_f32 v227, 0x3abe82fa, v227
    v_mul_f32 v231, 0x3abe82fa, v231
    v_fma_f32 v228, -v224, v224, v228
    v_fma_f32 v229, -v225, v225, v229
    v_fma_f32 v230, -v226, v226, v230
    v_fma_f32 v231, -v227, v227, v231
    v_max_f32 v228, 0, v228
    v_max_f32 v229, 0, v229
    v_max_f32 v230, 0, v230
    v_max_f32 v231, 0, v231
    v_add_f32 v228, 0x3727c5ac, v228
    v_add_f32 v229, 0x3727c5ac, v229
    v_add_f32 v230, 0x3727c5ac, v230
    v_add_f32 v231, 0x3727c5ac, v231
    v_rsq_f32 v228, v228
    v_rsq_f32 v229, v229
    v_rsq_f32 v230, v230
    v_rsq_f32 v231, v231
    s_nop 0
    v_mul_f32 v224, -v224, v228
    v_mul_f32 v225, -v225, v229
    v_mul_f32 v226, -v226, v230
    v_mul_f32 v227, -v227, v231
    ds_write_b128 v5, v[228:231]
    ds_write_b128 v5, v[224:227] offset:32
    ds_read_b128 v[208:211], v11 offset:0
    ds_read_b128 v[212:215], v11 offset:16
    ds_read_b128 v[216:219], v11 offset:32
    ds_read_b128 v[220:223], v11 offset:48
    s_lshl_b32 s4, s17, 7
    s_lshl_b32 s5, s16, 2
    s_add_u32 s4, s4, s5
    s_add_u32 s4, s4, s42
    s_mul_i32 s4, s4, 3072
    s_add_u32 s4, s4, 0x5000000
    s_waitcnt lgkmcnt(0)
    v_pk_fma_f32 v[160:161], v[160:161], v[208:209], v[216:217]
    v_pk_fma_f32 v[162:163], v[162:163], v[210:211], v[218:219]
    v_pk_fma_f32 v[164:165], v[164:165], v[212:213], v[220:221]
    v_pk_fma_f32 v[166:167], v[166:167], v[214:215], v[222:223]
    v_cvt_pk_bf16_f32 v168, v160, v161
    v_cvt_pk_bf16_f32 v169, v162, v163
    v_cvt_pk_bf16_f32 v170, v164, v165
    v_cvt_pk_bf16_f32 v171, v166, v167
    v_min_u32 v168, -2, v168
    v_min_u32 v169, -2, v169
    v_min_u32 v170, -2, v170
    v_min_u32 v171, -2, v171
    buffer_store_dwordx4 v[168:171], v12, s[8:11], s4 offen offset:0 sc1
    v_pk_fma_f32 v[176:177], v[176:177], v[208:209], v[216:217]
    v_pk_fma_f32 v[178:179], v[178:179], v[210:211], v[218:219]
    v_pk_fma_f32 v[180:181], v[180:181], v[212:213], v[220:221]
    v_pk_fma_f32 v[182:183], v[182:183], v[214:215], v[222:223]
    v_cvt_pk_bf16_f32 v184, v176, v177
    v_cvt_pk_bf16_f32 v185, v178, v179
    v_cvt_pk_bf16_f32 v186, v180, v181
    v_cvt_pk_bf16_f32 v187, v182, v183
    v_min_u32 v184, -2, v184
    v_min_u32 v185, -2, v185
    v_min_u32 v186, -2, v186
    v_min_u32 v187, -2, v187
    buffer_store_dwordx4 v[184:187], v12, s[8:11], s4 offen offset:1024 sc1
    v_pk_fma_f32 v[192:193], v[192:193], v[208:209], v[216:217]
    v_pk_fma_f32 v[194:195], v[194:195], v[210:211], v[218:219]
    v_pk_fma_f32 v[196:197], v[196:197], v[212:213], v[220:221]
    v_pk_fma_f32 v[198:199], v[198:199], v[214:215], v[222:223]
    v_cvt_pk_bf16_f32 v200, v192, v193
    v_cvt_pk_bf16_f32 v201, v194, v195
    v_cvt_pk_bf16_f32 v202, v196, v197
    v_cvt_pk_bf16_f32 v203, v198, v199
    v_min_u32 v200, -2, v200
    v_min_u32 v201, -2, v201
    v_min_u32 v202, -2, v202
    v_min_u32 v203, -2, v203
    buffer_store_dwordx4 v[200:203], v12, s[8:11], s4 offen offset:2048 sc1
    v_mov_b32 v4, 1
    s_cmp_eq_u32 s20, 0
    s_cselect_b32 s4, s19, 0x7f000000
    s_barrier
    buffer_store_dword v4, v7, s[56:59], s4 offen offset:128 sc1
    s_setprio 0
    s_branch L_kva_tj19
L_kva_tz18:
    s_sleep 3
    buffer_load_dwordx4 v[92:95], v10, s[8:11], s28 offen offset:0 sc1
    buffer_load_dwordx4 v[96:99], v10, s[8:11], s29 offen offset:0 sc1
    buffer_load_dwordx4 v[100:103], v10, s[8:11], s28 offen offset:1024 sc1
    buffer_load_dwordx4 v[104:107], v10, s[8:11], s29 offen offset:1024 sc1
    buffer_load_dwordx4 v[108:111], v10, s[8:11], s28 offen offset:2048 sc1
    buffer_load_dwordx4 v[112:115], v10, s[8:11], s29 offen offset:2048 sc1
    buffer_load_dwordx4 v[116:119], v10, s[8:11], s28 offen offset:3072 sc1
    buffer_load_dwordx4 v[120:123], v10, s[8:11], s29 offen offset:3072 sc1
    buffer_load_dwordx4 v[124:127], v11, s[8:11], s28 offen offset:0 sc1
    buffer_load_dwordx4 v[128:131], v11, s[8:11], s29 offen offset:0 sc1
    buffer_load_dwordx4 v[132:135], v11, s[8:11], s28 offen offset:1024 sc1
    buffer_load_dwordx4 v[136:139], v11, s[8:11], s29 offen offset:1024 sc1
    buffer_load_dwordx4 v[140:143], v11, s[8:11], s28 offen offset:2048 sc1
    buffer_load_dwordx4 v[144:147], v11, s[8:11], s29 offen offset:2048 sc1
    buffer_load_dwordx4 v[148:151], v11, s[8:11], s28 offen offset:3072 sc1
    buffer_load_dwordx4 v[152:155], v11, s[8:11], s29 offen offset:3072 sc1
    s_barrier
    s_waitcnt vmcnt(16)
    v_mfma_f32_16x16x32_bf16 v[160:163], v[224:227], v[20:23], 0
    v_mfma_f32_16x16x32_bf16 v[164:167], v[224:227], v[24:27], 0
    v_mfma_f32_16x16x32_bf16 v[168:171], v[224:227], v[28:31], 0
    v_mfma_f32_16x16x32_bf16 v[160:163], v[228:231], v[32:35], v[160:163]
    v_mfma_f32_16x16x32_bf16 v[164:167], v[228:231], v[36:39], v[164:167]
    v_mfma_f32_16x16x32_bf16 v[168:171], v[228:231], v[40:43], v[168:171]
    v_mfma_f32_16x16x32_bf16 v[160:163], v[232:235], v[44:47], v[160:163]
    v_mfma_f32_16x16x32_bf16 v[164:167], v[232:235], v[48:51], v[164:167]
    v_mfma_f32_16x16x32_bf16 v[168:171], v[232:235], v[52:55], v[168:171]
    v_mfma_f32_16x16x32_bf16 v[160:163], v[236:239], v[56:59], v[160:163]
    v_mfma_f32_16x16x32_bf16 v[164:167], v[236:239], v[60:63], v[164:167]
    v_mfma_f32_16x16x32_bf16 v[168:171], v[236:239], v[64:67], v[168:171]
    v_mfma_f32_16x16x32_bf16 v[160:163], v[240:243], v[68:71], v[160:163]
    v_mfma_f32_16x16x32_bf16 v[164:167], v[240:243], v[72:75], v[164:167]
    v_mfma_f32_16x16x32_bf16 v[168:171], v[240:243], v[76:79], v[168:171]
    v_mfma_f32_16x16x32_bf16 v[160:163], v[244:247], v[80:83], v[160:163]
    v_mfma_f32_16x16x32_bf16 v[164:167], v[244:247], v[84:87], v[164:167]
    v_mfma_f32_16x16x32_bf16 v[168:171], v[244:247], v[88:91], v[168:171]
    v_mfma_f32_16x16x32_bf16 v[160:163], v[248:251], v[184:187], v[160:163]
    v_mfma_f32_16x16x32_bf16 v[164:167], v[248:251], v[188:191], v[164:167]
    v_mfma_f32_16x16x32_bf16 v[168:171], v[248:251], v[192:195], v[168:171]
    v_mfma_f32_16x16x32_bf16 v[160:163], v[252:255], v[196:199], v[160:163]
    v_mfma_f32_16x16x32_bf16 v[164:167], v[252:255], v[200:203], v[164:167]
    v_mfma_f32_16x16x32_bf16 v[168:171], v[252:255], v[204:207], v[168:171]
    v_lshlrev_b32 v5, 1, v1
    v_and_b32 v5, 0x3e0, v5
    s_lshl_b32 s4, s42, 3
    s_add_u32 s4, s4, 160768
    v_add_u32 v5, s4, v5
    v_lshlrev_b32 v159, 5, v2
    v_add_u32 v159, 160768, v159
    s_nop 7
    ds_write_b64 v5, v[160:161] offset:0
    ds_write_b64 v5, v[164:165] offset:1024
    ds_write_b64 v5, v[168:169] offset:2048
    s_waitcnt vmcnt(14)
    v_max3_u32 v6, v92, v93, v94
    v_max3_u32 v6, v6, v95, v96
    v_max3_u32 v6, v6, v97, v98
    v_max_u32 v6, v6, v99
    v_cmp_eq_u32 vcc, -1, v6
    s_nop 3
    s_cbranch_vccnz L_kva_tv50
L_kva_tw51:
    v_mfma_f32_32x32x16_bf16 v[160:175], v[20:23], v[92:95], 0
    v_mfma_f32_32x32x16_bf16 v[176:191], v[24:27], v[92:95], 0
    v_mfma_f32_32x32x16_bf16 v[192:207], v[28:31], v[92:95], 0
    v_mfma_f32_32x32x16_bf16 v[208:223], v[20:23], v[96:99], 0
    v_mfma_f32_32x32x16_bf16 v[224:239], v[24:27], v[96:99], 0
    v_mfma_f32_32x32x16_bf16 v[240:255], v[28:31], v[96:99], 0
    s_add_u32 s4, s44, 12288
    buffer_load_dwordx4 v[20:23], v1, s[48:51], s4 offen offset:0 sc1
    s_add_u32 s4, s45, 12288
    buffer_load_dwordx4 v[24:27], v1, s[48:51], s4 offen offset:0 sc1
    s_add_u32 s4, s46, 12288
    buffer_load_dwordx4 v[28:31], v1, s[48:51], s4 offen offset:0 sc1
    s_waitcnt vmcnt(15)
    v_max3_u32 v6, v100, v101, v102
    v_max3_u32 v6, v6, v103, v104
    v_max3_u32 v6, v6, v105, v106
    v_max_u32 v6, v6, v107
    v_cmp_eq_u32 vcc, -1, v6
    s_nop 3
    s_cbranch_vccnz L_kva_tv53
L_kva_tw54:
    v_mfma_f32_32x32x16_bf16 v[160:175], v[32:35], v[100:103], v[160:175]
    v_mfma_f32_32x32x16_bf16 v[176:191], v[36:39], v[100:103], v[176:191]
    v_mfma_f32_32x32x16_bf16 v[192:207], v[40:43], v[100:103], v[192:207]
    v_mfma_f32_32x32x16_bf16 v[208:223], v[32:35], v[104:107], v[208:223]
    v_mfma_f32_32x32x16_bf16 v[224:239], v[36:39], v[104:107], v[224:239]
    v_mfma_f32_32x32x16_bf16 v[240:255], v[40:43], v[104:107], v[240:255]
    s_add_u32 s4, s44, 12288
    buffer_load_dwordx4 v[32:35], v1, s[48:51], s4 offen offset:2048 sc1
    s_add_u32 s4, s45, 12288
    buffer_load_dwordx4 v[36:39], v1, s[48:51], s4 offen offset:2048 sc1
    s_add_u32 s4, s46, 12288
    buffer_load_dwordx4 v[40:43], v1, s[48:51], s4 offen offset:2048 sc1
    s_waitcnt vmcnt(16)
    v_max3_u32 v6, v108, v109, v110
    v_max3_u32 v6, v6, v111, v112
    v_max3_u32 v6, v6, v113, v114
    v_max_u32 v6, v6, v115
    v_cmp_eq_u32 vcc, -1, v6
    s_nop 3
    s_cbranch_vccnz L_kva_tv56
L_kva_tw57:
    v_mfma_f32_32x32x16_bf16 v[160:175], v[44:47], v[108:111], v[160:175]
    v_mfma_f32_32x32x16_bf16 v[176:191], v[48:51], v[108:111], v[176:191]
    v_mfma_f32_32x32x16_bf16 v[192:207], v[52:55], v[108:111], v[192:207]
    v_mfma_f32_32x32x16_bf16 v[208:223], v[44:47], v[112:115], v[208:223]
    v_mfma_f32_32x32x16_bf16 v[224:239], v[48:51], v[112:115], v[224:239]
    v_mfma_f32_32x32x16_bf16 v[240:255], v[52:55], v[112:115], v[240:255]
    s_waitcnt vmcnt(14)
    v_max3_u32 v6, v116, v117, v118
    v_max3_u32 v6, v6, v119, v120
    v_max3_u32 v6, v6, v121, v122
    v_max_u32 v6, v6, v123
    v_cmp_eq_u32 vcc, -1, v6
    s_nop 3
    s_cbranch_vccnz L_kva_tv59
L_kva_tw60:
    v_mfma_f32_32x32x16_bf16 v[160:175], v[56:59], v[116:119], v[160:175]
    v_mfma_f32_32x32x16_bf16 v[176:191], v[60:63], v[116:119], v[176:191]
    v_mfma_f32_32x32x16_bf16 v[192:207], v[64:67], v[116:119], v[192:207]
    v_mfma_f32_32x32x16_bf16 v[208:223], v[56:59], v[120:123], v[208:223]
    v_mfma_f32_32x32x16_bf16 v[224:239], v[60:63], v[120:123], v[224:239]
    v_mfma_f32_32x32x16_bf16 v[240:255], v[64:67], v[120:123], v[240:255]
    s_waitcnt vmcnt(12)
    v_max3_u32 v6, v124, v125, v126
    v_max3_u32 v6, v6, v127, v128
    v_max3_u32 v6, v6, v129, v130
    v_max_u32 v6, v6, v131
    v_cmp_eq_u32 vcc, -1, v6
    s_nop 3
    s_cbranch_vccnz L_kva_tv62
L_kva_tw63:
    v_mfma_f32_32x32x16_bf16 v[160:175], v[68:71], v[124:127], v[160:175]
    v_mfma_f32_32x32x16_bf16 v[176:191], v[72:75], v[124:127], v[176:191]
    v_mfma_f32_32x32x16_bf16 v[192:207], v[76:79], v[124:127], v[192:207]
    v_mfma_f32_32x32x16_bf16 v[208:223], v[68:71], v[128:131], v[208:223]
    v_mfma_f32_32x32x16_bf16 v[224:239], v[72:75], v[128:131], v[224:239]
    v_mfma_f32_32x32x16_bf16 v[240:255], v[76:79], v[128:131], v[240:255]
    buffer_load_dwordx2 v[108:109], v158, s[56:59], s21 offen offset:0 sc1
    buffer_load_dwordx2 v[110:111], v158, s[56:59], s21 offen offset:2048 sc1
    buffer_load_dwordx2 v[112:113], v158, s[56:59], s41 offen offset:0 sc1
    buffer_load_dwordx2 v[114:115], v158, s[56:59], s41 offen offset:2048 sc1
    s_waitcnt vmcnt(14)
    v_max3_u32 v6, v132, v133, v134
    v_max3_u32 v6, v6, v135, v136
    v_max3_u32 v6, v6, v137, v138
    v_max_u32 v6, v6, v139
    v_cmp_eq_u32 vcc, -1, v6
    s_nop 3
    s_cbranch_vccnz L_kva_tv65
L_kva_tw66:
    v_mfma_f32_32x32x16_bf16 v[160:175], v[80:83], v[132:135], v[160:175]
    v_mfma_f32_32x32x16_bf16 v[176:191], v[84:87], v[132:135], v[176:191]
    v_mfma_f32_32x32x16_bf16 v[192:207], v[88:91], v[132:135], v[192:207]
    v_mfma_f32_32x32x16_bf16 v[208:223], v[80:83], v[136:139], v[208:223]
    v_mfma_f32_32x32x16_bf16 v[224:239], v[84:87], v[136:139], v[224:239]
    v_mfma_f32_32x32x16_bf16 v[240:255], v[88:91], v[136:139], v[240:255]
    s_waitcnt vmcnt(7)
    v_max3_u32 v6, v140, v141, v142
    v_max3_u32 v6, v6, v143, v144
    v_max3_u32 v6, v6, v145, v146
    v_max_u32 v6, v6, v147
    v_cmp_eq_u32 vcc, -1, v6
    s_nop 3
    s_cbranch_vccnz L_kva_tv68
L_kva_tw69:
    v_mfma_f32_32x32x16_bf16 v[160:175], v[20:23], v[140:143], v[160:175]
    v_mfma_f32_32x32x16_bf16 v[176:191], v[24:27], v[140:143], v[176:191]
    v_mfma_f32_32x32x16_bf16 v[192:207], v[28:31], v[140:143], v[192:207]
    v_mfma_f32_32x32x16_bf16 v[208:223], v[20:23], v[144:147], v[208:223]
    v_mfma_f32_32x32x16_bf16 v[224:239], v[24:27], v[144:147], v[224:239]
    v_mfma_f32_32x32x16_bf16 v[240:255], v[28:31], v[144:147], v[240:255]
    s_waitcnt vmcnt(4)
    v_max3_u32 v6, v148, v149, v150
    v_max3_u32 v6, v6, v151, v152
    v_max3_u32 v6, v6, v153, v154
    v_max_u32 v6, v6, v155
    v_cmp_eq_u32 vcc, -1, v6
    s_nop 3
    s_cbranch_vccnz L_kva_tv71
L_kva_tw72:
    v_mfma_f32_32x32x16_bf16 v[160:175], v[32:35], v[148:151], v[160:175]
    v_mfma_f32_32x32x16_bf16 v[176:191], v[36:39], v[148:151], v[176:191]
    v_mfma_f32_32x32x16_bf16 v[192:207], v[40:43], v[148:151], v[192:207]
    v_mfma_f32_32x32x16_bf16 v[208:223], v[32:35], v[152:155], v[208:223]
    v_mfma_f32_32x32x16_bf16 v[224:239], v[36:39], v[152:155], v[224:239]
    v_mfma_f32_32x32x16_bf16 v[240:255], v[40:43], v[152:155], v[240:255]
    s_mov_b32 s7, 0x40000
L_kva_ta74:
    s_waitcnt vmcnt(0)
    v_min3_u32 v4, v108, v109, v110
    v_min3_u32 v6, v111, v112, v113
    v_min3_u32 v4, v4, v114, v115
    v_min_u32 v4, v4, v6
    v_cmp_eq_u32 vcc, 0, v4
    s_sub_u32 s7, s7, 1
    s_nop 2
    s_cbranch_vccz L_kva_tb75
    s_cmp_eq_u32 s7, 0
    s_cbranch_scc1 L_kva_tb75
    s_sleep 1
    buffer_load_dwordx2 v[108:109], v158, s[56:59], s21 offen offset:0 sc1
    buffer_load_dwordx2 v[110:111], v158, s[56:59], s21 offen offset:2048 sc1
    buffer_load_dwordx2 v[112:113], v158, s[56:59], s41 offen offset:0 sc1
    buffer_load_dwordx2 v[114:115], v158, s[56:59], s41 offen offset:2048 sc1
    s_branch L_kva_ta74
L_kva_tb75:
    buffer_load_dwordx4 v[20:23], v8, s[8:11], s70 offen offset:0 sc1
    buffer_load_dwordx4 v[24:27], v9, s[8:11], s70 offen offset:0 sc1
    buffer_load_dwordx4 v[28:31], v8, s[8:11], s70 offen offset:1024 sc1
    buffer_load_dwordx4 v[32:35], v9, s[8:11], s70 offen offset:1024 sc1
    buffer_load_dwordx4 v[36:39], v8, s[8:11], s70 offen offset:2048 sc1
    buffer_load_dwordx4 v[40:43], v9, s[8:11], s70 offen offset:2048 sc1
    buffer_load_dwordx4 v[44:47], v8, s[8:11], s70 offen offset:3072 sc1
    buffer_load_dwordx4 v[48:51], v9, s[8:11], s70 offen offset:3072 sc1
    buffer_load_dwordx4 v[52:55], v8, s[8:11], s71 offen offset:0 sc1
    buffer_load_dwordx4 v[56:59], v9, s[8:11], s71 offen offset:0 sc1
    buffer_load_dwordx4 v[60:63], v8, s[8:11], s71 offen offset:1024 sc1
    buffer_load_dwordx4 v[64:67], v9, s[8:11], s71 offen offset:1024 sc1
    buffer_load_dwordx4 v[68:71], v8, s[8:11], s71 offen offset:2048 sc1
    buffer_load_dwordx4 v[72:75], v9, s[8:11], s71 offen offset:2048 sc1
    buffer_load_dwordx4 v[76:79], v8, s[8:11], s71 offen offset:3072 sc1
    buffer_load_dwordx4 v[80:83], v9, s[8:11], s71 offen offset:3072 sc1
    buffer_load_dwordx4 v[84:87], v8, s[8:11], s72 offen offset:0 sc1
    buffer_load_dwordx4 v[88:91], v9, s[8:11], s72 offen offset:0 sc1
    buffer_load_dwordx4 v[92:95], v8, s[8:11], s72 offen offset:1024 sc1
    buffer_load_dwordx4 v[96:99], v9, s[8:11], s72 offen offset:1024 sc1
    buffer_load_dwordx4 v[100:103], v8, s[8:11], s72 offen offset:2048 sc1
    buffer_load_dwordx4 v[104:107], v9, s[8:11], s72 offen offset:2048 sc1
    s_xor_b32 s4, s20, 1
    s_mul_i32 s4, s4, 18432
    v_add_u32 v4, s4, v12
    s_xor_b32 s4, s20, 2
    s_mul_i32 s4, s4, 18432
    v_add_u32 v5, s4, v12
    s_xor_b32 s4, s20, 3
    s_mul_i32 s4, s4, 18432
    v_add_u32 v6, s4, v12
    s_nop 7
    ds_write_b128 v4, v[168:171] offset:0
    ds_write_b128 v4, v[172:175] offset:1024
    ds_write_b128 v4, v[184:187] offset:2048
    ds_write_b128 v4, v[188:191] offset:3072
    ds_write_b128 v4, v[200:203] offset:4096
    ds_write_b128 v4, v[204:207] offset:5120
    ds_write_b128 v5, v[208:211] offset:6144
    ds_write_b128 v5, v[212:215] offset:7168
    ds_write_b128 v5, v[224:227] offset:8192
    ds_write_b128 v5, v[228:231] offset:9216
    s_nop 3
    ds_write_b128 v5, v[240:243] offset:10240
    ds_write_b128 v5, v[244:247] offset:11264
    ds_write_b128 v6, v[216:219] offset:12288
    ds_write_b128 v6, v[220:223] offset:13312
    ds_write_b128 v6, v[232:235] offset:14336
    ds_write_b128 v6, v[236:239] offset:15360
    ds_write_b128 v6, v[248:251] offset:16384
    ds_write_b128 v6, v[252:255] offset:17408
    s_mul_i32 s4, s20, 18432
    v_add_u32 v4, s4, v12
    s_mov_b32 s4, 0xc0135761
    v_mov_b32 v11, s4
    v_pk_add_f32 v[108:109], v[108:109], v[110:111]
    v_pk_add_f32 v[108:109], v[108:109], v[112:113]
    v_pk_add_f32 v[108:109], v[108:109], v[114:115]
    v_mov_b32 v110, v108
    v_mov_b32 v111, v109
    s_nop 1
    v_permlane32_swap_b32 v108, v110
    v_permlane32_swap_b32 v109, v111
    s_nop 1
    v_pk_add_f32 v[108:109], v[108:109], v[110:111]
    v_mul_f32 v108, 0x3b000000, v108
    v_mul_f32 v109, 0x3b000000, v109
    v_fma_f32 v109, -v108, v108, v109
    v_max_f32 v109, 0, v109
    v_add_f32 v109, 0x3727c5ac, v109
    v_rsq_f32 v109, v109
    s_nop 0
    v_mul_f32 v108, -v108, v109
    s_waitcnt lgkmcnt(0)
    s_barrier
    ds_read_b128 v[116:119], v159 offset:0
    ds_read_b128 v[120:123], v159 offset:16
    ds_read_b128 v[124:127], v159 offset:1024
    ds_read_b128 v[128:131], v159 offset:1040
    ds_read_b128 v[132:135], v159 offset:2048
    ds_read_b128 v[136:139], v159 offset:2064
    ds_read_b128 v[168:171], v4 offset:0
    ds_read_b128 v[172:175], v4 offset:1024
    ds_read_b128 v[184:187], v4 offset:2048
    ds_read_b128 v[188:191], v4 offset:3072
    ds_read_b128 v[200:203], v4 offset:4096
    ds_read_b128 v[204:207], v4 offset:5120
    ds_read_b128 v[208:211], v4 offset:6144
    ds_read_b128 v[212:215], v4 offset:7168
    ds_read_b128 v[224:227], v4 offset:8192
    ds_read_b128 v[228:231], v4 offset:9216
    ds_read_b128 v[240:243], v4 offset:10240
    ds_read_b128 v[244:247], v4 offset:11264
    ds_read_b128 v[216:219], v4 offset:12288
    ds_read_b128 v[220:223], v4 offset:13312
    ds_read_b128 v[232:235], v4 offset:14336
    ds_read_b128 v[236:239], v4 offset:15360
    ds_read_b128 v[248:251], v4 offset:16384
    ds_read_b128 v[252:255], v4 offset:17408
    s_waitcnt lgkmcnt(15)
    v_pk_add_f32 v[160:161], v[160:161], v[168:169]
    v_pk_add_f32 v[162:163], v[162:163], v[170:171]
    v_pk_add_f32 v[164:165], v[164:165], v[172:173]
    v_pk_add_f32 v[166:167], v[166:167], v[174:175]
    v_pk_add_f32 v[116:117], v[116:117], v[120:121]
    v_pk_add_f32 v[118:119], v[118:119], v[122:123]
    v_pk_add_f32 v[116:117], v[116:117], v[118:119]
    s_waitcnt lgkmcnt(14)
    v_pk_add_f32 v[176:177], v[176:177], v[184:185]
    v_pk_add_f32 v[178:179], v[178:179], v[186:187]
    v_pk_add_f32 v[180:181], v[180:181], v[188:189]
    v_pk_add_f32 v[182:183], v[182:183], v[190:191]
    v_pk_add_f32 v[124:125], v[124:125], v[128:129]
    v_pk_add_f32 v[126:127], v[126:127], v[130:131]
    v_pk_add_f32 v[124:125], v[124:125], v[126:127]
    s_waitcnt lgkmcnt(12)
    v_pk_add_f32 v[192:193], v[192:193], v[200:201]
    v_pk_add_f32 v[194:195], v[194:195], v[202:203]
    v_pk_add_f32 v[196:197], v[196:197], v[204:205]
    v_pk_add_f32 v[198:199], v[198:199], v[206:207]
    v_pk_add_f32 v[132:133], v[132:133], v[136:137]
    v_pk_add_f32 v[134:135], v[134:135], v[138:139]
    v_pk_add_f32 v[132:133], v[132:133], v[134:135]
    s_waitcnt lgkmcnt(10)
    v_pk_add_f32 v[160:161], v[160:161], v[208:209]
    v_pk_add_f32 v[162:163], v[162:163], v[210:211]
    v_pk_add_f32 v[164:165], v[164:165], v[212:213]
    v_pk_add_f32 v[166:167], v[166:167], v[214:215]
    s_waitcnt lgkmcnt(8)
    v_pk_add_f32 v[176:177], v[176:177], v[224:225]
    v_pk_add_f32 v[178:179], v[178:179], v[226:227]
    v_pk_add_f32 v[180:181], v[180:181], v[228:229]
    v_pk_add_f32 v[182:183], v[182:183], v[230:231]
    s_waitcnt lgkmcnt(6)
    v_pk_add_f32 v[192:193], v[192:193], v[240:241]
    v_pk_add_f32 v[194:195], v[194:195], v[242:243]
    v_pk_add_f32 v[196:197], v[196:197], v[244:245]
    v_pk_add_f32 v[198:199], v[198:199], v[246:247]
    s_waitcnt lgkmcnt(4)
    v_pk_add_f32 v[160:161], v[160:161], v[216:217]
    v_pk_add_f32 v[162:163], v[162:163], v[218:219]
    v_pk_add_f32 v[164:165], v[164:165], v[220:221]
    v_pk_add_f32 v[166:167], v[166:167], v[222:223]
    s_waitcnt lgkmcnt(2)
    v_pk_add_f32 v[176:177], v[176:177], v[232:233]
    v_pk_add_f32 v[178:179], v[178:179], v[234:235]
    v_pk_add_f32 v[180:181], v[180:181], v[236:237]
    v_pk_add_f32 v[182:183], v[182:183], v[238:239]
    s_waitcnt lgkmcnt(0)
    v_pk_add_f32 v[192:193], v[192:193], v[248:249]
    v_pk_add_f32 v[194:195], v[194:195], v[250:251]
    v_pk_add_f32 v[196:197], v[196:197], v[252:253]
    v_pk_add_f32 v[198:199], v[198:199], v[254:255]
    s_mul_i32 s4, s20, 18432
    v_lshl_add_u32 v5, v2, 2, s4
    s_lshl_b32 s5, s24, 6
    s_add_u32 s4, s4, s5
    v_lshl_add_u32 v6, v3, 4, s4
    ds_write2_b32 v5, v116, v117 offset0:0 offset1:32
    ds_write2_b32 v5, v124, v125 offset0:64 offset1:96
    ds_write2_b32 v5, v132, v133 offset0:128 offset1:160
    ds_read_b128 v[208:211], v6 offset:0
    ds_read_b128 v[212:215], v6 offset:32
    ds_read_b128 v[216:219], v6 offset:128
    ds_read_b128 v[220:223], v6 offset:160
    ds_read_b128 v[224:227], v6 offset:256
    ds_read_b128 v[228:231], v6 offset:288
    ds_read_b128 v[232:235], v6 offset:384
    ds_read_b128 v[236:239], v6 offset:416
    ds_read_b128 v[240:243], v6 offset:512
    ds_read_b128 v[244:247], v6 offset:544
    ds_read_b128 v[248:251], v6 offset:640
    ds_read_b128 v[252:255], v6 offset:672
    s_waitcnt lgkmcnt(8)
    v_pk_fma_f32 v[160:161], v[160:161], v[108:109], v[216:217] op_sel:[0,1,0] op_sel_hi:[1,1,1]
    v_pk_fma_f32 v[162:163], v[162:163], v[108:109], v[218:219] op_sel:[0,1,0] op_sel_hi:[1,1,1]
    v_pk_fma_f32 v[164:165], v[164:165], v[108:109], v[220:221] op_sel:[0,1,0] op_sel_hi:[1,1,1]
    v_pk_fma_f32 v[166:167], v[166:167], v[108:109], v[222:223] op_sel:[0,1,0] op_sel_hi:[1,1,1]
    v_pk_fma_f32 v[160:161], v[208:209], v[108:109], v[160:161] op_sel:[0,0,0] op_sel_hi:[1,0,1]
    v_pk_fma_f32 v[162:163], v[210:211], v[108:109], v[162:163] op_sel:[0,0,0] op_sel_hi:[1,0,1]
    v_pk_fma_f32 v[164:165], v[212:213], v[108:109], v[164:165] op_sel:[0,0,0] op_sel_hi:[1,0,1]
    v_pk_fma_f32 v[166:167], v[214:215], v[108:109], v[166:167] op_sel:[0,0,0] op_sel_hi:[1,0,1]
    s_waitcnt lgkmcnt(4)
    v_pk_fma_f32 v[176:177], v[176:177], v[108:109], v[232:233] op_sel:[0,1,0] op_sel_hi:[1,1,1]
    v_pk_fma_f32 v[178:179], v[178:179], v[108:109], v[234:235] op_sel:[0,1,0] op_sel_hi:[1,1,1]
    v_pk_fma_f32 v[180:181], v[180:181], v[108:109], v[236:237] op_sel:[0,1,0] op_sel_hi:[1,1,1]
    v_pk_fma_f32 v[182:183], v[182:183], v[108:109], v[238:239] op_sel:[0,1,0] op_sel_hi:[1,1,1]
    v_pk_fma_f32 v[176:177], v[224:225], v[108:109], v[176:177] op_sel:[0,0,0] op_sel_hi:[1,0,1]
    v_pk_fma_f32 v[178:179], v[226:227], v[108:109], v[178:179] op_sel:[0,0,0] op_sel_hi:[1,0,1]
    v_pk_fma_f32 v[180:181], v[228:229], v[108:109], v[180:181] op_sel:[0,0,0] op_sel_hi:[1,0,1]
    v_pk_fma_f32 v[182:183], v[230:231], v[108:109], v[182:183] op_sel:[0,0,0] op_sel_hi:[1,0,1]
    s_waitcnt lgkmcnt(0)
    v_pk_fma_f32 v[192:193], v[192:193], v[108:109], v[248:249] op_sel:[0,1,0] op_sel_hi:[1,1,1]
    v_pk_fma_f32 v[194:195], v[194:195], v[108:109], v[250:251] op_sel:[0,1,0] op_sel_hi:[1,1,1]
    v_pk_fma_f32 v[196:197], v[196:197], v[108:109], v[252:253] op_sel:[0,1,0] op_sel_hi:[1,1,1]
    v_pk_fma_f32 v[198:199], v[198:199], v[108:109], v[254:255] op_sel:[0,1,0] op_sel_hi:[1,1,1]
    v_pk_fma_f32 v[192:193], v[240:241], v[108:109], v[192:193] op_sel:[0,0,0] op_sel_hi:[1,0,1]
    v_pk_fma_f32 v[194:195], v[242:243], v[108:109], v[194:195] op_sel:[0,0,0] op_sel_hi:[1,0,1]
    v_pk_fma_f32 v[196:197], v[244:245], v[108:109], v[196:197] op_sel:[0,0,0] op_sel_hi:[1,0,1]
    v_pk_fma_f32 v[198:199], v[246:247], v[108:109], v[198:199] op_sel:[0,0,0] op_sel_hi:[1,0,1]
    s_mov_b32 s6, 0xbdd2d3e8
    s_mov_b32 s7, 1.0
    v_pk_mul_f32 v[168:169], v[160:161], v[160:161]
    v_pk_mul_f32 v[170:171], v[162:163], v[162:163]
    v_pk_mul_f32 v[172:173], v[164:165], v[164:165]
    v_pk_mul_f32 v[174:175], v[166:167], v[166:167]
    v_pk_fma_f32 v[168:169], v[168:169], s[6:7], v[10:11] op_sel:[0,0,1] op_sel_hi:[1,0,1]
    v_pk_fma_f32 v[170:171], v[170:171], s[6:7], v[10:11] op_sel:[0,0,1] op_sel_hi:[1,0,1]
    v_pk_fma_f32 v[172:173], v[172:173], s[6:7], v[10:11] op_sel:[0,0,1] op_sel_hi:[1,0,1]
    v_pk_fma_f32 v[174:175], v[174:175], s[6:7], v[10:11] op_sel:[0,0,1] op_sel_hi:[1,0,1]
    v_pk_mul_f32 v[168:169], v[168:169], v[160:161]
    v_pk_mul_f32 v[170:171], v[170:171], v[162:163]
    v_pk_mul_f32 v[172:173], v[172:173], v[164:165]
    v_pk_mul_f32 v[174:175], v[174:175], v[166:167]
    v_exp_f32 v168, v168
    v_exp_f32 v169, v169
    v_exp_f32 v170, v170
    v_exp_f32 v171, v171
    v_exp_f32 v172, v172
    v_exp_f32 v173, v173
    v_exp_f32 v174, v174
    v_exp_f32 v175, v175
    v_pk_add_f32 v[168:169], v[168:169], s[6:7] op_sel:[0,1] op_sel_hi:[1,1]
    v_pk_add_f32 v[170:171], v[170:171], s[6:7] op_sel:[0,1] op_sel_hi:[1,1]
    v_pk_add_f32 v[172:173], v[172:173], s[6:7] op_sel:[0,1] op_sel_hi:[1,1]
    v_pk_add_f32 v[174:175], v[174:175], s[6:7] op_sel:[0,1] op_sel_hi:[1,1]
    v_rcp_f32 v168, v168
    v_rcp_f32 v169, v169
    v_rcp_f32 v170, v170
    v_rcp_f32 v171, v171
    v_rcp_f32 v172, v172
    v_rcp_f32 v173, v173
    v_rcp_f32 v174, v174
    v_rcp_f32 v175, v175
    s_nop 0
    v_pk_mul_f32 v[160:161], v[168:169], v[160:161]
    v_pk_mul_f32 v[162:163], v[170:171], v[162:163]
    v_pk_mul_f32 v[164:165], v[172:173], v[164:165]
    v_pk_mul_f32 v[166:167], v[174:175], v[166:167]
    v_pk_mul_f32 v[184:185], v[176:177], v[176:177]
    v_pk_mul_f32 v[186:187], v[178:179], v[178:179]
    v_pk_mul_f32 v[188:189], v[180:181], v[180:181]
    v_pk_mul_f32 v[190:191], v[182:183], v[182:183]
    v_pk_fma_f32 v[184:185], v[184:185], s[6:7], v[10:11] op_sel:[0,0,1] op_sel_hi:[1,0,1]
    v_pk_fma_f32 v[186:187], v[186:187], s[6:7], v[10:11] op_sel:[0,0,1] op_sel_hi:[1,0,1]
    v_pk_fma_f32 v[188:189], v[188:189], s[6:7], v[10:11] op_sel:[0,0,1] op_sel_hi:[1,0,1]
    v_pk_fma_f32 v[190:191], v[190:191], s[6:7], v[10:11] op_sel:[0,0,1] op_sel_hi:[1,0,1]
    v_pk_mul_f32 v[184:185], v[184:185], v[176:177]
    v_pk_mul_f32 v[186:187], v[186:187], v[178:179]
    v_pk_mul_f32 v[188:189], v[188:189], v[180:181]
    v_pk_mul_f32 v[190:191], v[190:191], v[182:183]
    v_exp_f32 v184, v184
    v_exp_f32 v185, v185
    v_exp_f32 v186, v186
    v_exp_f32 v187, v187
    v_exp_f32 v188, v188
    v_exp_f32 v189, v189
    v_exp_f32 v190, v190
    v_exp_f32 v191, v191
    v_pk_add_f32 v[184:185], v[184:185], s[6:7] op_sel:[0,1] op_sel_hi:[1,1]
    v_pk_add_f32 v[186:187], v[186:187], s[6:7] op_sel:[0,1] op_sel_hi:[1,1]
    v_pk_add_f32 v[188:189], v[188:189], s[6:7] op_sel:[0,1] op_sel_hi:[1,1]
    v_pk_add_f32 v[190:191], v[190:191], s[6:7] op_sel:[0,1] op_sel_hi:[1,1]
    v_rcp_f32 v184, v184
    v_rcp_f32 v185, v185
    v_rcp_f32 v186, v186
    v_rcp_f32 v187, v187
    v_rcp_f32 v188, v188
    v_rcp_f32 v189, v189
    v_rcp_f32 v190, v190
    v_rcp_f32 v191, v191
    s_nop 0
    v_pk_mul_f32 v[176:177], v[184:185], v[176:177]
    v_pk_mul_f32 v[178:179], v[186:187], v[178:179]
    v_pk_mul_f32 v[180:181], v[188:189], v[180:181]
    v_pk_mul_f32 v[182:183], v[190:191], v[182:183]
    v_pk_mul_f32 v[200:201], v[192:193], v[192:193]
    v_pk_mul_f32 v[202:203], v[194:195], v[194:195]
    v_pk_mul_f32 v[204:205], v[196:197], v[196:197]
    v_pk_mul_f32 v[206:207], v[198:199], v[198:199]
    v_pk_fma_f32 v[200:201], v[200:201], s[6:7], v[10:11] op_sel:[0,0,1] op_sel_hi:[1,0,1]
    v_pk_fma_f32 v[202:203], v[202:203], s[6:7], v[10:11] op_sel:[0,0,1] op_sel_hi:[1,0,1]
    v_pk_fma_f32 v[204:205], v[204:205], s[6:7], v[10:11] op_sel:[0,0,1] op_sel_hi:[1,0,1]
    v_pk_fma_f32 v[206:207], v[206:207], s[6:7], v[10:11] op_sel:[0,0,1] op_sel_hi:[1,0,1]
    v_pk_mul_f32 v[200:201], v[200:201], v[192:193]
    v_pk_mul_f32 v[202:203], v[202:203], v[194:195]
    v_pk_mul_f32 v[204:205], v[204:205], v[196:197]
    v_pk_mul_f32 v[206:207], v[206:207], v[198:199]
    v_exp_f32 v200, v200
    v_exp_f32 v201, v201
    v_exp_f32 v202, v202
    v_exp_f32 v203, v203
    v_exp_f32 v204, v204
    v_exp_f32 v205, v205
    v_exp_f32 v206, v206
    v_exp_f32 v207, v207
    v_pk_add_f32 v[200:201], v[200:201], s[6:7] op_sel:[0,1] op_sel_hi:[1,1]
    v_pk_add_f32 v[202:203], v[202:203], s[6:7] op_sel:[0,1] op_sel_hi:[1,1]
    v_pk_add_f32 v[204:205], v[204:205], s[6:7] op_sel:[0,1] op_sel_hi:[1,1]
    v_pk_add_f32 v[206:207], v[206:207], s[6:7] op_sel:[0,1] op_sel_hi:[1,1]
    v_rcp_f32 v200, v200
    v_rcp_f32 v201, v201
    v_rcp_f32 v202, v202
    v_rcp_f32 v203, v203
    v_rcp_f32 v204, v204
    v_rcp_f32 v205, v205
    v_rcp_f32 v206, v206
    v_rcp_f32 v207, v207
    s_nop 0
    v_pk_mul_f32 v[192:193], v[200:201], v[192:193]
    v_pk_mul_f32 v[194:195], v[202:203], v[194:195]
    v_pk_mul_f32 v[196:197], v[204:205], v[196:197]
    v_pk_mul_f32 v[198:199], v[206:207], v[198:199]
    s_mul_i32 s4, s23, 6144
    s_lshl_b32 s5, s24, 10
    s_add_u32 s4, s4, s5
    s_add_u32 s4, s4, 147456
    v_add_u32 v4, s4, v12
    v_cvt_pk_bf16_f32 v168, v160, v161
    v_cvt_pk_bf16_f32 v169, v162, v163
    v_cvt_pk_bf16_f32 v170, v164, v165
    v_cvt_pk_bf16_f32 v171, v166, v167
    ds_write_b128 v4, v[168:171] offset:0
    v_cvt_pk_bf16_f32 v184, v176, v177
    v_cvt_pk_bf16_f32 v185, v178, v179
    v_cvt_pk_bf16_f32 v186, v180, v181
    v_cvt_pk_bf16_f32 v187, v182, v183
    ds_write_b128 v4, v[184:187] offset:2048
    v_cvt_pk_bf16_f32 v200, v192, v193
    v_cvt_pk_bf16_f32 v201, v194, v195
    v_cvt_pk_bf16_f32 v202, v196, v197
    v_cvt_pk_bf16_f32 v203, v198, v199
    ds_write_b128 v4, v[200:203] offset:4096
L_kva_tj19:
    v_lshlrev_b32 v4, 14, v0
    v_mov_b32 v6, 0x7f000000
    v_cmp_gt_u32 vcc, 4, v0
    s_lshl_b32 s4, s20, 16
    s_lshl_b32 s5, s17, 11
    s_add_u32 s4, s4, s5
    s_add_u32 s41, s4, 0x20080
    v_cndmask_b32 v4, v6, v4, vcc
    v_cndmask_b32 v5, 0, 1, vcc
    s_lshl_b32 s4, s23, 8
    s_lshl_b32 s5, s24, 7
    s_add_u32 s4, s4, s5
    v_xor_b32 v10, s4, v12
    s_waitcnt vmcnt(0)
    s_sleep 2
    s_add_u32 s4, s74, 0
    buffer_load_dwordx4 v[108:111], v10, s[8:11], s4 offen offset:0 sc1
    buffer_load_dwordx4 v[112:115], v10, s[8:11], s4 offen offset:1024 sc1
    buffer_load_dwordx4 v[116:119], v10, s[8:11], s4 offen offset:2048 sc1
    s_add_u32 s4, s74, 3072
    buffer_load_dwordx4 v[120:123], v10, s[8:11], s4 offen offset:0 sc1
    buffer_load_dwordx4 v[124:127], v10, s[8:11], s4 offen offset:1024 sc1
    buffer_load_dwordx4 v[128:131], v10, s[8:11], s4 offen offset:2048 sc1
    s_add_u32 s4, s74, 6144
    buffer_load_dwordx4 v[132:135], v10, s[8:11], s4 offen offset:0 sc1
    buffer_load_dwordx4 v[136:139], v10, s[8:11], s4 offen offset:1024 sc1
    buffer_load_dwordx4 v[140:143], v10, s[8:11], s4 offen offset:2048 sc1
    s_add_u32 s4, s74, 9216
    buffer_load_dwordx4 v[144:147], v10, s[8:11], s4 offen offset:0 sc1
    buffer_load_dwordx4 v[148:151], v10, s[8:11], s4 offen offset:1024 sc1
    buffer_load_dwordx4 v[152:155], v10, s[8:11], s4 offen offset:2048 sc1
    s_lshl_b32 s4, s24, 8
    v_xor_b32 v4, s4, v12
    s_lshl_b32 s4, s23, 10
    v_add_u32 v1, s4, v4
    s_xor_b32 s4, s4, 1024
    v_add_u32 v11, s4, v4
    s_mul_i32 s4, s17, 43
    s_add_u32 s4, s4, s20
    s_lshl_b32 s4, s4, 11
    s_add_u32 s4, s4, 0x3600000
    s_mul_i32 s5, s16, 96
    s_add_u32 s5, s5, s20
    s_lshl_b32 s5, s5, 10
    s_add_u32 s5, s5, 0x5400000
    s_add_u32 s32, s4, 0
    s_add_u32 s44, s5, 0
    s_add_u32 s33, s4, 16384
    s_add_u32 s45, s5, 8192
    s_add_u32 s34, s4, 32768
    s_add_u32 s46, s5, 16384
    s_add_u32 s35, s4, 49152
    s_add_u32 s47, s5, 24576
    s_add_u32 s36, s4, 65536
    s_add_u32 s28, s5, 32768
    s_add_u32 s37, s4, 81920
    s_add_u32 s29, s5, 40960
    s_cmp_lt_u32 s20, 3
    s_cselect_b32 s37, s37, 0x7f000000
    s_cselect_b32 s29, s29, 0x7f000000
    s_mov_b32 s48, s82
    s_mov_b32 s49, s83
    s_mov_b32 s50, 0x1000
    s_mov_b32 s51, 0x00020000
    s_waitcnt vmcnt(9)
    v_max3_u32 v6, v108, v109, v110
    v_max3_u32 v6, v6, v111, v112
    v_max3_u32 v6, v6, v113, v114
    v_max3_u32 v6, v6, v115, v116
    v_max3_u32 v6, v6, v117, v118
    v_max_u32 v6, v6, v119
    v_cmp_eq_u32 vcc, -1, v6
    s_nop 3
    s_cbranch_vccnz L_kva_tv76
L_kva_tw77:
    v_mfma_f32_32x32x16_bf16 v[160:175], v[108:111], v[20:23], 0
    v_mfma_f32_32x32x16_bf16 v[176:191], v[112:115], v[20:23], 0
    v_mfma_f32_32x32x16_bf16 v[192:207], v[116:119], v[20:23], 0
    v_mfma_f32_32x32x16_bf16 v[208:223], v[108:111], v[24:27], 0
    v_mfma_f32_32x32x16_bf16 v[224:239], v[112:115], v[24:27], 0
    v_mfma_f32_32x32x16_bf16 v[240:255], v[116:119], v[24:27], 0
    s_add_u32 s4, s75, 0
    buffer_load_dwordx4 v[108:111], v10, s[8:11], s4 offen offset:0 sc1
    buffer_load_dwordx4 v[112:115], v10, s[8:11], s4 offen offset:1024 sc1
    buffer_load_dwordx4 v[116:119], v10, s[8:11], s4 offen offset:2048 sc1
    buffer_load_dwordx4 v[20:23], v8, s[8:11], s72 offen offset:3072 sc1
    buffer_load_dwordx4 v[24:27], v9, s[8:11], s72 offen offset:3072 sc1
    s_waitcnt vmcnt(11)
    v_max3_u32 v6, v120, v121, v122
    v_max3_u32 v6, v6, v123, v124
    v_max3_u32 v6, v6, v125, v126
    v_max3_u32 v6, v6, v127, v128
    v_max3_u32 v6, v6, v129, v130
    v_max_u32 v6, v6, v131
    v_cmp_eq_u32 vcc, -1, v6
    s_nop 3
    s_cbranch_vccnz L_kva_tv79
L_kva_tw80:
    v_mfma_f32_32x32x16_bf16 v[160:175], v[120:123], v[28:31], v[160:175]
    v_mfma_f32_32x32x16_bf16 v[176:191], v[124:127], v[28:31], v[176:191]
    v_mfma_f32_32x32x16_bf16 v[192:207], v[128:131], v[28:31], v[192:207]
    v_mfma_f32_32x32x16_bf16 v[208:223], v[120:123], v[32:35], v[208:223]
    v_mfma_f32_32x32x16_bf16 v[224:239], v[124:127], v[32:35], v[224:239]
    v_mfma_f32_32x32x16_bf16 v[240:255], v[128:131], v[32:35], v[240:255]
    s_add_u32 s4, s75, 3072
    buffer_load_dwordx4 v[120:123], v10, s[8:11], s4 offen offset:0 sc1
    buffer_load_dwordx4 v[124:127], v10, s[8:11], s4 offen offset:1024 sc1
    buffer_load_dwordx4 v[128:131], v10, s[8:11], s4 offen offset:2048 sc1
    buffer_load_dwordx4 v[28:31], v8, s[8:11], s73 offen offset:0 sc1
    buffer_load_dwordx4 v[32:35], v9, s[8:11], s73 offen offset:0 sc1
    s_waitcnt vmcnt(13)
    v_max3_u32 v6, v132, v133, v134
    v_max3_u32 v6, v6, v135, v136
    v_max3_u32 v6, v6, v137, v138
    v_max3_u32 v6, v6, v139, v140
    v_max3_u32 v6, v6, v141, v142
    v_max_u32 v6, v6, v143
    v_cmp_eq_u32 vcc, -1, v6
    s_nop 3
    s_cbranch_vccnz L_kva_tv82
L_kva_tw83:
    v_mfma_f32_32x32x16_bf16 v[160:175], v[132:135], v[36:39], v[160:175]
    v_mfma_f32_32x32x16_bf16 v[176:191], v[136:139], v[36:39], v[176:191]
    v_mfma_f32_32x32x16_bf16 v[192:207], v[140:143], v[36:39], v[192:207]
    v_mfma_f32_32x32x16_bf16 v[208:223], v[132:135], v[40:43], v[208:223]
    v_mfma_f32_32x32x16_bf16 v[224:239], v[136:139], v[40:43], v[224:239]
    v_mfma_f32_32x32x16_bf16 v[240:255], v[140:143], v[40:43], v[240:255]
    s_add_u32 s4, s75, 6144
    buffer_load_dwordx4 v[132:135], v10, s[8:11], s4 offen offset:0 sc1
    buffer_load_dwordx4 v[136:139], v10, s[8:11], s4 offen offset:1024 sc1
    buffer_load_dwordx4 v[140:143], v10, s[8:11], s4 offen offset:2048 sc1
    buffer_load_dwordx4 v[36:39], v8, s[8:11], s73 offen offset:1024 sc1
    buffer_load_dwordx4 v[40:43], v9, s[8:11], s73 offen offset:1024 sc1
    s_waitcnt vmcnt(15)
    v_max3_u32 v6, v144, v145, v146
    v_max3_u32 v6, v6, v147, v148
    v_max3_u32 v6, v6, v149, v150
    v_max3_u32 v6, v6, v151, v152
    v_max3_u32 v6, v6, v153, v154
    v_max_u32 v6, v6, v155
    v_cmp_eq_u32 vcc, -1, v6
    s_nop 3
    s_cbranch_vccnz L_kva_tv85
L_kva_tw86:
    v_mfma_f32_32x32x16_bf16 v[160:175], v[144:147], v[44:47], v[160:175]
    v_mfma_f32_32x32x16_bf16 v[176:191], v[148:151], v[44:47], v[176:191]
    v_mfma_f32_32x32x16_bf16 v[192:207], v[152:155], v[44:47], v[192:207]
    v_mfma_f32_32x32x16_bf16 v[208:223], v[144:147], v[48:51], v[208:223]
    v_mfma_f32_32x32x16_bf16 v[224:239], v[148:151], v[48:51], v[224:239]
    v_mfma_f32_32x32x16_bf16 v[240:255], v[152:155], v[48:51], v[240:255]
    s_add_u32 s4, s75, 9216
    buffer_load_dwordx4 v[144:147], v10, s[8:11], s4 offen offset:0 sc1
    buffer_load_dwordx4 v[148:151], v10, s[8:11], s4 offen offset:1024 sc1
    buffer_load_dwordx4 v[152:155], v10, s[8:11], s4 offen offset:2048 sc1
    buffer_load_dwordx4 v[44:47], v8, s[8:11], s73 offen offset:2048 sc1
    buffer_load_dwordx4 v[48:51], v9, s[8:11], s73 offen offset:2048 sc1
    s_waitcnt vmcnt(17)
    v_max3_u32 v6, v108, v109, v110
    v_max3_u32 v6, v6, v111, v112
    v_max3_u32 v6, v6, v113, v114
    v_max3_u32 v6, v6, v115, v116
    v_max3_u32 v6, v6, v117, v118
    v_max_u32 v6, v6, v119
    v_cmp_eq_u32 vcc, -1, v6
    s_nop 3
    s_cbranch_vccnz L_kva_tv88
L_kva_tw89:
    v_mfma_f32_32x32x16_bf16 v[160:175], v[108:111], v[52:55], v[160:175]
    v_mfma_f32_32x32x16_bf16 v[176:191], v[112:115], v[52:55], v[176:191]
    v_mfma_f32_32x32x16_bf16 v[192:207], v[116:119], v[52:55], v[192:207]
    v_mfma_f32_32x32x16_bf16 v[208:223], v[108:111], v[56:59], v[208:223]
    v_mfma_f32_32x32x16_bf16 v[224:239], v[112:115], v[56:59], v[224:239]
    v_mfma_f32_32x32x16_bf16 v[240:255], v[116:119], v[56:59], v[240:255]
    s_add_u32 s4, s76, 0
    buffer_load_dwordx4 v[108:111], v10, s[8:11], s4 offen offset:0 sc1
    buffer_load_dwordx4 v[112:115], v10, s[8:11], s4 offen offset:1024 sc1
    buffer_load_dwordx4 v[116:119], v10, s[8:11], s4 offen offset:2048 sc1
    buffer_load_dwordx4 v[52:55], v8, s[8:11], s73 offen offset:3072 sc1
    buffer_load_dwordx4 v[56:59], v9, s[8:11], s73 offen offset:3072 sc1
    s_waitcnt vmcnt(17)
    v_max3_u32 v6, v120, v121, v122
    v_max3_u32 v6, v6, v123, v124
    v_max3_u32 v6, v6, v125, v126
    v_max3_u32 v6, v6, v127, v128
    v_max3_u32 v6, v6, v129, v130
    v_max_u32 v6, v6, v131
    v_cmp_eq_u32 vcc, -1, v6
    s_nop 3
    s_cbranch_vccnz L_kva_tv91
L_kva_tw92:
    v_mfma_f32_32x32x16_bf16 v[160:175], v[120:123], v[60:63], v[160:175]
    v_mfma_f32_32x32x16_bf16 v[176:191], v[124:127], v[60:63], v[176:191]
    v_mfma_f32_32x32x16_bf16 v[192:207], v[128:131], v[60:63], v[192:207]
    v_mfma_f32_32x32x16_bf16 v[208:223], v[120:123], v[64:67], v[208:223]
    v_mfma_f32_32x32x16_bf16 v[224:239], v[124:127], v[64:67], v[224:239]
    v_mfma_f32_32x32x16_bf16 v[240:255], v[128:131], v[64:67], v[240:255]
    s_add_u32 s4, s76, 3072
    buffer_load_dwordx4 v[120:123], v10, s[8:11], s4 offen offset:0 sc1
    buffer_load_dwordx4 v[124:127], v10, s[8:11], s4 offen offset:1024 sc1
    buffer_load_dwordx4 v[128:131], v10, s[8:11], s4 offen offset:2048 sc1
    s_waitcnt vmcnt(15)
    v_max3_u32 v6, v132, v133, v134
    v_max3_u32 v6, v6, v135, v136
    v_max3_u32 v6, v6, v137, v138
    v_max3_u32 v6, v6, v139, v140
    v_max3_u32 v6, v6, v141, v142
    v_max_u32 v6, v6, v143
    v_cmp_eq_u32 vcc, -1, v6
    s_nop 3
    s_cbranch_vccnz L_kva_tv94
L_kva_tw95:
    v_mfma_f32_32x32x16_bf16 v[160:175], v[132:135], v[68:71], v[160:175]
    v_mfma_f32_32x32x16_bf16 v[176:191], v[136:139], v[68:71], v[176:191]
    v_mfma_f32_32x32x16_bf16 v[192:207], v[140:143], v[68:71], v[192:207]
    v_mfma_f32_32x32x16_bf16 v[208:223], v[132:135], v[72:75], v[208:223]
    v_mfma_f32_32x32x16_bf16 v[224:239], v[136:139], v[72:75], v[224:239]
    v_mfma_f32_32x32x16_bf16 v[240:255], v[140:143], v[72:75], v[240:255]
    s_add_u32 s4, s76, 6144
    buffer_load_dwordx4 v[132:135], v10, s[8:11], s4 offen offset:0 sc1
    buffer_load_dwordx4 v[136:139], v10, s[8:11], s4 offen offset:1024 sc1
    buffer_load_dwordx4 v[140:143], v10, s[8:11], s4 offen offset:2048 sc1
    s_waitcnt vmcnt(13)
    v_max3_u32 v6, v144, v145, v146
    v_max3_u32 v6, v6, v147, v148
    v_max3_u32 v6, v6, v149, v150
    v_max3_u32 v6, v6, v151, v152
    v_max3_u32 v6, v6, v153, v154
    v_max_u32 v6, v6, v155
    v_cmp_eq_u32 vcc, -1, v6
    s_nop 3
    s_cbranch_vccnz L_kva_tv97
L_kva_tw98:
    v_mfma_f32_32x32x16_bf16 v[160:175], v[144:147], v[76:79], v[160:175]
    v_mfma_f32_32x32x16_bf16 v[176:191], v[148:151], v[76:79], v[176:191]
    v_mfma_f32_32x32x16_bf16 v[192:207], v[152:155], v[76:79], v[192:207]
    v_mfma_f32_32x32x16_bf16 v[208:223], v[144:147], v[80:83], v[208:223]
    v_mfma_f32_32x32x16_bf16 v[224:239], v[148:151], v[80:83], v[224:239]
    v_mfma_f32_32x32x16_bf16 v[240:255], v[152:155], v[80:83], v[240:255]
    s_add_u32 s4, s76, 9216
    buffer_load_dwordx4 v[144:147], v10, s[8:11], s4 offen offset:0 sc1
    buffer_load_dwordx4 v[148:151], v10, s[8:11], s4 offen offset:1024 sc1
    buffer_load_dwordx4 v[152:155], v10, s[8:11], s4 offen offset:2048 sc1
    s_waitcnt vmcnt(11)
    v_max3_u32 v6, v108, v109, v110
    v_max3_u32 v6, v6, v111, v112
    v_max3_u32 v6, v6, v113, v114
    v_max3_u32 v6, v6, v115, v116
    v_max3_u32 v6, v6, v117, v118
    v_max_u32 v6, v6, v119
    v_cmp_eq_u32 vcc, -1, v6
    s_nop 3
    s_cbranch_vccnz L_kva_tv100
L_kva_tw101:
    v_mfma_f32_32x32x16_bf16 v[160:175], v[108:111], v[84:87], v[160:175]
    v_mfma_f32_32x32x16_bf16 v[176:191], v[112:115], v[84:87], v[176:191]
    v_mfma_f32_32x32x16_bf16 v[192:207], v[116:119], v[84:87], v[192:207]
    v_mfma_f32_32x32x16_bf16 v[208:223], v[108:111], v[88:91], v[208:223]
    v_mfma_f32_32x32x16_bf16 v[224:239], v[112:115], v[88:91], v[224:239]
    v_mfma_f32_32x32x16_bf16 v[240:255], v[116:119], v[88:91], v[240:255]
    s_add_u32 s4, s77, 0
    buffer_load_dwordx4 v[108:111], v10, s[8:11], s4 offen offset:0 sc1
    buffer_load_dwordx4 v[112:115], v10, s[8:11], s4 offen offset:1024 sc1
    buffer_load_dwordx4 v[116:119], v10, s[8:11], s4 offen offset:2048 sc1
    s_waitcnt vmcnt(9)
    v_max3_u32 v6, v120, v121, v122
    v_max3_u32 v6, v6, v123, v124
    v_max3_u32 v6, v6, v125, v126
    v_max3_u32 v6, v6, v127, v128
    v_max3_u32 v6, v6, v129, v130
    v_max_u32 v6, v6, v131
    v_cmp_eq_u32 vcc, -1, v6
    s_nop 3
    s_cbranch_vccnz L_kva_tv103
L_kva_tw104:
    v_mfma_f32_32x32x16_bf16 v[160:175], v[120:123], v[92:95], v[160:175]
    v_mfma_f32_32x32x16_bf16 v[176:191], v[124:127], v[92:95], v[176:191]
    v_mfma_f32_32x32x16_bf16 v[192:207], v[128:131], v[92:95], v[192:207]
    v_mfma_f32_32x32x16_bf16 v[208:223], v[120:123], v[96:99], v[208:223]
    v_mfma_f32_32x32x16_bf16 v[224:239], v[124:127], v[96:99], v[224:239]
    v_mfma_f32_32x32x16_bf16 v[240:255], v[128:131], v[96:99], v[240:255]
    s_add_u32 s4, s77, 3072
    buffer_load_dwordx4 v[120:123], v10, s[8:11], s4 offen offset:0 sc1
    buffer_load_dwordx4 v[124:127], v10, s[8:11], s4 offen offset:1024 sc1
    buffer_load_dwordx4 v[128:131], v10, s[8:11], s4 offen offset:2048 sc1
    s_waitcnt vmcnt(9)
    v_max3_u32 v6, v132, v133, v134
    v_max3_u32 v6, v6, v135, v136
    v_max3_u32 v6, v6, v137, v138
    v_max3_u32 v6, v6, v139, v140
    v_max3_u32 v6, v6, v141, v142
    v_max_u32 v6, v6, v143
    v_cmp_eq_u32 vcc, -1, v6
    s_nop 3
    s_cbranch_vccnz L_kva_tv106
L_kva_tw107:
    v_mfma_f32_32x32x16_bf16 v[160:175], v[132:135], v[100:103], v[160:175]
    v_mfma_f32_32x32x16_bf16 v[176:191], v[136:139], v[100:103], v[176:191]
    v_mfma_f32_32x32x16_bf16 v[192:207], v[140:143], v[100:103], v[192:207]
    v_mfma_f32_32x32x16_bf16 v[208:223], v[132:135], v[104:107], v[208:223]
    v_mfma_f32_32x32x16_bf16 v[224:239], v[136:139], v[104:107], v[224:239]
    v_mfma_f32_32x32x16_bf16 v[240:255], v[140:143], v[104:107], v[240:255]
    s_add_u32 s4, s77, 6144
    buffer_load_dwordx4 v[132:135], v10, s[8:11], s4 offen offset:0 sc1
    buffer_load_dwordx4 v[136:139], v10, s[8:11], s4 offen offset:1024 sc1
    buffer_load_dwordx4 v[140:143], v10, s[8:11], s4 offen offset:2048 sc1
    s_waitcnt vmcnt(9)
    v_max3_u32 v6, v144, v145, v146
    v_max3_u32 v6, v6, v147, v148
    v_max3_u32 v6, v6, v149, v150
    v_max3_u32 v6, v6, v151, v152
    v_max3_u32 v6, v6, v153, v154
    v_max_u32 v6, v6, v155
    v_cmp_eq_u32 vcc, -1, v6
    s_nop 3
    s_cbranch_vccnz L_kva_tv109
L_kva_tw110:
    v_mfma_f32_32x32x16_bf16 v[160:175], v[144:147], v[20:23], v[160:175]
    v_mfma_f32_32x32x16_bf16 v[176:191], v[148:151], v[20:23], v[176:191]
    v_mfma_f32_32x32x16_bf16 v[192:207], v[152:155], v[20:23], v[192:207]
    v_mfma_f32_32x32x16_bf16 v[208:223], v[144:147], v[24:27], v[208:223]
    v_mfma_f32_32x32x16_bf16 v[224:239], v[148:151], v[24:27], v[224:239]
    v_mfma_f32_32x32x16_bf16 v[240:255], v[152:155], v[24:27], v[240:255]
    s_add_u32 s4, s77, 9216
    buffer_load_dwordx4 v[144:147], v10, s[8:11], s4 offen offset:0 sc1
    buffer_load_dwordx4 v[148:151], v10, s[8:11], s4 offen offset:1024 sc1
    buffer_load_dwordx4 v[152:155], v10, s[8:11], s4 offen offset:2048 sc1
    s_waitcnt vmcnt(9)
    v_max3_u32 v6, v108, v109, v110
    v_max3_u32 v6, v6, v111, v112
    v_max3_u32 v6, v6, v113, v114
    v_max3_u32 v6, v6, v115, v116
    v_max3_u32 v6, v6, v117, v118
    v_max_u32 v6, v6, v119
    v_cmp_eq_u32 vcc, -1, v6
    s_nop 3
    s_cbranch_vccnz L_kva_tv112
L_kva_tw113:
    v_mfma_f32_32x32x16_bf16 v[160:175], v[108:111], v[28:31], v[160:175]
    v_mfma_f32_32x32x16_bf16 v[176:191], v[112:115], v[28:31], v[176:191]
    v_mfma_f32_32x32x16_bf16 v[192:207], v[116:119], v[28:31], v[192:207]
    v_mfma_f32_32x32x16_bf16 v[208:223], v[108:111], v[32:35], v[208:223]
    v_mfma_f32_32x32x16_bf16 v[224:239], v[112:115], v[32:35], v[224:239]
    v_mfma_f32_32x32x16_bf16 v[240:255], v[116:119], v[32:35], v[240:255]
    s_waitcnt vmcnt(6)
    v_max3_u32 v6, v120, v121, v122
    v_max3_u32 v6, v6, v123, v124
    v_max3_u32 v6, v6, v125, v126
    v_max3_u32 v6, v6, v127, v128
    v_max3_u32 v6, v6, v129, v130
    v_max_u32 v6, v6, v131
    v_cmp_eq_u32 vcc, -1, v6
    s_nop 3
    s_cbranch_vccnz L_kva_tv115
L_kva_tw116:
    v_mfma_f32_32x32x16_bf16 v[160:175], v[120:123], v[36:39], v[160:175]
    v_mfma_f32_32x32x16_bf16 v[176:191], v[124:127], v[36:39], v[176:191]
    v_mfma_f32_32x32x16_bf16 v[192:207], v[128:131], v[36:39], v[192:207]
    v_mfma_f32_32x32x16_bf16 v[208:223], v[120:123], v[40:43], v[208:223]
    v_mfma_f32_32x32x16_bf16 v[224:239], v[124:127], v[40:43], v[224:239]
    v_mfma_f32_32x32x16_bf16 v[240:255], v[128:131], v[40:43], v[240:255]
    s_waitcnt vmcnt(3)
    v_max3_u32 v6, v132, v133, v134
    v_max3_u32 v6, v6, v135, v136
    v_max3_u32 v6, v6, v137, v138
    v_max3_u32 v6, v6, v139, v140
    v_max3_u32 v6, v6, v141, v142
    v_max_u32 v6, v6, v143
    v_cmp_eq_u32 vcc, -1, v6
    s_nop 3
    s_cbranch_vccnz L_kva_tv118
L_kva_tw119:
    v_mfma_f32_32x32x16_bf16 v[160:175], v[132:135], v[44:47], v[160:175]
    v_mfma_f32_32x32x16_bf16 v[176:191], v[136:139], v[44:47], v[176:191]
    v_mfma_f32_32x32x16_bf16 v[192:207], v[140:143], v[44:47], v[192:207]
    v_mfma_f32_32x32x16_bf16 v[208:223], v[132:135], v[48:51], v[208:223]
    v_mfma_f32_32x32x16_bf16 v[224:239], v[136:139], v[48:51], v[224:239]
    v_mfma_f32_32x32x16_bf16 v[240:255], v[140:143], v[48:51], v[240:255]
    s_waitcnt vmcnt(0)
    v_max3_u32 v6, v144, v145, v146
    v_max3_u32 v6, v6, v147, v148
    v_max3_u32 v6, v6, v149, v150
    v_max3_u32 v6, v6, v151, v152
    v_max3_u32 v6, v6, v153, v154
    v_max_u32 v6, v6, v155
    v_cmp_eq_u32 vcc, -1, v6
    s_nop 3
    s_cbranch_vccnz L_kva_tv121
L_kva_tw122:
    v_mfma_f32_32x32x16_bf16 v[160:175], v[144:147], v[52:55], v[160:175]
    v_mfma_f32_32x32x16_bf16 v[176:191], v[148:151], v[52:55], v[176:191]
    v_mfma_f32_32x32x16_bf16 v[192:207], v[152:155], v[52:55], v[192:207]
    v_mfma_f32_32x32x16_bf16 v[208:223], v[144:147], v[56:59], v[208:223]
    v_mfma_f32_32x32x16_bf16 v[224:239], v[148:151], v[56:59], v[224:239]
    v_mfma_f32_32x32x16_bf16 v[240:255], v[152:155], v[56:59], v[240:255]
    s_lshr_b32 s4, s27, 9
    s_and_b32 s4, s4, 0xffffffc0
    v_lshlrev_b32 v4, 1, v2
    buffer_load_ushort v124, v4, s[48:51], s4 offen
    s_add_u32 s4, s40, 10240
    buffer_load_dwordx4 v[116:119], v14, s[56:59], s4 offen sc1
    buffer_load_dwordx4 v[120:123], v14, s[56:59], s4 offen offset:16 sc1
    s_mul_i32 s4, s20, 18432
    v_add_u32 v4, s4, v12
    s_xor_b32 s5, s20, 4
    s_mul_i32 s4, s5, 18432
    v_add_u32 v5, s4, v12
    s_nop 4
    s_nop 7
    ds_write_b128 v4, v[208:211] offset:0
    ds_write_b128 v4, v[212:215] offset:1024
    ds_write_b128 v4, v[216:219] offset:2048
    ds_write_b128 v4, v[220:223] offset:3072
    ds_write_b128 v4, v[224:227] offset:4096
    ds_write_b128 v4, v[228:231] offset:5120
    ds_write_b128 v4, v[232:235] offset:6144
    ds_write_b128 v4, v[236:239] offset:7168
    ds_write_b128 v4, v[240:243] offset:8192
    ds_write_b128 v4, v[244:247] offset:9216
    ds_write_b128 v4, v[248:251] offset:10240
    ds_write_b128 v4, v[252:255] offset:11264
    s_xor_b32 s4, s5, 1
    s_mul_i32 s4, s4, 18432
    v_add_u32 v8, s4, v12
    s_xor_b32 s4, s5, 2
    s_mul_i32 s4, s4, 18432
    v_add_u32 v9, s4, v12
    s_xor_b32 s4, s5, 3
    s_mul_i32 s4, s4, 18432
    v_add_u32 v10, s4, v12
    s_mul_i32 s4, s22, 6144
    s_lshl_b32 s6, s23, 10
    s_add_u32 s4, s4, s6
    s_lshl_b32 s6, s24, 3
    s_add_u32 s4, s4, s6
    s_add_u32 s4, s4, 147456
    v_add_u32 v6, s4, v12
    s_waitcnt lgkmcnt(0)
    s_barrier
    ds_read_b128 v[212:215], v5 offset:1024
    ds_read_b128 v[228:231], v5 offset:5120
    ds_read_b128 v[244:247], v5 offset:9216
    ds_read_b128 v[216:219], v5 offset:2048
    ds_read_b128 v[232:235], v5 offset:6144
    ds_read_b128 v[248:251], v5 offset:10240
    ds_read_b128 v[220:223], v5 offset:3072
    ds_read_b128 v[236:239], v5 offset:7168
    ds_read_b128 v[252:255], v5 offset:11264
    ds_read_b128 v[208:211], v5 offset:0
    ds_read_b128 v[224:227], v5 offset:4096
    ds_read_b128 v[240:243], v5 offset:8192
    buffer_load_dwordx4 v[20:23], v1, s[8:11], s32 offen sc1
    buffer_load_dwordx4 v[24:27], v11, s[8:11], s32 offen sc1
    buffer_load_dwordx4 v[28:31], v1, s[8:11], s33 offen sc1
    buffer_load_dwordx4 v[32:35], v11, s[8:11], s33 offen sc1
    buffer_load_dwordx4 v[36:39], v1, s[8:11], s34 offen sc1
    buffer_load_dwordx4 v[40:43], v11, s[8:11], s34 offen sc1
    buffer_load_dwordx4 v[44:47], v1, s[8:11], s35 offen sc1
    buffer_load_dwordx4 v[48:51], v11, s[8:11], s35 offen sc1
    buffer_load_dwordx4 v[52:55], v1, s[8:11], s36 offen sc1
    buffer_load_dwordx4 v[56:59], v11, s[8:11], s36 offen sc1
    buffer_load_dwordx4 v[60:63], v1, s[8:11], s37 offen sc1
    buffer_load_dwordx4 v[64:67], v11, s[8:11], s37 offen sc1
    s_waitcnt lgkmcnt(11)
    v_pk_add_f32 v[164:165], v[164:165], v[212:213]
    v_pk_add_f32 v[166:167], v[166:167], v[214:215]
    s_waitcnt lgkmcnt(10)
    v_pk_add_f32 v[180:181], v[180:181], v[228:229]
    v_pk_add_f32 v[182:183], v[182:183], v[230:231]
    s_waitcnt lgkmcnt(9)
    v_pk_add_f32 v[196:197], v[196:197], v[244:245]
    v_pk_add_f32 v[198:199], v[198:199], v[246:247]
    s_waitcnt lgkmcnt(8)
    v_pk_add_f32 v[168:169], v[168:169], v[216:217]
    v_pk_add_f32 v[170:171], v[170:171], v[218:219]
    s_waitcnt lgkmcnt(7)
    v_pk_add_f32 v[184:185], v[184:185], v[232:233]
    v_pk_add_f32 v[186:187], v[186:187], v[234:235]
    s_waitcnt lgkmcnt(6)
    v_pk_add_f32 v[200:201], v[200:201], v[248:249]
    v_pk_add_f32 v[202:203], v[202:203], v[250:251]
    s_waitcnt lgkmcnt(5)
    v_pk_add_f32 v[172:173], v[172:173], v[220:221]
    v_pk_add_f32 v[174:175], v[174:175], v[222:223]
    s_waitcnt lgkmcnt(4)
    v_pk_add_f32 v[188:189], v[188:189], v[236:237]
    v_pk_add_f32 v[190:191], v[190:191], v[238:239]
    s_waitcnt lgkmcnt(3)
    v_pk_add_f32 v[204:205], v[204:205], v[252:253]
    v_pk_add_f32 v[206:207], v[206:207], v[254:255]
    s_waitcnt lgkmcnt(2)
    v_pk_add_f32 v[160:161], v[160:161], v[208:209]
    v_pk_add_f32 v[162:163], v[162:163], v[210:211]
    s_waitcnt lgkmcnt(1)
    v_pk_add_f32 v[176:177], v[176:177], v[224:225]
    v_pk_add_f32 v[178:179], v[178:179], v[226:227]
    s_waitcnt lgkmcnt(0)
    v_pk_add_f32 v[192:193], v[192:193], v[240:241]
    v_pk_add_f32 v[194:195], v[194:195], v[242:243]
    ds_write_b128 v5, v[164:167] offset:1024
    ds_write_b128 v5, v[180:183] offset:5120
    ds_write_b128 v5, v[196:199] offset:9216
    ds_write_b128 v5, v[168:171] offset:2048
    ds_write_b128 v5, v[184:187] offset:6144
    ds_write_b128 v5, v[200:203] offset:10240
    ds_write_b128 v5, v[172:175] offset:3072
    ds_write_b128 v5, v[188:191] offset:7168
    ds_write_b128 v5, v[204:207] offset:11264
    ds_read_b64 v[248:249], v6 offset:0
    ds_read_b64 v[250:251], v6 offset:2048
    ds_read_b64 v[252:253], v6 offset:4096
    s_waitcnt lgkmcnt(0)
    s_barrier
    ds_read_b128 v[208:211], v8 offset:1024
    ds_read_b128 v[212:215], v8 offset:5120
    ds_read_b128 v[216:219], v8 offset:9216
    ds_read_b128 v[220:223], v9 offset:2048
    ds_read_b128 v[224:227], v9 offset:6144
    ds_read_b128 v[228:231], v9 offset:10240
    ds_read_b128 v[232:235], v10 offset:3072
    ds_read_b128 v[236:239], v10 offset:7168
    ds_read_b128 v[240:243], v10 offset:11264
    s_waitcnt vmcnt(14)
    v_lshlrev_b32 v124, 16, v124
    v_add_f32 v160, v160, v124
    v_add_f32 v161, v161, v124
    v_add_f32 v162, v162, v124
    v_add_f32 v163, v163, v124
    v_lshlrev_b32 v164, 16, v248
    v_and_b32 v165, 0xffff0000, v248
    v_lshlrev_b32 v166, 16, v249
    v_and_b32 v167, 0xffff0000, v249
    v_add_f32 v176, v176, v124
    v_add_f32 v177, v177, v124
    v_add_f32 v178, v178, v124
    v_add_f32 v179, v179, v124
    v_lshlrev_b32 v180, 16, v250
    v_and_b32 v181, 0xffff0000, v250
    v_lshlrev_b32 v182, 16, v251
    v_and_b32 v183, 0xffff0000, v251
    v_add_f32 v192, v192, v124
    v_add_f32 v193, v193, v124
    v_add_f32 v194, v194, v124
    v_add_f32 v195, v195, v124
    v_lshlrev_b32 v196, 16, v252
    v_and_b32 v197, 0xffff0000, v252
    v_lshlrev_b32 v198, 16, v253
    v_and_b32 v199, 0xffff0000, v253
    s_lshl_b32 s4, s16, 1
    s_add_u32 s4, s4, s22
    s_mul_i32 s4, s4, 48
    s_mul_i32 s5, s17, 6
    s_add_u32 s4, s4, s5
    s_add_u32 s4, s4, s23
    s_lshl_b32 s4, s4, 10
    s_lshl_b32 s5, s24, 3
    s_add_u32 s4, s4, s5
    s_add_u32 s4, s4, 0x5400000
    s_add_u32 s5, s4, 4096
    s_waitcnt lgkmcnt(8)
    v_pk_add_f32 v[160:161], v[160:161], v[208:209]
    v_pk_add_f32 v[162:163], v[162:163], v[210:211]
    s_waitcnt lgkmcnt(7)
    v_pk_add_f32 v[176:177], v[176:177], v[212:213]
    v_pk_add_f32 v[178:179], v[178:179], v[214:215]
    s_waitcnt lgkmcnt(6)
    v_pk_add_f32 v[192:193], v[192:193], v[216:217]
    v_pk_add_f32 v[194:195], v[194:195], v[218:219]
    s_waitcnt lgkmcnt(5)
    v_pk_add_f32 v[160:161], v[160:161], v[220:221]
    v_pk_add_f32 v[162:163], v[162:163], v[222:223]
    s_waitcnt lgkmcnt(4)
    v_pk_add_f32 v[176:177], v[176:177], v[224:225]
    v_pk_add_f32 v[178:179], v[178:179], v[226:227]
    s_waitcnt lgkmcnt(3)
    v_pk_add_f32 v[192:193], v[192:193], v[228:229]
    v_pk_add_f32 v[194:195], v[194:195], v[230:231]
    s_waitcnt lgkmcnt(2)
    v_pk_add_f32 v[160:161], v[160:161], v[232:233]
    v_pk_add_f32 v[162:163], v[162:163], v[234:235]
    s_waitcnt lgkmcnt(1)
    v_pk_add_f32 v[176:177], v[176:177], v[236:237]
    v_pk_add_f32 v[178:179], v[178:179], v[238:239]
    s_waitcnt lgkmcnt(0)
    v_pk_add_f32 v[192:193], v[192:193], v[240:241]
    v_pk_add_f32 v[194:195], v[194:195], v[242:243]
    s_barrier
    v_pk_mul_f32 v[160:161], v[160:161], v[164:165]
    v_pk_mul_f32 v[162:163], v[162:163], v[166:167]
    v_cvt_pk_bf16_f32 v168, v160, v161
    v_cvt_pk_bf16_f32 v169, v162, v163
    v_min_u32 v168, -2, v168
    v_min_u32 v169, -2, v169
    v_pk_mul_f32 v[176:177], v[176:177], v[180:181]
    v_pk_mul_f32 v[178:179], v[178:179], v[182:183]
    v_cvt_pk_bf16_f32 v184, v176, v177
    v_cvt_pk_bf16_f32 v185, v178, v179
    v_min_u32 v184, -2, v184
    v_min_u32 v185, -2, v185
    v_pk_mul_f32 v[192:193], v[192:193], v[196:197]
    v_pk_mul_f32 v[194:195], v[194:195], v[198:199]
    v_cvt_pk_bf16_f32 v200, v192, v193
    v_cvt_pk_bf16_f32 v201, v194, v195
    v_min_u32 v200, -2, v200
    v_min_u32 v201, -2, v201
    s_cmp_eq_u32 s43, 0
    s_cbranch_scc1 L_kva_tf124
    buffer_store_dwordx2 v[168:169], v12, s[8:11], s4 offen offset:0
    buffer_store_dwordx2 v[184:185], v12, s[8:11], s4 offen offset:2048
    buffer_store_dwordx2 v[200:201], v12, s[8:11], s5 offen offset:0
L_kva_tg125:
    v_lshrrev_b32 v8, 1, v0
    v_lshlrev_b32 v8, 13, v8
    v_and_b32 v5, 1, v0
    v_mul_u32_u24 v5, 0xc000, v5
    v_add_u32 v8, v8, v5
    s_cmp_lt_u32 s20, 3
    s_cselect_b32 s4, 12, 10
    v_mov_b32 v5, 0x7f000000
    v_cmp_gt_u32 vcc, s4, v0
    s_mul_i32 s4, s22, 49152
    v_add_u32 v9, s4, v12
    s_sub_u32 s4, 49152, s4
    v_add_u32 v10, s4, v12
    v_cndmask_b32 v8, v5, v8, vcc
    s_waitcnt vmcnt(0)
    buffer_load_dwordx4 v[68:71], v9, s[8:11], s44 offen sc1
    buffer_load_dwordx4 v[72:75], v10, s[8:11], s44 offen sc1
    buffer_load_dwordx4 v[76:79], v9, s[8:11], s45 offen sc1
    buffer_load_dwordx4 v[80:83], v10, s[8:11], s45 offen sc1
    buffer_load_dwordx4 v[84:87], v9, s[8:11], s46 offen sc1
    buffer_load_dwordx4 v[88:91], v10, s[8:11], s46 offen sc1
    buffer_load_dwordx4 v[92:95], v9, s[8:11], s47 offen sc1
    buffer_load_dwordx4 v[96:99], v10, s[8:11], s47 offen sc1
    buffer_load_dwordx4 v[100:103], v9, s[8:11], s28 offen sc1
    buffer_load_dwordx4 v[104:107], v10, s[8:11], s28 offen sc1
    buffer_load_dwordx4 v[108:111], v9, s[8:11], s29 offen sc1
    buffer_load_dwordx4 v[112:115], v10, s[8:11], s29 offen sc1
    s_mov_b32 s36, s90
    s_mov_b32 s37, s91
    s_mov_b32 s38, 0x200000
    s_mov_b32 s39, 0x00020000
    s_waitcnt vmcnt(10)
    v_max3_u32 v6, v68, v69, v70
    v_max3_u32 v6, v6, v71, v72
    v_max3_u32 v6, v6, v73, v74
    v_max_u32 v6, v6, v75
    v_cmp_eq_u32 vcc, -1, v6
    s_nop 3
    s_cbranch_vccnz L_kva_tv126
L_kva_tw127:
    v_mfma_f32_32x32x16_bf16 v[160:175], v[20:23], v[68:71], 0
    v_mfma_f32_32x32x16_bf16 v[176:191], v[24:27], v[68:71], 0
    v_mfma_f32_32x32x16_bf16 v[192:207], v[20:23], v[72:75], 0
    v_mfma_f32_32x32x16_bf16 v[208:223], v[24:27], v[72:75], 0
    s_waitcnt vmcnt(8)
    v_max3_u32 v6, v76, v77, v78
    v_max3_u32 v6, v6, v79, v80
    v_max3_u32 v6, v6, v81, v82
    v_max_u32 v6, v6, v83
    v_cmp_eq_u32 vcc, -1, v6
    s_nop 3
    s_cbranch_vccnz L_kva_tv129
L_kva_tw130:
    v_mfma_f32_32x32x16_bf16 v[160:175], v[28:31], v[76:79], v[160:175]
    v_mfma_f32_32x32x16_bf16 v[176:191], v[32:35], v[76:79], v[176:191]
    v_mfma_f32_32x32x16_bf16 v[192:207], v[28:31], v[80:83], v[192:207]
    v_mfma_f32_32x32x16_bf16 v[208:223], v[32:35], v[80:83], v[208:223]
    s_waitcnt vmcnt(6)
    v_max3_u32 v6, v84, v85, v86
    v_max3_u32 v6, v6, v87, v88
    v_max3_u32 v6, v6, v89, v90
    v_max_u32 v6, v6, v91
    v_cmp_eq_u32 vcc, -1, v6
    s_nop 3
    s_cbranch_vccnz L_kva_tv132
L_kva_tw133:
    v_mfma_f32_32x32x16_bf16 v[160:175], v[36:39], v[84:87], v[160:175]
    v_mfma_f32_32x32x16_bf16 v[176:191], v[40:43], v[84:87], v[176:191]
    v_mfma_f32_32x32x16_bf16 v[192:207], v[36:39], v[88:91], v[192:207]
    v_mfma_f32_32x32x16_bf16 v[208:223], v[40:43], v[88:91], v[208:223]
    s_waitcnt vmcnt(4)
    v_max3_u32 v6, v92, v93, v94
    v_max3_u32 v6, v6, v95, v96
    v_max3_u32 v6, v6, v97, v98
    v_max_u32 v6, v6, v99
    v_cmp_eq_u32 vcc, -1, v6
    s_nop 3
    s_cbranch_vccnz L_kva_tv135
L_kva_tw136:
    v_mfma_f32_32x32x16_bf16 v[160:175], v[44:47], v[92:95], v[160:175]
    v_mfma_f32_32x32x16_bf16 v[176:191], v[48:51], v[92:95], v[176:191]
    v_mfma_f32_32x32x16_bf16 v[192:207], v[44:47], v[96:99], v[192:207]
    v_mfma_f32_32x32x16_bf16 v[208:223], v[48:51], v[96:99], v[208:223]
    s_waitcnt vmcnt(2)
    v_max3_u32 v6, v100, v101, v102
    v_max3_u32 v6, v6, v103, v104
    v_max3_u32 v6, v6, v105, v106
    v_max_u32 v6, v6, v107
    v_cmp_eq_u32 vcc, -1, v6
    s_nop 3
    s_cbranch_vccnz L_kva_tv138
L_kva_tw139:
    v_mfma_f32_32x32x16_bf16 v[160:175], v[52:55], v[100:103], v[160:175]
    v_mfma_f32_32x32x16_bf16 v[176:191], v[56:59], v[100:103], v[176:191]
    v_mfma_f32_32x32x16_bf16 v[192:207], v[52:55], v[104:107], v[192:207]
    v_mfma_f32_32x32x16_bf16 v[208:223], v[56:59], v[104:107], v[208:223]
    s_waitcnt vmcnt(0)
    v_max3_u32 v6, v108, v109, v110
    v_max3_u32 v6, v6, v111, v112
    v_max3_u32 v6, v6, v113, v114
    v_max_u32 v6, v6, v115
    v_cmp_eq_u32 vcc, -1, v6
    s_nop 3
    s_cbranch_vccnz L_kva_tv141
L_kva_tw142:
    v_mfma_f32_32x32x16_bf16 v[160:175], v[60:63], v[108:111], v[160:175]
    v_mfma_f32_32x32x16_bf16 v[176:191], v[64:67], v[108:111], v[176:191]
    v_mfma_f32_32x32x16_bf16 v[192:207], v[60:63], v[112:115], v[192:207]
    v_mfma_f32_32x32x16_bf16 v[208:223], v[64:67], v[112:115], v[208:223]
    s_lshl_b32 s4, s20, 12
    v_add_u32 v4, s4, v12
    v_add_u32 v5, 65536, v4
    v_add_u32 v6, s81, v12
    s_nop 6
    ds_write_b128 v4, v[168:171] offset:0
    ds_write_b128 v4, v[172:175] offset:1024
    ds_write_b128 v4, v[176:179] offset:2048
    ds_write_b128 v4, v[180:183] offset:3072
    ds_write_b128 v5, v[184:187] offset:0
    ds_write_b128 v5, v[188:191] offset:1024
    ds_write_b128 v5, v[192:195] offset:2048
    ds_write_b128 v5, v[196:199] offset:3072
    ds_write_b128 v5, v[200:203] offset:32768
    ds_write_b128 v5, v[204:207] offset:33792
    s_nop 7
    ds_write_b128 v5, v[208:211] offset:34816
    ds_write_b128 v5, v[212:215] offset:35840
    ds_write_b128 v6, v[216:219] offset:0
    ds_write_b128 v6, v[220:223] offset:1024
    v_xor_b32 v149, 4096, v4
    v_xor_b32 v150, 8192, v4
    v_xor_b32 v151, 12288, v5
    v_xor_b32 v152, 16384, v5
    v_xor_b32 v153, 20480, v5
    v_xor_b32 v154, 24576, v5
    s_xor_b32 s4, s42, 3
    s_lshl_b32 s4, s4, 13
    s_mul_i32 s5, s22, 98304
    s_add_u32 s5, s5, 32768
    s_add_u32 s4, s4, s5
    v_add_u32 v155, s4, v12
    s_waitcnt lgkmcnt(0)
    s_barrier
    ds_read_b128 v[168:171], v149 offset:0
    ds_read_b128 v[172:175], v149 offset:1024
    ds_read_b128 v[176:179], v150 offset:2048
    ds_read_b128 v[180:183], v150 offset:3072
    ds_read_b128 v[184:187], v151 offset:0
    ds_read_b128 v[188:191], v151 offset:1024
    ds_read_b128 v[192:195], v152 offset:2048
    ds_read_b128 v[196:199], v152 offset:3072
    ds_read_b128 v[200:203], v153 offset:32768
    ds_read_b128 v[204:207], v153 offset:33792
    ds_read_b128 v[208:211], v154 offset:34816
    ds_read_b128 v[212:215], v154 offset:35840
    ds_read_b128 v[216:219], v155 offset:0
    ds_read_b128 v[220:223], v155 offset:1024
    s_waitcnt lgkmcnt(12)
    v_pk_add_f32 v[160:161], v[160:161], v[168:169]
    v_pk_add_f32 v[162:163], v[162:163], v[170:171]
    v_pk_add_f32 v[164:165], v[164:165], v[172:173]
    v_pk_add_f32 v[166:167], v[166:167], v[174:175]
    s_waitcnt lgkmcnt(10)
    v_pk_add_f32 v[160:161], v[160:161], v[176:177]
    v_pk_add_f32 v[162:163], v[162:163], v[178:179]
    v_pk_add_f32 v[164:165], v[164:165], v[180:181]
    v_pk_add_f32 v[166:167], v[166:167], v[182:183]
    s_waitcnt lgkmcnt(8)
    v_pk_add_f32 v[160:161], v[160:161], v[184:185]
    v_pk_add_f32 v[162:163], v[162:163], v[186:187]
    v_pk_add_f32 v[164:165], v[164:165], v[188:189]
    v_pk_add_f32 v[166:167], v[166:167], v[190:191]
    s_waitcnt lgkmcnt(6)
    v_pk_add_f32 v[160:161], v[160:161], v[192:193]
    v_pk_add_f32 v[162:163], v[162:163], v[194:195]
    v_pk_add_f32 v[164:165], v[164:165], v[196:197]
    v_pk_add_f32 v[166:167], v[166:167], v[198:199]
    s_waitcnt lgkmcnt(4)
    v_pk_add_f32 v[160:161], v[160:161], v[200:201]
    v_pk_add_f32 v[162:163], v[162:163], v[202:203]
    v_pk_add_f32 v[164:165], v[164:165], v[204:205]
    v_pk_add_f32 v[166:167], v[166:167], v[206:207]
    s_waitcnt lgkmcnt(2)
    v_pk_add_f32 v[160:161], v[160:161], v[208:209]
    v_pk_add_f32 v[162:163], v[162:163], v[210:211]
    v_pk_add_f32 v[164:165], v[164:165], v[212:213]
    v_pk_add_f32 v[166:167], v[166:167], v[214:215]
    s_waitcnt lgkmcnt(0)
    v_pk_add_f32 v[160:161], v[160:161], v[216:217]
    v_pk_add_f32 v[162:163], v[162:163], v[218:219]
    v_pk_add_f32 v[164:165], v[164:165], v[220:221]
    v_pk_add_f32 v[166:167], v[166:167], v[222:223]
    v_lshlrev_b32 v168, 16, v16
    v_and_b32 v169, 0xffff0000, v16
    v_lshlrev_b32 v170, 16, v17
    v_and_b32 v171, 0xffff0000, v17
    v_lshlrev_b32 v172, 16, v18
    v_and_b32 v173, 0xffff0000, v18
    v_lshlrev_b32 v174, 16, v19
    v_and_b32 v175, 0xffff0000, v19
    v_pk_fma_f32 v[168:169], v[116:117], v[160:161], v[168:169]
    v_pk_fma_f32 v[170:171], v[118:119], v[162:163], v[170:171]
    v_pk_fma_f32 v[172:173], v[120:121], v[164:165], v[172:173]
    v_pk_fma_f32 v[174:175], v[122:123], v[166:167], v[174:175]
    v_cvt_pk_bf16_f32 v176, v168, v169
    v_cvt_pk_bf16_f32 v177, v170, v171
    v_cvt_pk_bf16_f32 v178, v172, v173
    v_cvt_pk_bf16_f32 v179, v174, v175
    buffer_store_dwordx4 v[176:179], v13, s[36:39], s27 offen
    s_waitcnt vmcnt(0)
L_kva_end:
    s_endpgm
L_kva_tf5:
    buffer_store_dwordx4 v[128:131], v12, s[8:11], s6 offen sc1
    s_branch L_kva_tg6
L_kva_tf8:
    buffer_store_dwordx2 v[136:137], v4, s[56:59], s19 offen offset:512 sc1
    s_branch L_kva_tg9
L_kva_tv20:
    s_mov_b32 s7, 0x40000
L_kva_tx22:
    s_sleep 1
    buffer_load_dwordx4 v[92:95], v10, s[8:11], s28 offen offset:0 sc1
    buffer_load_dwordx4 v[96:99], v10, s[8:11], s29 offen offset:0 sc1
    buffer_load_dwordx4 v[100:103], v10, s[8:11], s28 offen offset:1024 sc1
    buffer_load_dwordx4 v[104:107], v10, s[8:11], s29 offen offset:1024 sc1
    buffer_load_dwordx4 v[108:111], v10, s[8:11], s28 offen offset:2048 sc1
    buffer_load_dwordx4 v[112:115], v10, s[8:11], s29 offen offset:2048 sc1
    buffer_load_dwordx4 v[116:119], v10, s[8:11], s28 offen offset:3072 sc1
    buffer_load_dwordx4 v[120:123], v10, s[8:11], s29 offen offset:3072 sc1
    buffer_load_dwordx4 v[124:127], v11, s[8:11], s28 offen offset:0 sc1
    buffer_load_dwordx4 v[128:131], v11, s[8:11], s29 offen offset:0 sc1
    buffer_load_dwordx4 v[132:135], v11, s[8:11], s28 offen offset:1024 sc1
    buffer_load_dwordx4 v[136:139], v11, s[8:11], s29 offen offset:1024 sc1
    buffer_load_dwordx4 v[140:143], v11, s[8:11], s28 offen offset:2048 sc1
    buffer_load_dwordx4 v[144:147], v11, s[8:11], s29 offen offset:2048 sc1
    buffer_load_dwordx4 v[148:151], v11, s[8:11], s28 offen offset:3072 sc1
    buffer_load_dwordx4 v[152:155], v11, s[8:11], s29 offen offset:3072 sc1
    s_waitcnt vmcnt(0)
    v_max3_u32 v6, v92, v93, v94
    v_max3_u32 v6, v6, v95, v96
    v_max3_u32 v6, v6, v97, v98
    v_max_u32 v6, v6, v99
    v_cmp_eq_u32 vcc, -1, v6
    s_sub_u32 s7, s7, 1
    s_nop 2
    s_cbranch_vccz L_kva_tw21
    s_cmp_eq_u32 s7, 0
    s_cbranch_scc0 L_kva_tx22
    s_branch L_kva_tw21
L_kva_tv23:
    s_mov_b32 s7, 0x40000
L_kva_tx25:
    s_sleep 1
    buffer_load_dwordx4 v[100:103], v10, s[8:11], s28 offen offset:1024 sc1
    buffer_load_dwordx4 v[104:107], v10, s[8:11], s29 offen offset:1024 sc1
    buffer_load_dwordx4 v[108:111], v10, s[8:11], s28 offen offset:2048 sc1
    buffer_load_dwordx4 v[112:115], v10, s[8:11], s29 offen offset:2048 sc1
    buffer_load_dwordx4 v[116:119], v10, s[8:11], s28 offen offset:3072 sc1
    buffer_load_dwordx4 v[120:123], v10, s[8:11], s29 offen offset:3072 sc1
    buffer_load_dwordx4 v[124:127], v11, s[8:11], s28 offen offset:0 sc1
    buffer_load_dwordx4 v[128:131], v11, s[8:11], s29 offen offset:0 sc1
    buffer_load_dwordx4 v[132:135], v11, s[8:11], s28 offen offset:1024 sc1
    buffer_load_dwordx4 v[136:139], v11, s[8:11], s29 offen offset:1024 sc1
    buffer_load_dwordx4 v[140:143], v11, s[8:11], s28 offen offset:2048 sc1
    buffer_load_dwordx4 v[144:147], v11, s[8:11], s29 offen offset:2048 sc1
    buffer_load_dwordx4 v[148:151], v11, s[8:11], s28 offen offset:3072 sc1
    buffer_load_dwordx4 v[152:155], v11, s[8:11], s29 offen offset:3072 sc1
    s_waitcnt vmcnt(0)
    v_max3_u32 v6, v100, v101, v102
    v_max3_u32 v6, v6, v103, v104
    v_max3_u32 v6, v6, v105, v106
    v_max_u32 v6, v6, v107
    v_cmp_eq_u32 vcc, -1, v6
    s_sub_u32 s7, s7, 1
    s_nop 2
    s_cbranch_vccz L_kva_tw24
    s_cmp_eq_u32 s7, 0
    s_cbranch_scc0 L_kva_tx25
    s_branch L_kva_tw24
L_kva_tv26:
    s_mov_b32 s7, 0x40000
L_kva_tx28:
    s_sleep 1
    buffer_load_dwordx4 v[108:111], v10, s[8:11], s28 offen offset:2048 sc1
    buffer_load_dwordx4 v[112:115], v10, s[8:11], s29 offen offset:2048 sc1
    buffer_load_dwordx4 v[116:119], v10, s[8:11], s28 offen offset:3072 sc1
    buffer_load_dwordx4 v[120:123], v10, s[8:11], s29 offen offset:3072 sc1
    buffer_load_dwordx4 v[124:127], v11, s[8:11], s28 offen offset:0 sc1
    buffer_load_dwordx4 v[128:131], v11, s[8:11], s29 offen offset:0 sc1
    buffer_load_dwordx4 v[132:135], v11, s[8:11], s28 offen offset:1024 sc1
    buffer_load_dwordx4 v[136:139], v11, s[8:11], s29 offen offset:1024 sc1
    buffer_load_dwordx4 v[140:143], v11, s[8:11], s28 offen offset:2048 sc1
    buffer_load_dwordx4 v[144:147], v11, s[8:11], s29 offen offset:2048 sc1
    buffer_load_dwordx4 v[148:151], v11, s[8:11], s28 offen offset:3072 sc1
    buffer_load_dwordx4 v[152:155], v11, s[8:11], s29 offen offset:3072 sc1
    s_waitcnt vmcnt(0)
    v_max3_u32 v6, v108, v109, v110
    v_max3_u32 v6, v6, v111, v112
    v_max3_u32 v6, v6, v113, v114
    v_max_u32 v6, v6, v115
    v_cmp_eq_u32 vcc, -1, v6
    s_sub_u32 s7, s7, 1
    s_nop 2
    s_cbranch_vccz L_kva_tw27
    s_cmp_eq_u32 s7, 0
    s_cbranch_scc0 L_kva_tx28
    s_branch L_kva_tw27
L_kva_tv29:
    s_mov_b32 s7, 0x40000
L_kva_tx31:
    s_sleep 1
    buffer_load_dwordx4 v[116:119], v10, s[8:11], s28 offen offset:3072 sc1
    buffer_load_dwordx4 v[120:123], v10, s[8:11], s29 offen offset:3072 sc1
    buffer_load_dwordx4 v[124:127], v11, s[8:11], s28 offen offset:0 sc1
    buffer_load_dwordx4 v[128:131], v11, s[8:11], s29 offen offset:0 sc1
    buffer_load_dwordx4 v[132:135], v11, s[8:11], s28 offen offset:1024 sc1
    buffer_load_dwordx4 v[136:139], v11, s[8:11], s29 offen offset:1024 sc1
    buffer_load_dwordx4 v[140:143], v11, s[8:11], s28 offen offset:2048 sc1
    buffer_load_dwordx4 v[144:147], v11, s[8:11], s29 offen offset:2048 sc1
    buffer_load_dwordx4 v[148:151], v11, s[8:11], s28 offen offset:3072 sc1
    buffer_load_dwordx4 v[152:155], v11, s[8:11], s29 offen offset:3072 sc1
    s_waitcnt vmcnt(0)
    v_max3_u32 v6, v116, v117, v118
    v_max3_u32 v6, v6, v119, v120
    v_max3_u32 v6, v6, v121, v122
    v_max_u32 v6, v6, v123
    v_cmp_eq_u32 vcc, -1, v6
    s_sub_u32 s7, s7, 1
    s_nop 2
    s_cbranch_vccz L_kva_tw30
    s_cmp_eq_u32 s7, 0
    s_cbranch_scc0 L_kva_tx31
    s_branch L_kva_tw30
L_kva_tv32:
    s_mov_b32 s7, 0x40000
L_kva_tx34:
    s_sleep 1
    buffer_load_dwordx4 v[124:127], v11, s[8:11], s28 offen offset:0 sc1
    buffer_load_dwordx4 v[128:131], v11, s[8:11], s29 offen offset:0 sc1
    buffer_load_dwordx4 v[132:135], v11, s[8:11], s28 offen offset:1024 sc1
    buffer_load_dwordx4 v[136:139], v11, s[8:11], s29 offen offset:1024 sc1
    buffer_load_dwordx4 v[140:143], v11, s[8:11], s28 offen offset:2048 sc1
    buffer_load_dwordx4 v[144:147], v11, s[8:11], s29 offen offset:2048 sc1
    buffer_load_dwordx4 v[148:151], v11, s[8:11], s28 offen offset:3072 sc1
    buffer_load_dwordx4 v[152:155], v11, s[8:11], s29 offen offset:3072 sc1
    s_waitcnt vmcnt(0)
    v_max3_u32 v6, v124, v125, v126
    v_max3_u32 v6, v6, v127, v128
    v_max3_u32 v6, v6, v129, v130
    v_max_u32 v6, v6, v131
    v_cmp_eq_u32 vcc, -1, v6
    s_sub_u32 s7, s7, 1
    s_nop 2
    s_cbranch_vccz L_kva_tw33
    s_cmp_eq_u32 s7, 0
    s_cbranch_scc0 L_kva_tx34
    s_branch L_kva_tw33
L_kva_tv35:
    s_mov_b32 s7, 0x40000
L_kva_tx37:
    s_sleep 1
    buffer_load_dwordx4 v[132:135], v11, s[8:11], s28 offen offset:1024 sc1
    buffer_load_dwordx4 v[136:139], v11, s[8:11], s29 offen offset:1024 sc1
    buffer_load_dwordx4 v[140:143], v11, s[8:11], s28 offen offset:2048 sc1
    buffer_load_dwordx4 v[144:147], v11, s[8:11], s29 offen offset:2048 sc1
    buffer_load_dwordx4 v[148:151], v11, s[8:11], s28 offen offset:3072 sc1
    buffer_load_dwordx4 v[152:155], v11, s[8:11], s29 offen offset:3072 sc1
    s_waitcnt vmcnt(0)
    v_max3_u32 v6, v132, v133, v134
    v_max3_u32 v6, v6, v135, v136
    v_max3_u32 v6, v6, v137, v138
    v_max_u32 v6, v6, v139
    v_cmp_eq_u32 vcc, -1, v6
    s_sub_u32 s7, s7, 1
    s_nop 2
    s_cbranch_vccz L_kva_tw36
    s_cmp_eq_u32 s7, 0
    s_cbranch_scc0 L_kva_tx37
    s_branch L_kva_tw36
L_kva_tv38:
    s_mov_b32 s7, 0x40000
L_kva_tx40:
    s_sleep 1
    buffer_load_dwordx4 v[140:143], v11, s[8:11], s28 offen offset:2048 sc1
    buffer_load_dwordx4 v[144:147], v11, s[8:11], s29 offen offset:2048 sc1
    buffer_load_dwordx4 v[148:151], v11, s[8:11], s28 offen offset:3072 sc1
    buffer_load_dwordx4 v[152:155], v11, s[8:11], s29 offen offset:3072 sc1
    s_waitcnt vmcnt(0)
    v_max3_u32 v6, v140, v141, v142
    v_max3_u32 v6, v6, v143, v144
    v_max3_u32 v6, v6, v145, v146
    v_max_u32 v6, v6, v147
    v_cmp_eq_u32 vcc, -1, v6
    s_sub_u32 s7, s7, 1
    s_nop 2
    s_cbranch_vccz L_kva_tw39
    s_cmp_eq_u32 s7, 0
    s_cbranch_scc0 L_kva_tx40
    s_branch L_kva_tw39
L_kva_tv41:
    s_mov_b32 s7, 0x40000
L_kva_tx43:
    s_sleep 1
    buffer_load_dwordx4 v[148:151], v11, s[8:11], s28 offen offset:3072 sc1
    buffer_load_dwordx4 v[152:155], v11, s[8:11], s29 offen offset:3072 sc1
    s_waitcnt vmcnt(0)
    v_max3_u32 v6, v148, v149, v150
    v_max3_u32 v6, v6, v151, v152
    v_max3_u32 v6, v6, v153, v154
    v_max_u32 v6, v6, v155
    v_cmp_eq_u32 vcc, -1, v6
    s_sub_u32 s7, s7, 1
    s_nop 2
    s_cbranch_vccz L_kva_tw42
    s_cmp_eq_u32 s7, 0
    s_cbranch_scc0 L_kva_tx43
    s_branch L_kva_tw42
L_kva_tf46:
    buffer_store_dwordx4 v[208:211], v4, s[56:59], s5 offen offset:1024 sc1
    buffer_store_dwordx4 v[212:215], v4, s[56:59], s5 offen offset:1040 sc1
    s_branch L_kva_tg47
L_kva_tv50:
    s_mov_b32 s7, 0x40000
L_kva_tx52:
    s_sleep 1
    buffer_load_dwordx4 v[92:95], v10, s[8:11], s28 offen offset:0 sc1
    buffer_load_dwordx4 v[96:99], v10, s[8:11], s29 offen offset:0 sc1
    buffer_load_dwordx4 v[100:103], v10, s[8:11], s28 offen offset:1024 sc1
    buffer_load_dwordx4 v[104:107], v10, s[8:11], s29 offen offset:1024 sc1
    buffer_load_dwordx4 v[108:111], v10, s[8:11], s28 offen offset:2048 sc1
    buffer_load_dwordx4 v[112:115], v10, s[8:11], s29 offen offset:2048 sc1
    buffer_load_dwordx4 v[116:119], v10, s[8:11], s28 offen offset:3072 sc1
    buffer_load_dwordx4 v[120:123], v10, s[8:11], s29 offen offset:3072 sc1
    buffer_load_dwordx4 v[124:127], v11, s[8:11], s28 offen offset:0 sc1
    buffer_load_dwordx4 v[128:131], v11, s[8:11], s29 offen offset:0 sc1
    buffer_load_dwordx4 v[132:135], v11, s[8:11], s28 offen offset:1024 sc1
    buffer_load_dwordx4 v[136:139], v11, s[8:11], s29 offen offset:1024 sc1
    buffer_load_dwordx4 v[140:143], v11, s[8:11], s28 offen offset:2048 sc1
    buffer_load_dwordx4 v[144:147], v11, s[8:11], s29 offen offset:2048 sc1
    buffer_load_dwordx4 v[148:151], v11, s[8:11], s28 offen offset:3072 sc1
    buffer_load_dwordx4 v[152:155], v11, s[8:11], s29 offen offset:3072 sc1
    s_waitcnt vmcnt(0)
    v_max3_u32 v6, v92, v93, v94
    v_max3_u32 v6, v6, v95, v96
    v_max3_u32 v6, v6, v97, v98
    v_max_u32 v6, v6, v99
    v_cmp_eq_u32 vcc, -1, v6
    s_sub_u32 s7, s7, 1
    s_nop 2
    s_cbranch_vccz L_kva_tw51
    s_cmp_eq_u32 s7, 0
    s_cbranch_scc0 L_kva_tx52
    s_branch L_kva_tw51
L_kva_tv53:
    s_mov_b32 s7, 0x40000
L_kva_tx55:
    s_sleep 1
    buffer_load_dwordx4 v[100:103], v10, s[8:11], s28 offen offset:1024 sc1
    buffer_load_dwordx4 v[104:107], v10, s[8:11], s29 offen offset:1024 sc1
    buffer_load_dwordx4 v[108:111], v10, s[8:11], s28 offen offset:2048 sc1
    buffer_load_dwordx4 v[112:115], v10, s[8:11], s29 offen offset:2048 sc1
    buffer_load_dwordx4 v[116:119], v10, s[8:11], s28 offen offset:3072 sc1
    buffer_load_dwordx4 v[120:123], v10, s[8:11], s29 offen offset:3072 sc1
    buffer_load_dwordx4 v[124:127], v11, s[8:11], s28 offen offset:0 sc1
    buffer_load_dwordx4 v[128:131], v11, s[8:11], s29 offen offset:0 sc1
    buffer_load_dwordx4 v[132:135], v11, s[8:11], s28 offen offset:1024 sc1
    buffer_load_dwordx4 v[136:139], v11, s[8:11], s29 offen offset:1024 sc1
    buffer_load_dwordx4 v[140:143], v11, s[8:11], s28 offen offset:2048 sc1
    buffer_load_dwordx4 v[144:147], v11, s[8:11], s29 offen offset:2048 sc1
    buffer_load_dwordx4 v[148:151], v11, s[8:11], s28 offen offset:3072 sc1
    buffer_load_dwordx4 v[152:155], v11, s[8:11], s29 offen offset:3072 sc1
    s_waitcnt vmcnt(0)
    v_max3_u32 v6, v100, v101, v102
    v_max3_u32 v6, v6, v103, v104
    v_max3_u32 v6, v6, v105, v106
    v_max_u32 v6, v6, v107
    v_cmp_eq_u32 vcc, -1, v6
    s_sub_u32 s7, s7, 1
    s_nop 2
    s_cbranch_vccz L_kva_tw54
    s_cmp_eq_u32 s7, 0
    s_cbranch_scc0 L_kva_tx55
    s_branch L_kva_tw54
L_kva_tv56:
    s_mov_b32 s7, 0x40000
L_kva_tx58:
    s_sleep 1
    buffer_load_dwordx4 v[108:111], v10, s[8:11], s28 offen offset:2048 sc1
    buffer_load_dwordx4 v[112:115], v10, s[8:11], s29 offen offset:2048 sc1
    buffer_load_dwordx4 v[116:119], v10, s[8:11], s28 offen offset:3072 sc1
    buffer_load_dwordx4 v[120:123], v10, s[8:11], s29 offen offset:3072 sc1
    buffer_load_dwordx4 v[124:127], v11, s[8:11], s28 offen offset:0 sc1
    buffer_load_dwordx4 v[128:131], v11, s[8:11], s29 offen offset:0 sc1
    buffer_load_dwordx4 v[132:135], v11, s[8:11], s28 offen offset:1024 sc1
    buffer_load_dwordx4 v[136:139], v11, s[8:11], s29 offen offset:1024 sc1
    buffer_load_dwordx4 v[140:143], v11, s[8:11], s28 offen offset:2048 sc1
    buffer_load_dwordx4 v[144:147], v11, s[8:11], s29 offen offset:2048 sc1
    buffer_load_dwordx4 v[148:151], v11, s[8:11], s28 offen offset:3072 sc1
    buffer_load_dwordx4 v[152:155], v11, s[8:11], s29 offen offset:3072 sc1
    s_waitcnt vmcnt(0)
    v_max3_u32 v6, v108, v109, v110
    v_max3_u32 v6, v6, v111, v112
    v_max3_u32 v6, v6, v113, v114
    v_max_u32 v6, v6, v115
    v_cmp_eq_u32 vcc, -1, v6
    s_sub_u32 s7, s7, 1
    s_nop 2
    s_cbranch_vccz L_kva_tw57
    s_cmp_eq_u32 s7, 0
    s_cbranch_scc0 L_kva_tx58
    s_branch L_kva_tw57
L_kva_tv59:
    s_mov_b32 s7, 0x40000
L_kva_tx61:
    s_sleep 1
    buffer_load_dwordx4 v[116:119], v10, s[8:11], s28 offen offset:3072 sc1
    buffer_load_dwordx4 v[120:123], v10, s[8:11], s29 offen offset:3072 sc1
    buffer_load_dwordx4 v[124:127], v11, s[8:11], s28 offen offset:0 sc1
    buffer_load_dwordx4 v[128:131], v11, s[8:11], s29 offen offset:0 sc1
    buffer_load_dwordx4 v[132:135], v11, s[8:11], s28 offen offset:1024 sc1
    buffer_load_dwordx4 v[136:139], v11, s[8:11], s29 offen offset:1024 sc1
    buffer_load_dwordx4 v[140:143], v11, s[8:11], s28 offen offset:2048 sc1
    buffer_load_dwordx4 v[144:147], v11, s[8:11], s29 offen offset:2048 sc1
    buffer_load_dwordx4 v[148:151], v11, s[8:11], s28 offen offset:3072 sc1
    buffer_load_dwordx4 v[152:155], v11, s[8:11], s29 offen offset:3072 sc1
    s_waitcnt vmcnt(0)
    v_max3_u32 v6, v116, v117, v118
    v_max3_u32 v6, v6, v119, v120
    v_max3_u32 v6, v6, v121, v122
    v_max_u32 v6, v6, v123
    v_cmp_eq_u32 vcc, -1, v6
    s_sub_u32 s7, s7, 1
    s_nop 2
    s_cbranch_vccz L_kva_tw60
    s_cmp_eq_u32 s7, 0
    s_cbranch_scc0 L_kva_tx61
    s_branch L_kva_tw60
L_kva_tv62:
    s_mov_b32 s7, 0x40000
L_kva_tx64:
    s_sleep 1
    buffer_load_dwordx4 v[124:127], v11, s[8:11], s28 offen offset:0 sc1
    buffer_load_dwordx4 v[128:131], v11, s[8:11], s29 offen offset:0 sc1
    buffer_load_dwordx4 v[132:135], v11, s[8:11], s28 offen offset:1024 sc1
    buffer_load_dwordx4 v[136:139], v11, s[8:11], s29 offen offset:1024 sc1
    buffer_load_dwordx4 v[140:143], v11, s[8:11], s28 offen offset:2048 sc1
    buffer_load_dwordx4 v[144:147], v11, s[8:11], s29 offen offset:2048 sc1
    buffer_load_dwordx4 v[148:151], v11, s[8:11], s28 offen offset:3072 sc1
    buffer_load_dwordx4 v[152:155], v11, s[8:11], s29 offen offset:3072 sc1
    s_waitcnt vmcnt(0)
    v_max3_u32 v6, v124, v125, v126
    v_max3_u32 v6, v6, v127, v128
    v_max3_u32 v6, v6, v129, v130
    v_max_u32 v6, v6, v131
    v_cmp_eq_u32 vcc, -1, v6
    s_sub_u32 s7, s7, 1
    s_nop 2
    s_cbranch_vccz L_kva_tw63
    s_cmp_eq_u32 s7, 0
    s_cbranch_scc0 L_kva_tx64
    s_branch L_kva_tw63
L_kva_tv65:
    s_mov_b32 s7, 0x40000
L_kva_tx67:
    s_sleep 1
    buffer_load_dwordx4 v[132:135], v11, s[8:11], s28 offen offset:1024 sc1
    buffer_load_dwordx4 v[136:139], v11, s[8:11], s29 offen offset:1024 sc1
    buffer_load_dwordx4 v[140:143], v11, s[8:11], s28 offen offset:2048 sc1
    buffer_load_dwordx4 v[144:147], v11, s[8:11], s29 offen offset:2048 sc1
    buffer_load_dwordx4 v[148:151], v11, s[8:11], s28 offen offset:3072 sc1
    buffer_load_dwordx4 v[152:155], v11, s[8:11], s29 offen offset:3072 sc1
    s_waitcnt vmcnt(0)
    v_max3_u32 v6, v132, v133, v134
    v_max3_u32 v6, v6, v135, v136
    v_max3_u32 v6, v6, v137, v138
    v_max_u32 v6, v6, v139
    v_cmp_eq_u32 vcc, -1, v6
    s_sub_u32 s7, s7, 1
    s_nop 2
    s_cbranch_vccz L_kva_tw66
    s_cmp_eq_u32 s7, 0
    s_cbranch_scc0 L_kva_tx67
    s_branch L_kva_tw66
L_kva_tv68:
    s_mov_b32 s7, 0x40000
L_kva_tx70:
    s_sleep 1
    buffer_load_dwordx4 v[140:143], v11, s[8:11], s28 offen offset:2048 sc1
    buffer_load_dwordx4 v[144:147], v11, s[8:11], s29 offen offset:2048 sc1
    buffer_load_dwordx4 v[148:151], v11, s[8:11], s28 offen offset:3072 sc1
    buffer_load_dwordx4 v[152:155], v11, s[8:11], s29 offen offset:3072 sc1
    s_waitcnt vmcnt(0)
    v_max3_u32 v6, v140, v141, v142
    v_max3_u32 v6, v6, v143, v144
    v_max3_u32 v6, v6, v145, v146
    v_max_u32 v6, v6, v147
    v_cmp_eq_u32 vcc, -1, v6
    s_sub_u32 s7, s7, 1
    s_nop 2
    s_cbranch_vccz L_kva_tw69
    s_cmp_eq_u32 s7, 0
    s_cbranch_scc0 L_kva_tx70
    s_branch L_kva_tw69
L_kva_tv71:
    s_mov_b32 s7, 0x40000
L_kva_tx73:
    s_sleep 1
    buffer_load_dwordx4 v[148:151], v11, s[8:11], s28 offen offset:3072 sc1
    buffer_load_dwordx4 v[152:155], v11, s[8:11], s29 offen offset:3072 sc1
    s_waitcnt vmcnt(0)
    v_max3_u32 v6, v148, v149, v150
    v_max3_u32 v6, v6, v151, v152
    v_max3_u32 v6, v6, v153, v154
    v_max_u32 v6, v6, v155
    v_cmp_eq_u32 vcc, -1, v6
    s_sub_u32 s7, s7, 1
    s_nop 2
    s_cbranch_vccz L_kva_tw72
    s_cmp_eq_u32 s7, 0
    s_cbranch_scc0 L_kva_tx73
    s_branch L_kva_tw72
L_kva_tv76:
    s_mov_b32 s7, 0x40000
L_kva_tx78:
    s_sleep 1
    s_add_u32 s4, s74, 0
    buffer_load_dwordx4 v[108:111], v10, s[8:11], s4 offen offset:0 sc1
    buffer_load_dwordx4 v[112:115], v10, s[8:11], s4 offen offset:1024 sc1
    buffer_load_dwordx4 v[116:119], v10, s[8:11], s4 offen offset:2048 sc1
    s_waitcnt vmcnt(0)
    v_max3_u32 v6, v108, v109, v110
    v_max3_u32 v6, v6, v111, v112
    v_max3_u32 v6, v6, v113, v114
    v_max3_u32 v6, v6, v115, v116
    v_max3_u32 v6, v6, v117, v118
    v_max_u32 v6, v6, v119
    v_cmp_eq_u32 vcc, -1, v6
    s_sub_u32 s7, s7, 1
    s_nop 2
    s_cbranch_vccz L_kva_tw77
    s_cmp_eq_u32 s7, 0
    s_cbranch_scc0 L_kva_tx78
    s_branch L_kva_tw77
L_kva_tv79:
    s_mov_b32 s7, 0x40000
L_kva_tx81:
    s_sleep 1
    s_add_u32 s4, s74, 3072
    buffer_load_dwordx4 v[120:123], v10, s[8:11], s4 offen offset:0 sc1
    buffer_load_dwordx4 v[124:127], v10, s[8:11], s4 offen offset:1024 sc1
    buffer_load_dwordx4 v[128:131], v10, s[8:11], s4 offen offset:2048 sc1
    s_waitcnt vmcnt(0)
    v_max3_u32 v6, v120, v121, v122
    v_max3_u32 v6, v6, v123, v124
    v_max3_u32 v6, v6, v125, v126
    v_max3_u32 v6, v6, v127, v128
    v_max3_u32 v6, v6, v129, v130
    v_max_u32 v6, v6, v131
    v_cmp_eq_u32 vcc, -1, v6
    s_sub_u32 s7, s7, 1
    s_nop 2
    s_cbranch_vccz L_kva_tw80
    s_cmp_eq_u32 s7, 0
    s_cbranch_scc0 L_kva_tx81
    s_branch L_kva_tw80
L_kva_tv82:
    s_mov_b32 s7, 0x40000
L_kva_tx84:
    s_sleep 1
    s_add_u32 s4, s74, 6144
    buffer_load_dwordx4 v[132:135], v10, s[8:11], s4 offen offset:0 sc1
    buffer_load_dwordx4 v[136:139], v10, s[8:11], s4 offen offset:1024 sc1
    buffer_load_dwordx4 v[140:143], v10, s[8:11], s4 offen offset:2048 sc1
    s_waitcnt vmcnt(0)
    v_max3_u32 v6, v132, v133, v134
    v_max3_u32 v6, v6, v135, v136
    v_max3_u32 v6, v6, v137, v138
    v_max3_u32 v6, v6, v139, v140
    v_max3_u32 v6, v6, v141, v142
    v_max_u32 v6, v6, v143
    v_cmp_eq_u32 vcc, -1, v6
    s_sub_u32 s7, s7, 1
    s_nop 2
    s_cbranch_vccz L_kva_tw83
    s_cmp_eq_u32 s7, 0
    s_cbranch_scc0 L_kva_tx84
    s_branch L_kva_tw83
L_kva_tv85:
    s_mov_b32 s7, 0x40000
L_kva_tx87:
    s_sleep 1
    s_add_u32 s4, s74, 9216
    buffer_load_dwordx4 v[144:147], v10, s[8:11], s4 offen offset:0 sc1
    buffer_load_dwordx4 v[148:151], v10, s[8:11], s4 offen offset:1024 sc1
    buffer_load_dwordx4 v[152:155], v10, s[8:11], s4 offen offset:2048 sc1
    s_waitcnt vmcnt(0)
    v_max3_u32 v6, v144, v145, v146
    v_max3_u32 v6, v6, v147, v148
    v_max3_u32 v6, v6, v149, v150
    v_max3_u32 v6, v6, v151, v152
    v_max3_u32 v6, v6, v153, v154
    v_max_u32 v6, v6, v155
    v_cmp_eq_u32 vcc, -1, v6
    s_sub_u32 s7, s7, 1
    s_nop 2
    s_cbranch_vccz L_kva_tw86
    s_cmp_eq_u32 s7, 0
    s_cbranch_scc0 L_kva_tx87
    s_branch L_kva_tw86
L_kva_tv88:
    s_mov_b32 s7, 0x40000
L_kva_tx90:
    s_sleep 1
    s_add_u32 s4, s75, 0
    buffer_load_dwordx4 v[108:111], v10, s[8:11], s4 offen offset:0 sc1
    buffer_load_dwordx4 v[112:115], v10, s[8:11], s4 offen offset:1024 sc1
    buffer_load_dwordx4 v[116:119], v10, s[8:11], s4 offen offset:2048 sc1
    s_waitcnt vmcnt(0)
    v_max3_u32 v6, v108, v109, v110
    v_max3_u32 v6, v6, v111, v112
    v_max3_u32 v6, v6, v113, v114
    v_max3_u32 v6, v6, v115, v116
    v_max3_u32 v6, v6, v117, v118
    v_max_u32 v6, v6, v119
    v_cmp_eq_u32 vcc, -1, v6
    s_sub_u32 s7, s7, 1
    s_nop 2
    s_cbranch_vccz L_kva_tw89
    s_cmp_eq_u32 s7, 0
    s_cbranch_scc0 L_kva_tx90
    s_branch L_kva_tw89
L_kva_tv91:
    s_mov_b32 s7, 0x40000
L_kva_tx93:
    s_sleep 1
    s_add_u32 s4, s75, 3072
    buffer_load_dwordx4 v[120:123], v10, s[8:11], s4 offen offset:0 sc1
    buffer_load_dwordx4 v[124:127], v10, s[8:11], s4 offen offset:1024 sc1
    buffer_load_dwordx4 v[128:131], v10, s[8:11], s4 offen offset:2048 sc1
    s_waitcnt vmcnt(0)
    v_max3_u32 v6, v120, v121, v122
    v_max3_u32 v6, v6, v123, v124
    v_max3_u32 v6, v6, v125, v126
    v_max3_u32 v6, v6, v127, v128
    v_max3_u32 v6, v6, v129, v130
    v_max_u32 v6, v6, v131
    v_cmp_eq_u32 vcc, -1, v6
    s_sub_u32 s7, s7, 1
    s_nop 2
    s_cbranch_vccz L_kva_tw92
    s_cmp_eq_u32 s7, 0
    s_cbranch_scc0 L_kva_tx93
    s_branch L_kva_tw92
L_kva_tv94:
    s_mov_b32 s7, 0x40000
L_kva_tx96:
    s_sleep 1
    s_add_u32 s4, s75, 6144
    buffer_load_dwordx4 v[132:135], v10, s[8:11], s4 offen offset:0 sc1
    buffer_load_dwordx4 v[136:139], v10, s[8:11], s4 offen offset:1024 sc1
    buffer_load_dwordx4 v[140:143], v10, s[8:11], s4 offen offset:2048 sc1
    s_waitcnt vmcnt(0)
    v_max3_u32 v6, v132, v133, v134
    v_max3_u32 v6, v6, v135, v136
    v_max3_u32 v6, v6, v137, v138
    v_max3_u32 v6, v6, v139, v140
    v_max3_u32 v6, v6, v141, v142
    v_max_u32 v6, v6, v143
    v_cmp_eq_u32 vcc, -1, v6
    s_sub_u32 s7, s7, 1
    s_nop 2
    s_cbranch_vccz L_kva_tw95
    s_cmp_eq_u32 s7, 0
    s_cbranch_scc0 L_kva_tx96
    s_branch L_kva_tw95
L_kva_tv97:
    s_mov_b32 s7, 0x40000
L_kva_tx99:
    s_sleep 1
    s_add_u32 s4, s75, 9216
    buffer_load_dwordx4 v[144:147], v10, s[8:11], s4 offen offset:0 sc1
    buffer_load_dwordx4 v[148:151], v10, s[8:11], s4 offen offset:1024 sc1
    buffer_load_dwordx4 v[152:155], v10, s[8:11], s4 offen offset:2048 sc1
    s_waitcnt vmcnt(0)
    v_max3_u32 v6, v144, v145, v146
    v_max3_u32 v6, v6, v147, v148
    v_max3_u32 v6, v6, v149, v150
    v_max3_u32 v6, v6, v151, v152
    v_max3_u32 v6, v6, v153, v154
    v_max_u32 v6, v6, v155
    v_cmp_eq_u32 vcc, -1, v6
    s_sub_u32 s7, s7, 1
    s_nop 2
    s_cbranch_vccz L_kva_tw98
    s_cmp_eq_u32 s7, 0
    s_cbranch_scc0 L_kva_tx99
    s_branch L_kva_tw98
L_kva_tv100:
    s_mov_b32 s7, 0x40000
L_kva_tx102:
    s_sleep 1
    s_add_u32 s4, s76, 0
    buffer_load_dwordx4 v[108:111], v10, s[8:11], s4 offen offset:0 sc1
    buffer_load_dwordx4 v[112:115], v10, s[8:11], s4 offen offset:1024 sc1
    buffer_load_dwordx4 v[116:119], v10, s[8:11], s4 offen offset:2048 sc1
    s_waitcnt vmcnt(0)
    v_max3_u32 v6, v108, v109, v110
    v_max3_u32 v6, v6, v111, v112
    v_max3_u32 v6, v6, v113, v114
    v_max3_u32 v6, v6, v115, v116
    v_max3_u32 v6, v6, v117, v118
    v_max_u32 v6, v6, v119
    v_cmp_eq_u32 vcc, -1, v6
    s_sub_u32 s7, s7, 1
    s_nop 2
    s_cbranch_vccz L_kva_tw101
    s_cmp_eq_u32 s7, 0
    s_cbranch_scc0 L_kva_tx102
    s_branch L_kva_tw101
L_kva_tv103:
    s_mov_b32 s7, 0x40000
L_kva_tx105:
    s_sleep 1
    s_add_u32 s4, s76, 3072
    buffer_load_dwordx4 v[120:123], v10, s[8:11], s4 offen offset:0 sc1
    buffer_load_dwordx4 v[124:127], v10, s[8:11], s4 offen offset:1024 sc1
    buffer_load_dwordx4 v[128:131], v10, s[8:11], s4 offen offset:2048 sc1
    s_waitcnt vmcnt(0)
    v_max3_u32 v6, v120, v121, v122
    v_max3_u32 v6, v6, v123, v124
    v_max3_u32 v6, v6, v125, v126
    v_max3_u32 v6, v6, v127, v128
    v_max3_u32 v6, v6, v129, v130
    v_max_u32 v6, v6, v131
    v_cmp_eq_u32 vcc, -1, v6
    s_sub_u32 s7, s7, 1
    s_nop 2
    s_cbranch_vccz L_kva_tw104
    s_cmp_eq_u32 s7, 0
    s_cbranch_scc0 L_kva_tx105
    s_branch L_kva_tw104
L_kva_tv106:
    s_mov_b32 s7, 0x40000
L_kva_tx108:
    s_sleep 1
    s_add_u32 s4, s76, 6144
    buffer_load_dwordx4 v[132:135], v10, s[8:11], s4 offen offset:0 sc1
    buffer_load_dwordx4 v[136:139], v10, s[8:11], s4 offen offset:1024 sc1
    buffer_load_dwordx4 v[140:143], v10, s[8:11], s4 offen offset:2048 sc1
    s_waitcnt vmcnt(0)
    v_max3_u32 v6, v132, v133, v134
    v_max3_u32 v6, v6, v135, v136
    v_max3_u32 v6, v6, v137, v138
    v_max3_u32 v6, v6, v139, v140
    v_max3_u32 v6, v6, v141, v142
    v_max_u32 v6, v6, v143
    v_cmp_eq_u32 vcc, -1, v6
    s_sub_u32 s7, s7, 1
    s_nop 2
    s_cbranch_vccz L_kva_tw107
    s_cmp_eq_u32 s7, 0
    s_cbranch_scc0 L_kva_tx108
    s_branch L_kva_tw107
L_kva_tv109:
    s_mov_b32 s7, 0x40000
L_kva_tx111:
    s_sleep 1
    s_add_u32 s4, s76, 9216
    buffer_load_dwordx4 v[144:147], v10, s[8:11], s4 offen offset:0 sc1
    buffer_load_dwordx4 v[148:151], v10, s[8:11], s4 offen offset:1024 sc1
    buffer_load_dwordx4 v[152:155], v10, s[8:11], s4 offen offset:2048 sc1
    s_waitcnt vmcnt(0)
    v_max3_u32 v6, v144, v145, v146
    v_max3_u32 v6, v6, v147, v148
    v_max3_u32 v6, v6, v149, v150
    v_max3_u32 v6, v6, v151, v152
    v_max3_u32 v6, v6, v153, v154
    v_max_u32 v6, v6, v155
    v_cmp_eq_u32 vcc, -1, v6
    s_sub_u32 s7, s7, 1
    s_nop 2
    s_cbranch_vccz L_kva_tw110
    s_cmp_eq_u32 s7, 0
    s_cbranch_scc0 L_kva_tx111
    s_branch L_kva_tw110
L_kva_tv112:
    s_mov_b32 s7, 0x40000
L_kva_tx114:
    s_sleep 1
    s_add_u32 s4, s77, 0
    buffer_load_dwordx4 v[108:111], v10, s[8:11], s4 offen offset:0 sc1
    buffer_load_dwordx4 v[112:115], v10, s[8:11], s4 offen offset:1024 sc1
    buffer_load_dwordx4 v[116:119], v10, s[8:11], s4 offen offset:2048 sc1
    s_waitcnt vmcnt(0)
    v_max3_u32 v6, v108, v109, v110
    v_max3_u32 v6, v6, v111, v112
    v_max3_u32 v6, v6, v113, v114
    v_max3_u32 v6, v6, v115, v116
    v_max3_u32 v6, v6, v117, v118
    v_max_u32 v6, v6, v119
    v_cmp_eq_u32 vcc, -1, v6
    s_sub_u32 s7, s7, 1
    s_nop 2
    s_cbranch_vccz L_kva_tw113
    s_cmp_eq_u32 s7, 0
    s_cbranch_scc0 L_kva_tx114
    s_branch L_kva_tw113
L_kva_tv115:
    s_mov_b32 s7, 0x40000
L_kva_tx117:
    s_sleep 1
    s_add_u32 s4, s77, 3072
    buffer_load_dwordx4 v[120:123], v10, s[8:11], s4 offen offset:0 sc1
    buffer_load_dwordx4 v[124:127], v10, s[8:11], s4 offen offset:1024 sc1
    buffer_load_dwordx4 v[128:131], v10, s[8:11], s4 offen offset:2048 sc1
    s_waitcnt vmcnt(0)
    v_max3_u32 v6, v120, v121, v122
    v_max3_u32 v6, v6, v123, v124
    v_max3_u32 v6, v6, v125, v126
    v_max3_u32 v6, v6, v127, v128
    v_max3_u32 v6, v6, v129, v130
    v_max_u32 v6, v6, v131
    v_cmp_eq_u32 vcc, -1, v6
    s_sub_u32 s7, s7, 1
    s_nop 2
    s_cbranch_vccz L_kva_tw116
    s_cmp_eq_u32 s7, 0
    s_cbranch_scc0 L_kva_tx117
    s_branch L_kva_tw116
L_kva_tv118:
    s_mov_b32 s7, 0x40000
L_kva_tx120:
    s_sleep 1
    s_add_u32 s4, s77, 6144
    buffer_load_dwordx4 v[132:135], v10, s[8:11], s4 offen offset:0 sc1
    buffer_load_dwordx4 v[136:139], v10, s[8:11], s4 offen offset:1024 sc1
    buffer_load_dwordx4 v[140:143], v10, s[8:11], s4 offen offset:2048 sc1
    s_waitcnt vmcnt(0)
    v_max3_u32 v6, v132, v133, v134
    v_max3_u32 v6, v6, v135, v136
    v_max3_u32 v6, v6, v137, v138
    v_max3_u32 v6, v6, v139, v140
    v_max3_u32 v6, v6, v141, v142
    v_max_u32 v6, v6, v143
    v_cmp_eq_u32 vcc, -1, v6
    s_sub_u32 s7, s7, 1
    s_nop 2
    s_cbranch_vccz L_kva_tw119
    s_cmp_eq_u32 s7, 0
    s_cbranch_scc0 L_kva_tx120
    s_branch L_kva_tw119
L_kva_tv121:
    s_mov_b32 s7, 0x40000
L_kva_tx123:
    s_sleep 1
    s_add_u32 s4, s77, 9216
    buffer_load_dwordx4 v[144:147], v10, s[8:11], s4 offen offset:0 sc1
    buffer_load_dwordx4 v[148:151], v10, s[8:11], s4 offen offset:1024 sc1
    buffer_load_dwordx4 v[152:155], v10, s[8:11], s4 offen offset:2048 sc1
    s_waitcnt vmcnt(0)
    v_max3_u32 v6, v144, v145, v146
    v_max3_u32 v6, v6, v147, v148
    v_max3_u32 v6, v6, v149, v150
    v_max3_u32 v6, v6, v151, v152
    v_max3_u32 v6, v6, v153, v154
    v_max_u32 v6, v6, v155
    v_cmp_eq_u32 vcc, -1, v6
    s_sub_u32 s7, s7, 1
    s_nop 2
    s_cbranch_vccz L_kva_tw122
    s_cmp_eq_u32 s7, 0
    s_cbranch_scc0 L_kva_tx123
    s_branch L_kva_tw122
L_kva_tf124:
    buffer_store_dwordx2 v[168:169], v12, s[8:11], s4 offen offset:0 sc1
    buffer_store_dwordx2 v[184:185], v12, s[8:11], s4 offen offset:2048 sc1
    buffer_store_dwordx2 v[200:201], v12, s[8:11], s5 offen offset:0 sc1
    s_branch L_kva_tg125
L_kva_tv126:
    s_mov_b32 s7, 0x40000
L_kva_tx128:
    s_sleep 4
    buffer_load_dwordx4 v[68:71], v9, s[8:11], s44 offen sc1
    buffer_load_dwordx4 v[72:75], v10, s[8:11], s44 offen sc1
    buffer_load_dwordx4 v[76:79], v9, s[8:11], s45 offen sc1
    buffer_load_dwordx4 v[80:83], v10, s[8:11], s45 offen sc1
    buffer_load_dwordx4 v[84:87], v9, s[8:11], s46 offen sc1
    buffer_load_dwordx4 v[88:91], v10, s[8:11], s46 offen sc1
    buffer_load_dwordx4 v[92:95], v9, s[8:11], s47 offen sc1
    buffer_load_dwordx4 v[96:99], v10, s[8:11], s47 offen sc1
    buffer_load_dwordx4 v[100:103], v9, s[8:11], s28 offen sc1
    buffer_load_dwordx4 v[104:107], v10, s[8:11], s28 offen sc1
    buffer_load_dwordx4 v[108:111], v9, s[8:11], s29 offen sc1
    buffer_load_dwordx4 v[112:115], v10, s[8:11], s29 offen sc1
    s_waitcnt vmcnt(0)
    v_max3_u32 v6, v68, v69, v70
    v_max3_u32 v6, v6, v71, v72
    v_max3_u32 v6, v6, v73, v74
    v_max_u32 v6, v6, v75
    v_cmp_eq_u32 vcc, -1, v6
    s_sub_u32 s7, s7, 1
    s_nop 2
    s_cbranch_vccz L_kva_tw127
    s_cmp_eq_u32 s7, 0
    s_cbranch_scc0 L_kva_tx128
    s_branch L_kva_tw127
L_kva_tv129:
    s_mov_b32 s7, 0x40000
L_kva_tx131:
    s_sleep 4
    buffer_load_dwordx4 v[76:79], v9, s[8:11], s45 offen sc1
    buffer_load_dwordx4 v[80:83], v10, s[8:11], s45 offen sc1
    buffer_load_dwordx4 v[84:87], v9, s[8:11], s46 offen sc1
    buffer_load_dwordx4 v[88:91], v10, s[8:11], s46 offen sc1
    buffer_load_dwordx4 v[92:95], v9, s[8:11], s47 offen sc1
    buffer_load_dwordx4 v[96:99], v10, s[8:11], s47 offen sc1
    buffer_load_dwordx4 v[100:103], v9, s[8:11], s28 offen sc1
    buffer_load_dwordx4 v[104:107], v10, s[8:11], s28 offen sc1
    buffer_load_dwordx4 v[108:111], v9, s[8:11], s29 offen sc1
    buffer_load_dwordx4 v[112:115], v10, s[8:11], s29 offen sc1
    s_waitcnt vmcnt(0)
    v_max3_u32 v6, v76, v77, v78
    v_max3_u32 v6, v6, v79, v80
    v_max3_u32 v6, v6, v81, v82
    v_max_u32 v6, v6, v83
    v_cmp_eq_u32 vcc, -1, v6
    s_sub_u32 s7, s7, 1
    s_nop 2
    s_cbranch_vccz L_kva_tw130
    s_cmp_eq_u32 s7, 0
    s_cbranch_scc0 L_kva_tx131
    s_branch L_kva_tw130
L_kva_tv132:
    s_mov_b32 s7, 0x40000
L_kva_tx134:
    s_sleep 4
    buffer_load_dwordx4 v[84:87], v9, s[8:11], s46 offen sc1
    buffer_load_dwordx4 v[88:91], v10, s[8:11], s46 offen sc1
    buffer_load_dwordx4 v[92:95], v9, s[8:11], s47 offen sc1
    buffer_load_dwordx4 v[96:99], v10, s[8:11], s47 offen sc1
    buffer_load_dwordx4 v[100:103], v9, s[8:11], s28 offen sc1
    buffer_load_dwordx4 v[104:107], v10, s[8:11], s28 offen sc1
    buffer_load_dwordx4 v[108:111], v9, s[8:11], s29 offen sc1
    buffer_load_dwordx4 v[112:115], v10, s[8:11], s29 offen sc1
    s_waitcnt vmcnt(0)
    v_max3_u32 v6, v84, v85, v86
    v_max3_u32 v6, v6, v87, v88
    v_max3_u32 v6, v6, v89, v90
    v_max_u32 v6, v6, v91
    v_cmp_eq_u32 vcc, -1, v6
    s_sub_u32 s7, s7, 1
    s_nop 2
    s_cbranch_vccz L_kva_tw133
    s_cmp_eq_u32 s7, 0
    s_cbranch_scc0 L_kva_tx134
    s_branch L_kva_tw133
L_kva_tv135:
    s_mov_b32 s7, 0x40000
L_kva_tx137:
    s_sleep 4
    buffer_load_dwordx4 v[92:95], v9, s[8:11], s47 offen sc1
    buffer_load_dwordx4 v[96:99], v10, s[8:11], s47 offen sc1
    buffer_load_dwordx4 v[100:103], v9, s[8:11], s28 offen sc1
    buffer_load_dwordx4 v[104:107], v10, s[8:11], s28 offen sc1
    buffer_load_dwordx4 v[108:111], v9, s[8:11], s29 offen sc1
    buffer_load_dwordx4 v[112:115], v10, s[8:11], s29 offen sc1
    s_waitcnt vmcnt(0)
    v_max3_u32 v6, v92, v93, v94
    v_max3_u32 v6, v6, v95, v96
    v_max3_u32 v6, v6, v97, v98
    v_max_u32 v6, v6, v99
    v_cmp_eq_u32 vcc, -1, v6
    s_sub_u32 s7, s7, 1
    s_nop 2
    s_cbranch_vccz L_kva_tw136
    s_cmp_eq_u32 s7, 0
    s_cbranch_scc0 L_kva_tx137
    s_branch L_kva_tw136
L_kva_tv138:
    s_mov_b32 s7, 0x40000
L_kva_tx140:
    s_sleep 4
    buffer_load_dwordx4 v[100:103], v9, s[8:11], s28 offen sc1
    buffer_load_dwordx4 v[104:107], v10, s[8:11], s28 offen sc1
    buffer_load_dwordx4 v[108:111], v9, s[8:11], s29 offen sc1
    buffer_load_dwordx4 v[112:115], v10, s[8:11], s29 offen sc1
    s_waitcnt vmcnt(0)
    v_max3_u32 v6, v100, v101, v102
    v_max3_u32 v6, v6, v103, v104
    v_max3_u32 v6, v6, v105, v106
    v_max_u32 v6, v6, v107
    v_cmp_eq_u32 vcc, -1, v6
    s_sub_u32 s7, s7, 1
    s_nop 2
    s_cbranch_vccz L_kva_tw139
    s_cmp_eq_u32 s7, 0
    s_cbranch_scc0 L_kva_tx140
    s_branch L_kva_tw139
L_kva_tv141:
    s_mov_b32 s7, 0x40000
L_kva_tx143:
    s_sleep 4
    buffer_load_dwordx4 v[108:111], v9, s[8:11], s29 offen sc1
    buffer_load_dwordx4 v[112:115], v10, s[8:11], s29 offen sc1
    s_waitcnt vmcnt(0)
    v_max3_u32 v6, v108, v109, v110
    v_max3_u32 v6, v6, v111, v112
    v_max3_u32 v6, v6, v113, v114
    v_max_u32 v6, v6, v115
    v_cmp_eq_u32 vcc, -1, v6
    s_sub_u32 s7, s7, 1
    s_nop 2
    s_cbranch_vccz L_kva_tw142
    s_cmp_eq_u32 s7, 0
    s_cbranch_scc0 L_kva_tx143
    s_branch L_kva_tw142
L_kva_last:
.section .rodata,"a"
.p2align 6
.amdhsa_kernel kva_kernel
  .amdhsa_next_free_vgpr 256
  .amdhsa_next_free_sgpr 100
  .amdhsa_accum_offset 256
  .amdhsa_group_segment_fixed_size 0
  .amdhsa_kernarg_size 128
  .amdhsa_user_sgpr_count 2
  .amdhsa_user_sgpr_kernarg_segment_ptr 1
  .amdhsa_system_sgpr_workgroup_id_x 1
.end_amdhsa_kernel
```
